```python
import torch

def _softmax(x, axis=-1):
    return torch.softmax(x, dim=axis)
def _gelu(x):
    return torch.nn.functional.gelu(x, approximate="tanh")
def _silu(x):
    return torch.nn.functional.silu(x)
def _sigmoid(x):
    return torch.sigmoid(x)
def _layernorm(x, axis=-1, eps=1e-5):
    m = x.mean(dim=axis, keepdim=True)
    v = x.var(dim=axis, keepdim=True, unbiased=False)
    return (x - m) / torch.sqrt(v + eps)
def _scatter_add(tgt, idx, src, axis=0):
    return tgt.clone().index_add_(axis, idx, src)
def _segment_sum(src, seg, n):
    out = torch.zeros((n,) + src.shape[1:], dtype=src.dtype)
    return out.index_add_(0, seg, src)
def _pad(x, pw):
    flat = tuple(v for pair in reversed(pw) for v in pair)
    return torch.nn.functional.pad(x, flat)

kernel_name = 'parallel_sum__ssm_conv_h3__glu_gated_swiglu__prompt'

def setup_inputs():

    _w = (lambda a: (lambda t: t.to(torch.bfloat16) if t.is_floating_point() else t)(torch.as_tensor(a)))
    def _A_setup():
        B, S, D = 1, 2048, 1024
        ks = 4
        return {
            "q": _w((lambda *s: torch.randn(*s, dtype=torch.bfloat16) * 0.05)(B, S, D)),
            "k": _w((lambda *s: torch.randn(*s, dtype=torch.bfloat16) * 0.2)(B, S, D)),
            "v": _w((lambda *s: torch.randn(*s, dtype=torch.bfloat16) * 0.2)(B, S, D)),
            "shift_k": _w((lambda *s: torch.randn(*s, dtype=torch.bfloat16) * 0.2)(D, ks) * 0.5),
            "ssm_k": _w((lambda *s: torch.randn(*s, dtype=torch.bfloat16) * 0.4)(D, S) * (1.0 / S ** 0.5)),
            "ssm_D": _w((lambda *s: torch.randn(*s, dtype=torch.bfloat16) * 0.2)(D)),
        }
    _A_in = _A_setup()

    def _B_setup():
        B, S, D, F = 1, 2048, 1024, 3584
        return {
            "x": _w((lambda *s: torch.randn(*s, dtype=torch.bfloat16) * 0.05)(B, S, D)),
            "w1": _w((lambda *s: torch.randn(*s, dtype=torch.bfloat16) * 0.2)(D, F) * (2.0 / D) ** 0.5),
            "w3": _w((lambda *s: torch.randn(*s, dtype=torch.bfloat16) * 0.2)(D, F) * (2.0 / D) ** 0.5),
            "w2": _w((lambda *s: torch.randn(*s, dtype=torch.bfloat16) * 0.2)(F, D) * (2.0 / F) ** 0.5),
        }
    _B_in = _B_setup()

    return {
        "A_q": _A_in["q"],
        "A_k": _A_in["k"],
        "A_v": _A_in["v"],
        "A_shift_k": _A_in["shift_k"],
        "A_ssm_k": _A_in["ssm_k"],
        "A_ssm_D": _A_in["ssm_D"],
        "B_x": _B_in["x"],
        "B_w1": _B_in["w1"],
        "B_w3": _B_in["w3"],
        "B_w2": _B_in["w2"],
    }

def reference(A_q, A_k, A_v, A_shift_k, A_ssm_k, A_ssm_D, B_x, B_w1, B_w3, B_w2):
    def _A_ref(q, k, v, shift_k, ssm_k, ssm_D):
        B, S, D = q.shape
        ks = shift_k.shape[-1]
        k_pad = _pad(k, ((0, 0), (ks - 1, 0), (0, 0)))
        k_shift = torch.zeros_like(k)
        for t in range(ks):
            k_shift = k_shift + k_pad[:, t:t + S, :] * shift_k[:, ks - 1 - t][None, None, :]
        kv = k_shift * v
        L = 2 * S
        kv_pad = _pad(kv, ((0, 0), (0, S), (0, 0)))
        kf_pad = _pad(ssm_k, ((0, 0), (0, S)))
        kv_f = (lambda x, axes=(-2,-1): torch.fft.rfft2(x.float(), dim=axes))(kv_pad[:, None, :, :], axes=(1, 2))
        kf_f = (lambda x, axes=(-2,-1): torch.fft.rfft2(x.float(), dim=axes))(kf_pad[:, None, :], axes=(1, 2))
        kf_f = (lambda x, *d: x.permute(*d))(kf_f, 1, 2, 0)
        y_f = kv_f * kf_f[None, :, :, :]
        y = (lambda x, s, axes=(-2,-1): torch.fft.irfft2(x, s=s, dim=axes).to(torch.bfloat16))(y_f, (1, L), axes=(1, 2))[:, 0, :S, :]
        y = y + kv * ssm_D[None, None, :]
        return q * y

    def _B_ref(x, w1, w3, w2):
        gate = torch.einsum("bsd,df->bsf", x, w1)
        up = torch.einsum("bsd,df->bsf", x, w3)
        h = _silu(gate) * up
        out = torch.einsum("bsf,fd->bsd", h, w2)
        return out

    x = A_q
    xn = _layernorm(x, axis=-1)
    return x + _A_ref(xn, A_k, A_v, A_shift_k, A_ssm_k, A_ssm_D) + _B_ref(xn, B_w1, B_w3, B_w2)
```

```asm
; @launch kernel=k1_kernel grid=(256,1,1) block=(256,1,1) lds=134144
; @launch kernel=k2_kernel grid=(256,1,1) block=(512,1,1) lds=150592
.amdgcn_target "amdgcn-amd-amdhsa--gfx950"
.text
.globl k1_kernel
.p2align 8
.type k1_kernel,@function
k1_kernel:

    s_cmp_ge_u32 s2, 256
    s_cbranch_scc1 k1_kernel_end
    s_load_dwordx2 s[4:5], s[0:1], 96
    s_load_dwordx4 s[52:55], s[0:1], 56
    s_load_dwordx4 s[92:95], s[0:1], 0
    s_load_dwordx2 s[90:91], s[0:1], 88
    v_lshrrev_b32 v1, 6, v0
    v_and_b32 v2, 63, v0
    v_lshlrev_b32 v26, 4, v2
    v_readfirstlane_b32 s32, v1
    s_cmp_lt_u32 s2, 32
    s_cbranch_scc1 k1_kernel_helper
    s_sub_u32 s58, s2, 32
    s_and_b32 s56, s58, 7
    s_lshr_b32 s57, s58, 3
    s_and_b32 s58, s56, 1
    s_lshl_b32 s58, s58, 2
    s_and_b32 s59, s57, 3
    s_add_u32 s44, s58, s59
    s_lshr_b32 s58, s56, 1
    s_mul_i32 s58, s58, 7
    s_lshr_b32 s59, s57, 2
    s_add_u32 s45, s58, s59
    v_lshrrev_b32 v3, 4, v2
    v_sub_u32 v3, 0, v3
    v_xor_b32 v3, v3, v2
    v_and_b32 v3, 3, v3
    v_lshrrev_b32 v4, 2, v2
    s_lshl_b32 s56, s44, 8
    s_lshl_b32 s57, s32, 6
    s_add_u32 s56, s56, s57
    v_add_u32 v4, s56, v4
    v_lshlrev_b32 v4, 11, v4
    v_lshl_add_u32 v12, v3, 4, v4
    s_lshl_b32 s36, s32, 12
    s_add_u32 s36, s36, 0
    v_add_u32 v13, 32768, v12
    s_lshl_b32 s37, s32, 12
    s_add_u32 s37, s37, 1024
    v_add_u32 v14, 65536, v12
    s_lshl_b32 s38, s32, 12
    s_add_u32 s38, s38, 2048
    v_add_u32 v15, 98304, v12
    s_lshl_b32 s39, s32, 12
    s_add_u32 s39, s39, 3072
    v_lshrrev_b32 v3, 4, v2
    v_bfe_u32 v4, v2, 2, 2
    v_and_b32 v5, 3, v2
    s_and_b32 s56, s32, 1
    s_lshl_b32 s56, s56, 4
    v_add_u32 v4, s56, v4
    v_mul_u32_u24 v4, 0x1c00, v4
    s_lshl_b32 s56, s45, 8
    v_lshl_add_u32 v4, v3, 6, v4
    v_add_u32 v4, s56, v4
    v_xor_b32 v6, 0, v5
    v_lshlrev_b32 v6, 4, v6
    v_add_u32 v6, 0, v6
    v_add_u32 v16, v4, v6
    s_lshl_b32 s40, s32, 12
    s_add_u32 s40, s40, 16384
    v_xor_b32 v6, 0, v5
    v_lshlrev_b32 v6, 4, v6
    v_add_u32 v6, 28672, v6
    v_add_u32 v17, v4, v6
    s_lshl_b32 s41, s32, 12
    s_add_u32 s41, s41, 17408
    v_xor_b32 v6, 2, v5
    v_lshlrev_b32 v6, 4, v6
    v_add_u32 v6, 57344, v6
    v_add_u32 v18, v4, v6
    s_lshl_b32 s42, s32, 12
    s_add_u32 s42, s42, 18432
    v_xor_b32 v6, 2, v5
    v_lshlrev_b32 v6, 4, v6
    v_add_u32 v6, 86016, v6
    v_add_u32 v19, v4, v6
    s_lshl_b32 s43, s32, 12
    s_add_u32 s43, s43, 19456
    s_waitcnt lgkmcnt(0)
    s_mov_b32 s8, s92
    s_mov_b32 s9, s93
    s_mov_b32 s10, 4194304
    s_mov_b32 s11, 0x00020000
    s_cmp_lt_u32 s32, 2
    s_cselect_b32 s12, s52, s54
    s_cselect_b32 s13, s53, s55
    s_mov_b32 s14, 7340032
    s_mov_b32 s15, 0x00020000
    s_mov_b32 s33, 0
    s_mov_b32 s34, 0
    s_add_u32 m0, s36, 0
    s_nop 0
    buffer_load_dwordx4 v12, s[8:11], s33 offen lds
    s_add_u32 m0, s37, 0
    s_nop 0
    buffer_load_dwordx4 v13, s[8:11], s33 offen lds
    s_add_u32 m0, s38, 0
    s_nop 0
    buffer_load_dwordx4 v14, s[8:11], s33 offen lds
    s_add_u32 m0, s39, 0
    s_nop 0
    buffer_load_dwordx4 v15, s[8:11], s33 offen lds
    s_add_u32 m0, s40, 0
    s_nop 0
    buffer_load_dwordx4 v16, s[12:15], s34 offen lds
    s_add_u32 m0, s41, 0
    s_nop 0
    buffer_load_dwordx4 v17, s[12:15], s34 offen lds
    s_add_u32 m0, s42, 0
    s_nop 0
    buffer_load_dwordx4 v18, s[12:15], s34 offen lds
    s_add_u32 m0, s43, 0
    s_nop 0
    buffer_load_dwordx4 v19, s[12:15], s34 offen lds
    s_mov_b32 s33, 64
    s_mov_b32 s34, 229376
    s_add_u32 m0, s36, 32768
    s_nop 0
    buffer_load_dwordx4 v12, s[8:11], s33 offen lds
    s_add_u32 m0, s37, 32768
    s_nop 0
    buffer_load_dwordx4 v13, s[8:11], s33 offen lds
    s_add_u32 m0, s38, 32768
    s_nop 0
    buffer_load_dwordx4 v14, s[8:11], s33 offen lds
    s_add_u32 m0, s39, 32768
    s_nop 0
    buffer_load_dwordx4 v15, s[8:11], s33 offen lds
    s_add_u32 m0, s40, 32768
    s_nop 0
    buffer_load_dwordx4 v16, s[12:15], s34 offen lds
    s_add_u32 m0, s41, 32768
    s_nop 0
    buffer_load_dwordx4 v17, s[12:15], s34 offen lds
    s_add_u32 m0, s42, 32768
    s_nop 0
    buffer_load_dwordx4 v18, s[12:15], s34 offen lds
    s_add_u32 m0, s43, 32768
    s_nop 0
    buffer_load_dwordx4 v19, s[12:15], s34 offen lds
    s_mov_b32 s33, 128
    s_mov_b32 s34, 458752
    s_add_u32 m0, s36, 65536
    s_nop 0
    buffer_load_dwordx4 v12, s[8:11], s33 offen lds
    s_add_u32 m0, s37, 65536
    s_nop 0
    buffer_load_dwordx4 v13, s[8:11], s33 offen lds
    s_add_u32 m0, s38, 65536
    s_nop 0
    buffer_load_dwordx4 v14, s[8:11], s33 offen lds
    s_add_u32 m0, s39, 65536
    s_nop 0
    buffer_load_dwordx4 v15, s[8:11], s33 offen lds
    s_add_u32 m0, s40, 65536
    s_nop 0
    buffer_load_dwordx4 v16, s[12:15], s34 offen lds
    s_add_u32 m0, s41, 65536
    s_nop 0
    buffer_load_dwordx4 v17, s[12:15], s34 offen lds
    s_add_u32 m0, s42, 65536
    s_nop 0
    buffer_load_dwordx4 v18, s[12:15], s34 offen lds
    s_add_u32 m0, s43, 65536
    s_nop 0
    buffer_load_dwordx4 v19, s[12:15], s34 offen lds
    s_mov_b32 s33, 192
    s_mov_b32 s34, 688128
    s_mov_b32 s48, 98304
    v_lshrrev_b32 v3, 4, v2
    v_bfe_u32 v4, v2, 2, 2
    v_and_b32 v5, 3, v2
    v_lshlrev_b32 v6, 6, v4
    v_lshl_add_u32 v6, v5, 3, v6
    v_lshl_add_u32 v6, v3, 11, v6
    s_and_b32 s56, s32, 1
    s_lshl_b32 s56, s56, 9
    v_add_u32 v6, s56, v6
    v_and_b32 v7, 1, v3
    v_lshl_add_u32 v8, v7, 5, v6
    v_xor_b32 v7, 1, v7
    v_lshl_add_u32 v9, v7, 5, v6
    v_lshrrev_b32 v6, 2, v2
    v_sub_u32 v6, 0, v6
    v_xor_b32 v6, v6, v3
    v_and_b32 v6, 3, v6
    v_and_b32 v7, 15, v2
    s_lshr_b32 s56, s32, 1
    s_lshl_b32 s56, s56, 7
    v_add_u32 v7, s56, v7
    v_lshlrev_b32 v7, 6, v7
    v_lshl_add_u32 v10, v6, 4, v7
    v_mov_b32 v192, 0x3f803f80
    v_mov_b32 v193, 0x3f803f80
    v_mov_b32 v194, 0x3f803f80
    v_mov_b32 v195, 0x3f803f80
    s_mov_b32 s16, s52
    s_mov_b32 s17, s53
    s_mov_b32 s18, 7340032
    s_mov_b32 s19, 0x00020000
    s_mov_b32 s20, s54
    s_mov_b32 s21, s55
    s_mov_b32 s22, 7340032
    s_mov_b32 s23, 0x00020000
    s_sub_u32 s60, s2, 32
    s_lshl_b32 s60, s60, 2
    s_add_u32 s60, s60, s32
    s_lshl_b32 s60, s60, 9
    v_lshlrev_b32 v23, 7, v2
    v_add_u32 v23, s60, v23
    v_mov_b32 v24, 0x80000000
    v_cmp_gt_u32 vcc, 4, v2
    s_mov_b32 s24, 688128
    v_cndmask_b32 v23, v24, v23, vcc
    buffer_load_dword v25, v23, s[16:19], s24 offen
    buffer_load_dword v25, v23, s[20:23], s24 offen
    s_add_u32 s24, s24, 458752
    buffer_load_dword v25, v23, s[16:19], s24 offen
    buffer_load_dword v25, v23, s[20:23], s24 offen
    s_add_u32 s24, s24, 458752
    buffer_load_dword v25, v23, s[16:19], s24 offen
    buffer_load_dword v25, v23, s[20:23], s24 offen
    s_add_u32 s24, s24, 458752
    buffer_load_dword v25, v23, s[16:19], s24 offen
    buffer_load_dword v25, v23, s[20:23], s24 offen
    s_add_u32 s24, s24, 458752
    buffer_load_dword v25, v23, s[16:19], s24 offen
    buffer_load_dword v25, v23, s[20:23], s24 offen
    s_add_u32 s24, s24, 458752
    s_mov_b32 s47, 0
    s_mov_b32 s50, 0
    v_mov_b32 v31, 0
    s_mov_b32 s56, s90
    s_mov_b32 s57, s91
    s_mov_b32 s58, 256
    s_mov_b32 s59, 0x00020000
    s_lshl_b32 s60, s44, 2
    v_mov_b32 v27, s60
    s_cmp_ge_u32 s32, 2
    s_cbranch_scc1 k1_kernel_p1
k1_kernel_p0:
    s_waitcnt vmcnt(26)
    s_barrier
    ds_read_b64_tr_b16 v[32:33], v8 offset:16384
    ds_read_b64_tr_b16 v[34:35], v8 offset:17408
    ds_read_b64_tr_b16 v[36:37], v8 offset:24576
    ds_read_b64_tr_b16 v[38:39], v8 offset:25600
    ds_read_b64_tr_b16 v[40:41], v9 offset:16384
    ds_read_b64_tr_b16 v[42:43], v9 offset:17408
    ds_read_b128 a[128:131], v10 offset:0
    ds_read_b128 a[132:135], v10 offset:1024
    ds_read_b128 a[136:139], v10 offset:2048
    ds_read_b128 a[140:143], v10 offset:3072
    ds_read_b128 a[144:147], v10 offset:4096
    ds_read_b128 a[148:151], v10 offset:5120
    ds_read_b128 a[152:155], v10 offset:6144
    ds_read_b128 a[156:159], v10 offset:7168
    s_waitcnt lgkmcnt(0)
    s_waitcnt vmcnt(18)
    s_barrier
    s_waitcnt lgkmcnt(0)
    v_mfma_f32_16x16x32_bf16 v[64:67], v[32:35], a[128:131], 0
    ds_read_b64_tr_b16 v[44:45], v9 offset:24576
    v_mfma_f32_16x16x32_bf16 v[68:71], v[32:35], a[132:135], 0
    ds_read_b64_tr_b16 v[46:47], v9 offset:25600
    v_mfma_f32_16x16x32_bf16 v[72:75], v[32:35], a[136:139], 0
    v_mfma_f32_16x16x32_bf16 v[76:79], v[32:35], a[140:143], 0
    v_mfma_f32_16x16x32_bf16 v[80:83], v[32:35], a[144:147], 0
    v_mfma_f32_16x16x32_bf16 v[84:87], v[32:35], a[148:151], 0
    s_add_u32 m0, s48, s36
    v_mfma_f32_16x16x32_bf16 v[88:91], v[32:35], a[152:155], 0
    buffer_load_dwordx4 v12, s[8:11], s33 offen lds
    v_mfma_f32_16x16x32_bf16 v[92:95], v[32:35], a[156:159], 0
    v_mfma_f32_16x16x32_bf16 a[192:195], v[32:35], v[192:195], 0
    v_mfma_f32_16x16x32_bf16 a[0:3], v[36:39], a[128:131], 0
    ds_read_b64_tr_b16 v[48:49], v8 offset:16640
    v_mfma_f32_16x16x32_bf16 a[4:7], v[36:39], a[132:135], 0
    ds_read_b64_tr_b16 v[50:51], v8 offset:17664
    v_mfma_f32_16x16x32_bf16 a[8:11], v[36:39], a[136:139], 0
    v_mfma_f32_16x16x32_bf16 a[12:15], v[36:39], a[140:143], 0
    v_mfma_f32_16x16x32_bf16 a[16:19], v[36:39], a[144:147], 0
    v_mfma_f32_16x16x32_bf16 a[20:23], v[36:39], a[148:151], 0
    s_add_u32 m0, s48, s37
    v_mfma_f32_16x16x32_bf16 a[24:27], v[36:39], a[152:155], 0
    buffer_load_dwordx4 v13, s[8:11], s33 offen lds
    v_mfma_f32_16x16x32_bf16 a[28:31], v[36:39], a[156:159], 0
    v_mfma_f32_16x16x32_bf16 a[196:199], v[36:39], v[192:195], 0
    v_mfma_f32_16x16x32_bf16 v[96:99], v[40:43], a[128:131], 0
    ds_read_b64_tr_b16 v[52:53], v8 offset:24832
    v_mfma_f32_16x16x32_bf16 v[100:103], v[40:43], a[132:135], 0
    ds_read_b64_tr_b16 v[54:55], v8 offset:25856
    v_mfma_f32_16x16x32_bf16 v[104:107], v[40:43], a[136:139], 0
    v_mfma_f32_16x16x32_bf16 v[108:111], v[40:43], a[140:143], 0
    v_mfma_f32_16x16x32_bf16 v[112:115], v[40:43], a[144:147], 0
    v_mfma_f32_16x16x32_bf16 v[116:119], v[40:43], a[148:151], 0
    s_add_u32 m0, s48, s38
    v_mfma_f32_16x16x32_bf16 v[120:123], v[40:43], a[152:155], 0
    buffer_load_dwordx4 v14, s[8:11], s33 offen lds
    v_mfma_f32_16x16x32_bf16 v[124:127], v[40:43], a[156:159], 0
    v_mfma_f32_16x16x32_bf16 a[200:203], v[40:43], v[192:195], 0
    s_waitcnt lgkmcnt(4)
    v_mfma_f32_16x16x32_bf16 a[32:35], v[44:47], a[128:131], 0
    ds_read_b64_tr_b16 v[56:57], v9 offset:16640
    v_mfma_f32_16x16x32_bf16 a[36:39], v[44:47], a[132:135], 0
    ds_read_b64_tr_b16 v[58:59], v9 offset:17664
    v_mfma_f32_16x16x32_bf16 a[40:43], v[44:47], a[136:139], 0
    v_mfma_f32_16x16x32_bf16 a[44:47], v[44:47], a[140:143], 0
    s_add_u32 s49, s47, 32768
    s_cmp_eq_u32 s49, 131072
    s_cselect_b32 s62, 0, s49
    s_sub_u32 s49, s62, s47
    s_mov_b32 s47, s62
    v_mfma_f32_16x16x32_bf16 a[48:51], v[44:47], a[144:147], 0
    v_mfma_f32_16x16x32_bf16 a[52:55], v[44:47], a[148:151], 0
    s_add_u32 m0, s48, s39
    v_mfma_f32_16x16x32_bf16 a[56:59], v[44:47], a[152:155], 0
    buffer_load_dwordx4 v15, s[8:11], s33 offen lds
    v_mfma_f32_16x16x32_bf16 a[60:63], v[44:47], a[156:159], 0
    v_mfma_f32_16x16x32_bf16 a[204:207], v[44:47], v[192:195], 0
    s_waitcnt lgkmcnt(4)
    v_mfma_f32_16x16x32_bf16 v[128:131], v[48:51], a[128:131], 0
    ds_read_b64_tr_b16 v[60:61], v9 offset:24832
    v_mfma_f32_16x16x32_bf16 v[132:135], v[48:51], a[132:135], 0
    ds_read_b64_tr_b16 v[62:63], v9 offset:25856
    v_mfma_f32_16x16x32_bf16 v[136:139], v[48:51], a[136:139], 0
    v_add_u32 v8, s49, v8
    v_mfma_f32_16x16x32_bf16 v[140:143], v[48:51], a[140:143], 0
    v_add_u32 v9, s49, v9
    v_mfma_f32_16x16x32_bf16 v[144:147], v[48:51], a[144:147], 0
    v_add_u32 v10, s49, v10
    v_mfma_f32_16x16x32_bf16 v[148:151], v[48:51], a[148:151], 0
    s_add_u32 m0, s48, s40
    v_mfma_f32_16x16x32_bf16 v[152:155], v[48:51], a[152:155], 0
    buffer_load_dwordx4 v16, s[12:15], s34 offen lds
    v_mfma_f32_16x16x32_bf16 v[156:159], v[48:51], a[156:159], 0
    s_waitcnt lgkmcnt(4)
    v_mfma_f32_16x16x32_bf16 a[64:67], v[52:55], a[128:131], 0
    ds_read_b64_tr_b16 v[32:33], v8 offset:16384
    v_mfma_f32_16x16x32_bf16 a[68:71], v[52:55], a[132:135], 0
    ds_read_b64_tr_b16 v[34:35], v8 offset:17408
    v_mfma_f32_16x16x32_bf16 a[72:75], v[52:55], a[136:139], 0
    ds_read_b128 a[160:163], v10 offset:0
    v_mfma_f32_16x16x32_bf16 a[76:79], v[52:55], a[140:143], 0
    ds_read_b128 a[164:167], v10 offset:1024
    v_mfma_f32_16x16x32_bf16 a[80:83], v[52:55], a[144:147], 0
    ds_read_b128 a[168:171], v10 offset:2048
    v_mfma_f32_16x16x32_bf16 a[84:87], v[52:55], a[148:151], 0
    s_add_u32 m0, s48, s41
    v_mfma_f32_16x16x32_bf16 a[88:91], v[52:55], a[152:155], 0
    buffer_load_dwordx4 v17, s[12:15], s34 offen lds
    v_mfma_f32_16x16x32_bf16 a[92:95], v[52:55], a[156:159], 0
    s_waitcnt lgkmcnt(7)
    v_mfma_f32_16x16x32_bf16 v[160:163], v[56:59], a[128:131], 0
    ds_read_b64_tr_b16 v[36:37], v8 offset:24576
    v_mfma_f32_16x16x32_bf16 v[164:167], v[56:59], a[132:135], 0
    ds_read_b64_tr_b16 v[38:39], v8 offset:25600
    v_mfma_f32_16x16x32_bf16 v[168:171], v[56:59], a[136:139], 0
    ds_read_b128 a[172:175], v10 offset:3072
    v_mfma_f32_16x16x32_bf16 v[172:175], v[56:59], a[140:143], 0
    ds_read_b128 a[176:179], v10 offset:4096
    v_mfma_f32_16x16x32_bf16 v[176:179], v[56:59], a[144:147], 0
    ds_read_b128 a[180:183], v10 offset:5120
    v_mfma_f32_16x16x32_bf16 v[180:183], v[56:59], a[148:151], 0
    s_add_u32 m0, s48, s42
    v_mfma_f32_16x16x32_bf16 v[184:187], v[56:59], a[152:155], 0
    buffer_load_dwordx4 v18, s[12:15], s34 offen lds
    v_mfma_f32_16x16x32_bf16 v[188:191], v[56:59], a[156:159], 0
    s_waitcnt lgkmcnt(10)
    v_mfma_f32_16x16x32_bf16 a[96:99], v[60:63], a[128:131], 0
    ds_read_b64_tr_b16 v[40:41], v9 offset:16384
    v_mfma_f32_16x16x32_bf16 a[100:103], v[60:63], a[132:135], 0
    ds_read_b64_tr_b16 v[42:43], v9 offset:17408
    v_mfma_f32_16x16x32_bf16 a[104:107], v[60:63], a[136:139], 0
    ds_read_b128 a[184:187], v10 offset:6144
    v_mfma_f32_16x16x32_bf16 a[108:111], v[60:63], a[140:143], 0
    ds_read_b128 a[188:191], v10 offset:7168
    v_mfma_f32_16x16x32_bf16 a[112:115], v[60:63], a[144:147], 0
    v_mfma_f32_16x16x32_bf16 a[116:119], v[60:63], a[148:151], 0
    s_add_u32 m0, s48, s43
    v_mfma_f32_16x16x32_bf16 a[120:123], v[60:63], a[152:155], 0
    buffer_load_dwordx4 v19, s[12:15], s34 offen lds
    buffer_load_dword v25, v23, s[16:19], s24 offen
    v_mfma_f32_16x16x32_bf16 a[124:127], v[60:63], a[156:159], 0
    s_add_u32 s33, s33, 64
    s_add_u32 s34, s34, 229376
    s_add_u32 s48, s48, 32768
    s_cmp_eq_u32 s48, 131072
    s_cselect_b32 s48, 0, s48
    s_waitcnt vmcnt(19)
    s_barrier
    s_waitcnt lgkmcnt(0)
    v_mfma_f32_16x16x32_bf16 v[64:67], v[32:35], a[160:163], v[64:67]
    ds_read_b64_tr_b16 v[44:45], v9 offset:24576
    v_mfma_f32_16x16x32_bf16 v[68:71], v[32:35], a[164:167], v[68:71]
    ds_read_b64_tr_b16 v[46:47], v9 offset:25600
    v_mfma_f32_16x16x32_bf16 v[72:75], v[32:35], a[168:171], v[72:75]
    v_mfma_f32_16x16x32_bf16 v[76:79], v[32:35], a[172:175], v[76:79]
    v_mfma_f32_16x16x32_bf16 v[80:83], v[32:35], a[176:179], v[80:83]
    v_mfma_f32_16x16x32_bf16 v[84:87], v[32:35], a[180:183], v[84:87]
    s_add_u32 m0, s48, s36
    v_mfma_f32_16x16x32_bf16 v[88:91], v[32:35], a[184:187], v[88:91]
    buffer_load_dwordx4 v12, s[8:11], s33 offen lds
    v_mfma_f32_16x16x32_bf16 v[92:95], v[32:35], a[188:191], v[92:95]
    v_mfma_f32_16x16x32_bf16 a[192:195], v[32:35], v[192:195], a[192:195]
    v_mfma_f32_16x16x32_bf16 a[0:3], v[36:39], a[160:163], a[0:3]
    ds_read_b64_tr_b16 v[48:49], v8 offset:16640
    v_mfma_f32_16x16x32_bf16 a[4:7], v[36:39], a[164:167], a[4:7]
    ds_read_b64_tr_b16 v[50:51], v8 offset:17664
    v_mfma_f32_16x16x32_bf16 a[8:11], v[36:39], a[168:171], a[8:11]
    v_mfma_f32_16x16x32_bf16 a[12:15], v[36:39], a[172:175], a[12:15]
    v_mfma_f32_16x16x32_bf16 a[16:19], v[36:39], a[176:179], a[16:19]
    v_mfma_f32_16x16x32_bf16 a[20:23], v[36:39], a[180:183], a[20:23]
    s_add_u32 m0, s48, s37
    v_mfma_f32_16x16x32_bf16 a[24:27], v[36:39], a[184:187], a[24:27]
    buffer_load_dwordx4 v13, s[8:11], s33 offen lds
    v_mfma_f32_16x16x32_bf16 a[28:31], v[36:39], a[188:191], a[28:31]
    v_mfma_f32_16x16x32_bf16 a[196:199], v[36:39], v[192:195], a[196:199]
    v_mfma_f32_16x16x32_bf16 v[96:99], v[40:43], a[160:163], v[96:99]
    ds_read_b64_tr_b16 v[52:53], v8 offset:24832
    v_mfma_f32_16x16x32_bf16 v[100:103], v[40:43], a[164:167], v[100:103]
    ds_read_b64_tr_b16 v[54:55], v8 offset:25856
    v_mfma_f32_16x16x32_bf16 v[104:107], v[40:43], a[168:171], v[104:107]
    v_mfma_f32_16x16x32_bf16 v[108:111], v[40:43], a[172:175], v[108:111]
    v_mfma_f32_16x16x32_bf16 v[112:115], v[40:43], a[176:179], v[112:115]
    v_mfma_f32_16x16x32_bf16 v[116:119], v[40:43], a[180:183], v[116:119]
    s_add_u32 m0, s48, s38
    v_mfma_f32_16x16x32_bf16 v[120:123], v[40:43], a[184:187], v[120:123]
    buffer_load_dwordx4 v14, s[8:11], s33 offen lds
    v_mfma_f32_16x16x32_bf16 v[124:127], v[40:43], a[188:191], v[124:127]
    v_mfma_f32_16x16x32_bf16 a[200:203], v[40:43], v[192:195], a[200:203]
    s_waitcnt lgkmcnt(4)
    v_mfma_f32_16x16x32_bf16 a[32:35], v[44:47], a[160:163], a[32:35]
    ds_read_b64_tr_b16 v[56:57], v9 offset:16640
    v_mfma_f32_16x16x32_bf16 a[36:39], v[44:47], a[164:167], a[36:39]
    ds_read_b64_tr_b16 v[58:59], v9 offset:17664
    v_mfma_f32_16x16x32_bf16 a[40:43], v[44:47], a[168:171], a[40:43]
    v_mfma_f32_16x16x32_bf16 a[44:47], v[44:47], a[172:175], a[44:47]
    s_add_u32 s49, s47, 32768
    s_cmp_eq_u32 s49, 131072
    s_cselect_b32 s62, 0, s49
    s_sub_u32 s49, s62, s47
    s_mov_b32 s47, s62
    v_mfma_f32_16x16x32_bf16 a[48:51], v[44:47], a[176:179], a[48:51]
    v_mfma_f32_16x16x32_bf16 a[52:55], v[44:47], a[180:183], a[52:55]
    s_add_u32 m0, s48, s39
    v_mfma_f32_16x16x32_bf16 a[56:59], v[44:47], a[184:187], a[56:59]
    buffer_load_dwordx4 v15, s[8:11], s33 offen lds
    v_mfma_f32_16x16x32_bf16 a[60:63], v[44:47], a[188:191], a[60:63]
    v_mfma_f32_16x16x32_bf16 a[204:207], v[44:47], v[192:195], a[204:207]
    s_waitcnt lgkmcnt(4)
    v_mfma_f32_16x16x32_bf16 v[128:131], v[48:51], a[160:163], v[128:131]
    ds_read_b64_tr_b16 v[60:61], v9 offset:24832
    v_mfma_f32_16x16x32_bf16 v[132:135], v[48:51], a[164:167], v[132:135]
    ds_read_b64_tr_b16 v[62:63], v9 offset:25856
    v_mfma_f32_16x16x32_bf16 v[136:139], v[48:51], a[168:171], v[136:139]
    v_add_u32 v8, s49, v8
    v_mfma_f32_16x16x32_bf16 v[140:143], v[48:51], a[172:175], v[140:143]
    v_add_u32 v9, s49, v9
    v_mfma_f32_16x16x32_bf16 v[144:147], v[48:51], a[176:179], v[144:147]
    v_add_u32 v10, s49, v10
    v_mfma_f32_16x16x32_bf16 v[148:151], v[48:51], a[180:183], v[148:151]
    s_add_u32 m0, s48, s40
    v_mfma_f32_16x16x32_bf16 v[152:155], v[48:51], a[184:187], v[152:155]
    buffer_load_dwordx4 v16, s[12:15], s34 offen lds
    v_mfma_f32_16x16x32_bf16 v[156:159], v[48:51], a[188:191], v[156:159]
    s_waitcnt lgkmcnt(4)
    v_mfma_f32_16x16x32_bf16 a[64:67], v[52:55], a[160:163], a[64:67]
    ds_read_b64_tr_b16 v[32:33], v8 offset:16384
    v_mfma_f32_16x16x32_bf16 a[68:71], v[52:55], a[164:167], a[68:71]
    ds_read_b64_tr_b16 v[34:35], v8 offset:17408
    v_mfma_f32_16x16x32_bf16 a[72:75], v[52:55], a[168:171], a[72:75]
    ds_read_b128 a[128:131], v10 offset:0
    v_mfma_f32_16x16x32_bf16 a[76:79], v[52:55], a[172:175], a[76:79]
    ds_read_b128 a[132:135], v10 offset:1024
    v_mfma_f32_16x16x32_bf16 a[80:83], v[52:55], a[176:179], a[80:83]
    ds_read_b128 a[136:139], v10 offset:2048
    v_mfma_f32_16x16x32_bf16 a[84:87], v[52:55], a[180:183], a[84:87]
    s_add_u32 m0, s48, s41
    v_mfma_f32_16x16x32_bf16 a[88:91], v[52:55], a[184:187], a[88:91]
    buffer_load_dwordx4 v17, s[12:15], s34 offen lds
    v_mfma_f32_16x16x32_bf16 a[92:95], v[52:55], a[188:191], a[92:95]
    s_waitcnt lgkmcnt(7)
    v_mfma_f32_16x16x32_bf16 v[160:163], v[56:59], a[160:163], v[160:163]
    ds_read_b64_tr_b16 v[36:37], v8 offset:24576
    v_mfma_f32_16x16x32_bf16 v[164:167], v[56:59], a[164:167], v[164:167]
    ds_read_b64_tr_b16 v[38:39], v8 offset:25600
    v_mfma_f32_16x16x32_bf16 v[168:171], v[56:59], a[168:171], v[168:171]
    ds_read_b128 a[140:143], v10 offset:3072
    v_mfma_f32_16x16x32_bf16 v[172:175], v[56:59], a[172:175], v[172:175]
    ds_read_b128 a[144:147], v10 offset:4096
    v_mfma_f32_16x16x32_bf16 v[176:179], v[56:59], a[176:179], v[176:179]
    ds_read_b128 a[148:151], v10 offset:5120
    v_mfma_f32_16x16x32_bf16 v[180:183], v[56:59], a[180:183], v[180:183]
    s_add_u32 m0, s48, s42
    v_mfma_f32_16x16x32_bf16 v[184:187], v[56:59], a[184:187], v[184:187]
    buffer_load_dwordx4 v18, s[12:15], s34 offen lds
    v_mfma_f32_16x16x32_bf16 v[188:191], v[56:59], a[188:191], v[188:191]
    s_waitcnt lgkmcnt(10)
    v_mfma_f32_16x16x32_bf16 a[96:99], v[60:63], a[160:163], a[96:99]
    ds_read_b64_tr_b16 v[40:41], v9 offset:16384
    v_mfma_f32_16x16x32_bf16 a[100:103], v[60:63], a[164:167], a[100:103]
    ds_read_b64_tr_b16 v[42:43], v9 offset:17408
    v_mfma_f32_16x16x32_bf16 a[104:107], v[60:63], a[168:171], a[104:107]
    ds_read_b128 a[152:155], v10 offset:6144
    v_mfma_f32_16x16x32_bf16 a[108:111], v[60:63], a[172:175], a[108:111]
    ds_read_b128 a[156:159], v10 offset:7168
    v_mfma_f32_16x16x32_bf16 a[112:115], v[60:63], a[176:179], a[112:115]
    v_mfma_f32_16x16x32_bf16 a[116:119], v[60:63], a[180:183], a[116:119]
    s_add_u32 m0, s48, s43
    v_mfma_f32_16x16x32_bf16 a[120:123], v[60:63], a[184:187], a[120:123]
    buffer_load_dwordx4 v19, s[12:15], s34 offen lds
    buffer_load_dword v25, v23, s[20:23], s24 offen
    v_mfma_f32_16x16x32_bf16 a[124:127], v[60:63], a[188:191], a[124:127]
    s_add_u32 s33, s33, 64
    s_add_u32 s34, s34, 229376
    s_add_u32 s48, s48, 32768
    s_cmp_eq_u32 s48, 131072
    s_cselect_b32 s48, 0, s48
    s_add_u32 s24, s24, 458752
    s_mov_b32 s35, 15
k1_kernel_p0_loop:
    s_waitcnt vmcnt(10)
    s_barrier
    s_waitcnt lgkmcnt(0)
    v_mfma_f32_16x16x32_bf16 v[64:67], v[32:35], a[128:131], v[64:67]
    ds_read_b64_tr_b16 v[44:45], v9 offset:24576
    v_mfma_f32_16x16x32_bf16 v[68:71], v[32:35], a[132:135], v[68:71]
    ds_read_b64_tr_b16 v[46:47], v9 offset:25600
    v_mfma_f32_16x16x32_bf16 v[72:75], v[32:35], a[136:139], v[72:75]
    v_mfma_f32_16x16x32_bf16 v[76:79], v[32:35], a[140:143], v[76:79]
    v_mfma_f32_16x16x32_bf16 v[80:83], v[32:35], a[144:147], v[80:83]
    v_mfma_f32_16x16x32_bf16 v[84:87], v[32:35], a[148:151], v[84:87]
    s_add_u32 m0, s48, s36
    v_mfma_f32_16x16x32_bf16 v[88:91], v[32:35], a[152:155], v[88:91]
    buffer_load_dwordx4 v12, s[8:11], s33 offen lds
    v_mfma_f32_16x16x32_bf16 v[92:95], v[32:35], a[156:159], v[92:95]
    v_mfma_f32_16x16x32_bf16 a[192:195], v[32:35], v[192:195], a[192:195]
    v_mfma_f32_16x16x32_bf16 a[0:3], v[36:39], a[128:131], a[0:3]
    ds_read_b64_tr_b16 v[48:49], v8 offset:16640
    v_mfma_f32_16x16x32_bf16 a[4:7], v[36:39], a[132:135], a[4:7]
    ds_read_b64_tr_b16 v[50:51], v8 offset:17664
    v_mfma_f32_16x16x32_bf16 a[8:11], v[36:39], a[136:139], a[8:11]
    v_mfma_f32_16x16x32_bf16 a[12:15], v[36:39], a[140:143], a[12:15]
    v_mfma_f32_16x16x32_bf16 a[16:19], v[36:39], a[144:147], a[16:19]
    v_mfma_f32_16x16x32_bf16 a[20:23], v[36:39], a[148:151], a[20:23]
    s_add_u32 m0, s48, s37
    v_mfma_f32_16x16x32_bf16 a[24:27], v[36:39], a[152:155], a[24:27]
    buffer_load_dwordx4 v13, s[8:11], s33 offen lds
    v_mfma_f32_16x16x32_bf16 a[28:31], v[36:39], a[156:159], a[28:31]
    v_mfma_f32_16x16x32_bf16 a[196:199], v[36:39], v[192:195], a[196:199]
    v_mfma_f32_16x16x32_bf16 v[96:99], v[40:43], a[128:131], v[96:99]
    ds_read_b64_tr_b16 v[52:53], v8 offset:24832
    v_mfma_f32_16x16x32_bf16 v[100:103], v[40:43], a[132:135], v[100:103]
    ds_read_b64_tr_b16 v[54:55], v8 offset:25856
    v_mfma_f32_16x16x32_bf16 v[104:107], v[40:43], a[136:139], v[104:107]
    v_mfma_f32_16x16x32_bf16 v[108:111], v[40:43], a[140:143], v[108:111]
    v_mfma_f32_16x16x32_bf16 v[112:115], v[40:43], a[144:147], v[112:115]
    v_mfma_f32_16x16x32_bf16 v[116:119], v[40:43], a[148:151], v[116:119]
    s_add_u32 m0, s48, s38
    v_mfma_f32_16x16x32_bf16 v[120:123], v[40:43], a[152:155], v[120:123]
    buffer_load_dwordx4 v14, s[8:11], s33 offen lds
    v_mfma_f32_16x16x32_bf16 v[124:127], v[40:43], a[156:159], v[124:127]
    v_mfma_f32_16x16x32_bf16 a[200:203], v[40:43], v[192:195], a[200:203]
    s_waitcnt lgkmcnt(4)
    v_mfma_f32_16x16x32_bf16 a[32:35], v[44:47], a[128:131], a[32:35]
    ds_read_b64_tr_b16 v[56:57], v9 offset:16640
    v_mfma_f32_16x16x32_bf16 a[36:39], v[44:47], a[132:135], a[36:39]
    ds_read_b64_tr_b16 v[58:59], v9 offset:17664
    v_mfma_f32_16x16x32_bf16 a[40:43], v[44:47], a[136:139], a[40:43]
    v_mfma_f32_16x16x32_bf16 a[44:47], v[44:47], a[140:143], a[44:47]
    s_add_u32 s49, s47, 32768
    s_cmp_eq_u32 s49, 131072
    s_cselect_b32 s62, 0, s49
    s_sub_u32 s49, s62, s47
    s_mov_b32 s47, s62
    v_mfma_f32_16x16x32_bf16 a[48:51], v[44:47], a[144:147], a[48:51]
    v_mfma_f32_16x16x32_bf16 a[52:55], v[44:47], a[148:151], a[52:55]
    s_add_u32 m0, s48, s39
    v_mfma_f32_16x16x32_bf16 a[56:59], v[44:47], a[152:155], a[56:59]
    buffer_load_dwordx4 v15, s[8:11], s33 offen lds
    v_mfma_f32_16x16x32_bf16 a[60:63], v[44:47], a[156:159], a[60:63]
    v_mfma_f32_16x16x32_bf16 a[204:207], v[44:47], v[192:195], a[204:207]
    s_waitcnt lgkmcnt(4)
    v_mfma_f32_16x16x32_bf16 v[128:131], v[48:51], a[128:131], v[128:131]
    ds_read_b64_tr_b16 v[60:61], v9 offset:24832
    v_mfma_f32_16x16x32_bf16 v[132:135], v[48:51], a[132:135], v[132:135]
    ds_read_b64_tr_b16 v[62:63], v9 offset:25856
    v_mfma_f32_16x16x32_bf16 v[136:139], v[48:51], a[136:139], v[136:139]
    v_add_u32 v8, s49, v8
    v_mfma_f32_16x16x32_bf16 v[140:143], v[48:51], a[140:143], v[140:143]
    v_add_u32 v9, s49, v9
    v_mfma_f32_16x16x32_bf16 v[144:147], v[48:51], a[144:147], v[144:147]
    v_add_u32 v10, s49, v10
    v_mfma_f32_16x16x32_bf16 v[148:151], v[48:51], a[148:151], v[148:151]
    s_add_u32 m0, s48, s40
    v_mfma_f32_16x16x32_bf16 v[152:155], v[48:51], a[152:155], v[152:155]
    buffer_load_dwordx4 v16, s[12:15], s34 offen lds
    v_mfma_f32_16x16x32_bf16 v[156:159], v[48:51], a[156:159], v[156:159]
    s_waitcnt lgkmcnt(4)
    v_mfma_f32_16x16x32_bf16 a[64:67], v[52:55], a[128:131], a[64:67]
    ds_read_b64_tr_b16 v[32:33], v8 offset:16384
    v_mfma_f32_16x16x32_bf16 a[68:71], v[52:55], a[132:135], a[68:71]
    ds_read_b64_tr_b16 v[34:35], v8 offset:17408
    v_mfma_f32_16x16x32_bf16 a[72:75], v[52:55], a[136:139], a[72:75]
    ds_read_b128 a[160:163], v10 offset:0
    v_mfma_f32_16x16x32_bf16 a[76:79], v[52:55], a[140:143], a[76:79]
    ds_read_b128 a[164:167], v10 offset:1024
    v_mfma_f32_16x16x32_bf16 a[80:83], v[52:55], a[144:147], a[80:83]
    ds_read_b128 a[168:171], v10 offset:2048
    v_mfma_f32_16x16x32_bf16 a[84:87], v[52:55], a[148:151], a[84:87]
    s_add_u32 m0, s48, s41
    v_mfma_f32_16x16x32_bf16 a[88:91], v[52:55], a[152:155], a[88:91]
    buffer_load_dwordx4 v17, s[12:15], s34 offen lds
    v_mfma_f32_16x16x32_bf16 a[92:95], v[52:55], a[156:159], a[92:95]
    s_waitcnt lgkmcnt(7)
    v_mfma_f32_16x16x32_bf16 v[160:163], v[56:59], a[128:131], v[160:163]
    ds_read_b64_tr_b16 v[36:37], v8 offset:24576
    v_mfma_f32_16x16x32_bf16 v[164:167], v[56:59], a[132:135], v[164:167]
    ds_read_b64_tr_b16 v[38:39], v8 offset:25600
    v_mfma_f32_16x16x32_bf16 v[168:171], v[56:59], a[136:139], v[168:171]
    ds_read_b128 a[172:175], v10 offset:3072
    v_mfma_f32_16x16x32_bf16 v[172:175], v[56:59], a[140:143], v[172:175]
    ds_read_b128 a[176:179], v10 offset:4096
    v_mfma_f32_16x16x32_bf16 v[176:179], v[56:59], a[144:147], v[176:179]
    ds_read_b128 a[180:183], v10 offset:5120
    v_mfma_f32_16x16x32_bf16 v[180:183], v[56:59], a[148:151], v[180:183]
    s_add_u32 m0, s48, s42
    v_mfma_f32_16x16x32_bf16 v[184:187], v[56:59], a[152:155], v[184:187]
    buffer_load_dwordx4 v18, s[12:15], s34 offen lds
    v_mfma_f32_16x16x32_bf16 v[188:191], v[56:59], a[156:159], v[188:191]
    s_waitcnt lgkmcnt(10)
    v_mfma_f32_16x16x32_bf16 a[96:99], v[60:63], a[128:131], a[96:99]
    ds_read_b64_tr_b16 v[40:41], v9 offset:16384
    v_mfma_f32_16x16x32_bf16 a[100:103], v[60:63], a[132:135], a[100:103]
    ds_read_b64_tr_b16 v[42:43], v9 offset:17408
    v_mfma_f32_16x16x32_bf16 a[104:107], v[60:63], a[136:139], a[104:107]
    ds_read_b128 a[184:187], v10 offset:6144
    v_mfma_f32_16x16x32_bf16 a[108:111], v[60:63], a[140:143], a[108:111]
    ds_read_b128 a[188:191], v10 offset:7168
    v_mfma_f32_16x16x32_bf16 a[112:115], v[60:63], a[144:147], a[112:115]
    v_mfma_f32_16x16x32_bf16 a[116:119], v[60:63], a[148:151], a[116:119]
    s_add_u32 m0, s48, s43
    v_mfma_f32_16x16x32_bf16 a[120:123], v[60:63], a[152:155], a[120:123]
    buffer_load_dwordx4 v19, s[12:15], s34 offen lds
    buffer_load_dword v25, v23, s[16:19], s24 offen
    v_mfma_f32_16x16x32_bf16 a[124:127], v[60:63], a[156:159], a[124:127]
    s_add_u32 s33, s33, 64
    s_add_u32 s34, s34, 229376
    s_add_u32 s48, s48, 32768
    s_cmp_eq_u32 s48, 131072
    s_cselect_b32 s48, 0, s48
    s_waitcnt vmcnt(10)
    s_barrier
    s_waitcnt lgkmcnt(0)
    v_mfma_f32_16x16x32_bf16 v[64:67], v[32:35], a[160:163], v[64:67]
    ds_read_b64_tr_b16 v[44:45], v9 offset:24576
    v_mfma_f32_16x16x32_bf16 v[68:71], v[32:35], a[164:167], v[68:71]
    ds_read_b64_tr_b16 v[46:47], v9 offset:25600
    v_mfma_f32_16x16x32_bf16 v[72:75], v[32:35], a[168:171], v[72:75]
    v_mfma_f32_16x16x32_bf16 v[76:79], v[32:35], a[172:175], v[76:79]
    v_mfma_f32_16x16x32_bf16 v[80:83], v[32:35], a[176:179], v[80:83]
    v_mfma_f32_16x16x32_bf16 v[84:87], v[32:35], a[180:183], v[84:87]
    s_add_u32 m0, s48, s36
    v_mfma_f32_16x16x32_bf16 v[88:91], v[32:35], a[184:187], v[88:91]
    buffer_load_dwordx4 v12, s[8:11], s33 offen lds
    v_mfma_f32_16x16x32_bf16 v[92:95], v[32:35], a[188:191], v[92:95]
    v_mfma_f32_16x16x32_bf16 a[192:195], v[32:35], v[192:195], a[192:195]
    v_mfma_f32_16x16x32_bf16 a[0:3], v[36:39], a[160:163], a[0:3]
    ds_read_b64_tr_b16 v[48:49], v8 offset:16640
    v_mfma_f32_16x16x32_bf16 a[4:7], v[36:39], a[164:167], a[4:7]
    ds_read_b64_tr_b16 v[50:51], v8 offset:17664
    v_mfma_f32_16x16x32_bf16 a[8:11], v[36:39], a[168:171], a[8:11]
    v_mfma_f32_16x16x32_bf16 a[12:15], v[36:39], a[172:175], a[12:15]
    v_mfma_f32_16x16x32_bf16 a[16:19], v[36:39], a[176:179], a[16:19]
    v_mfma_f32_16x16x32_bf16 a[20:23], v[36:39], a[180:183], a[20:23]
    s_add_u32 m0, s48, s37
    v_mfma_f32_16x16x32_bf16 a[24:27], v[36:39], a[184:187], a[24:27]
    buffer_load_dwordx4 v13, s[8:11], s33 offen lds
    v_mfma_f32_16x16x32_bf16 a[28:31], v[36:39], a[188:191], a[28:31]
    v_mfma_f32_16x16x32_bf16 a[196:199], v[36:39], v[192:195], a[196:199]
    v_mfma_f32_16x16x32_bf16 v[96:99], v[40:43], a[160:163], v[96:99]
    ds_read_b64_tr_b16 v[52:53], v8 offset:24832
    v_mfma_f32_16x16x32_bf16 v[100:103], v[40:43], a[164:167], v[100:103]
    ds_read_b64_tr_b16 v[54:55], v8 offset:25856
    v_mfma_f32_16x16x32_bf16 v[104:107], v[40:43], a[168:171], v[104:107]
    v_mfma_f32_16x16x32_bf16 v[108:111], v[40:43], a[172:175], v[108:111]
    v_mfma_f32_16x16x32_bf16 v[112:115], v[40:43], a[176:179], v[112:115]
    v_mfma_f32_16x16x32_bf16 v[116:119], v[40:43], a[180:183], v[116:119]
    s_add_u32 m0, s48, s38
    v_mfma_f32_16x16x32_bf16 v[120:123], v[40:43], a[184:187], v[120:123]
    buffer_load_dwordx4 v14, s[8:11], s33 offen lds
    v_mfma_f32_16x16x32_bf16 v[124:127], v[40:43], a[188:191], v[124:127]
    v_mfma_f32_16x16x32_bf16 a[200:203], v[40:43], v[192:195], a[200:203]
    s_waitcnt lgkmcnt(4)
    v_mfma_f32_16x16x32_bf16 a[32:35], v[44:47], a[160:163], a[32:35]
    ds_read_b64_tr_b16 v[56:57], v9 offset:16640
    v_mfma_f32_16x16x32_bf16 a[36:39], v[44:47], a[164:167], a[36:39]
    ds_read_b64_tr_b16 v[58:59], v9 offset:17664
    v_mfma_f32_16x16x32_bf16 a[40:43], v[44:47], a[168:171], a[40:43]
    v_mfma_f32_16x16x32_bf16 a[44:47], v[44:47], a[172:175], a[44:47]
    s_add_u32 s49, s47, 32768
    s_cmp_eq_u32 s49, 131072
    s_cselect_b32 s62, 0, s49
    s_sub_u32 s49, s62, s47
    s_mov_b32 s47, s62
    v_mfma_f32_16x16x32_bf16 a[48:51], v[44:47], a[176:179], a[48:51]
    v_mfma_f32_16x16x32_bf16 a[52:55], v[44:47], a[180:183], a[52:55]
    s_add_u32 m0, s48, s39
    v_mfma_f32_16x16x32_bf16 a[56:59], v[44:47], a[184:187], a[56:59]
    buffer_load_dwordx4 v15, s[8:11], s33 offen lds
    v_mfma_f32_16x16x32_bf16 a[60:63], v[44:47], a[188:191], a[60:63]
    v_mfma_f32_16x16x32_bf16 a[204:207], v[44:47], v[192:195], a[204:207]
    s_waitcnt lgkmcnt(4)
    v_mfma_f32_16x16x32_bf16 v[128:131], v[48:51], a[160:163], v[128:131]
    ds_read_b64_tr_b16 v[60:61], v9 offset:24832
    v_mfma_f32_16x16x32_bf16 v[132:135], v[48:51], a[164:167], v[132:135]
    ds_read_b64_tr_b16 v[62:63], v9 offset:25856
    v_mfma_f32_16x16x32_bf16 v[136:139], v[48:51], a[168:171], v[136:139]
    v_add_u32 v8, s49, v8
    v_mfma_f32_16x16x32_bf16 v[140:143], v[48:51], a[172:175], v[140:143]
    v_add_u32 v9, s49, v9
    v_mfma_f32_16x16x32_bf16 v[144:147], v[48:51], a[176:179], v[144:147]
    v_add_u32 v10, s49, v10
    v_mfma_f32_16x16x32_bf16 v[148:151], v[48:51], a[180:183], v[148:151]
    s_add_u32 m0, s48, s40
    v_mfma_f32_16x16x32_bf16 v[152:155], v[48:51], a[184:187], v[152:155]
    buffer_load_dwordx4 v16, s[12:15], s34 offen lds
    v_mfma_f32_16x16x32_bf16 v[156:159], v[48:51], a[188:191], v[156:159]
    s_waitcnt lgkmcnt(4)
    v_mfma_f32_16x16x32_bf16 a[64:67], v[52:55], a[160:163], a[64:67]
    ds_read_b64_tr_b16 v[32:33], v8 offset:16384
    v_mfma_f32_16x16x32_bf16 a[68:71], v[52:55], a[164:167], a[68:71]
    ds_read_b64_tr_b16 v[34:35], v8 offset:17408
    v_mfma_f32_16x16x32_bf16 a[72:75], v[52:55], a[168:171], a[72:75]
    ds_read_b128 a[128:131], v10 offset:0
    v_mfma_f32_16x16x32_bf16 a[76:79], v[52:55], a[172:175], a[76:79]
    ds_read_b128 a[132:135], v10 offset:1024
    v_mfma_f32_16x16x32_bf16 a[80:83], v[52:55], a[176:179], a[80:83]
    ds_read_b128 a[136:139], v10 offset:2048
    v_mfma_f32_16x16x32_bf16 a[84:87], v[52:55], a[180:183], a[84:87]
    s_add_u32 m0, s48, s41
    v_mfma_f32_16x16x32_bf16 a[88:91], v[52:55], a[184:187], a[88:91]
    buffer_load_dwordx4 v17, s[12:15], s34 offen lds
    v_mfma_f32_16x16x32_bf16 a[92:95], v[52:55], a[188:191], a[92:95]
    s_waitcnt lgkmcnt(7)
    v_mfma_f32_16x16x32_bf16 v[160:163], v[56:59], a[160:163], v[160:163]
    ds_read_b64_tr_b16 v[36:37], v8 offset:24576
    v_mfma_f32_16x16x32_bf16 v[164:167], v[56:59], a[164:167], v[164:167]
    ds_read_b64_tr_b16 v[38:39], v8 offset:25600
    v_mfma_f32_16x16x32_bf16 v[168:171], v[56:59], a[168:171], v[168:171]
    ds_read_b128 a[140:143], v10 offset:3072
    v_mfma_f32_16x16x32_bf16 v[172:175], v[56:59], a[172:175], v[172:175]
    ds_read_b128 a[144:147], v10 offset:4096
    v_mfma_f32_16x16x32_bf16 v[176:179], v[56:59], a[176:179], v[176:179]
    ds_read_b128 a[148:151], v10 offset:5120
    v_mfma_f32_16x16x32_bf16 v[180:183], v[56:59], a[180:183], v[180:183]
    s_add_u32 m0, s48, s42
    v_mfma_f32_16x16x32_bf16 v[184:187], v[56:59], a[184:187], v[184:187]
    buffer_load_dwordx4 v18, s[12:15], s34 offen lds
    v_mfma_f32_16x16x32_bf16 v[188:191], v[56:59], a[188:191], v[188:191]
    s_waitcnt lgkmcnt(10)
    v_mfma_f32_16x16x32_bf16 a[96:99], v[60:63], a[160:163], a[96:99]
    ds_read_b64_tr_b16 v[40:41], v9 offset:16384
    v_mfma_f32_16x16x32_bf16 a[100:103], v[60:63], a[164:167], a[100:103]
    ds_read_b64_tr_b16 v[42:43], v9 offset:17408
    v_mfma_f32_16x16x32_bf16 a[104:107], v[60:63], a[168:171], a[104:107]
    ds_read_b128 a[152:155], v10 offset:6144
    v_mfma_f32_16x16x32_bf16 a[108:111], v[60:63], a[172:175], a[108:111]
    ds_read_b128 a[156:159], v10 offset:7168
    v_mfma_f32_16x16x32_bf16 a[112:115], v[60:63], a[176:179], a[112:115]
    v_mfma_f32_16x16x32_bf16 a[116:119], v[60:63], a[180:183], a[116:119]
    s_add_u32 m0, s48, s43
    v_mfma_f32_16x16x32_bf16 a[120:123], v[60:63], a[184:187], a[120:123]
    buffer_load_dwordx4 v19, s[12:15], s34 offen lds
    buffer_load_dword v25, v23, s[20:23], s24 offen
    v_mfma_f32_16x16x32_bf16 a[124:127], v[60:63], a[188:191], a[124:127]
    s_add_u32 s33, s33, 64
    s_add_u32 s34, s34, 229376
    s_add_u32 s48, s48, 32768
    s_cmp_eq_u32 s48, 131072
    s_cselect_b32 s48, 0, s48
    s_add_u32 s24, s24, 458752
    s_sub_u32 s35, s35, 1
    s_cmp_lg_u32 s35, 0
    s_cbranch_scc1 k1_kernel_p0_loop
    v_lshrrev_b32 v3, 4, v2
    v_lshlrev_b32 v3, 4, v3
    s_and_b32 s60, s32, 1
    s_lshl_b32 s60, s60, 9
    s_add_u32 s60, s60, 131072
    v_add_u32 v3, s60, v3
    s_nop 7
    s_mov_b32 s60, 0x00010001
    s_mov_b32 s61, 0x00010001
    s_mov_b64 exec, s[60:61]
    ds_write_b128 v3, a[192:195] offset:0
    ds_write_b128 v3, a[196:199] offset:64
    ds_write_b128 v3, a[200:203] offset:128
    ds_write_b128 v3, a[204:207] offset:192
    s_mov_b64 exec, -1
    s_branch k1_kernel_epi
k1_kernel_p1:
    s_waitcnt vmcnt(26)
    s_barrier
    ds_read_b64_tr_b16 v[32:33], v8 offset:16384
    ds_read_b64_tr_b16 v[34:35], v8 offset:17408
    ds_read_b64_tr_b16 v[36:37], v8 offset:24576
    ds_read_b64_tr_b16 v[38:39], v8 offset:25600
    ds_read_b64_tr_b16 v[40:41], v9 offset:16384
    ds_read_b64_tr_b16 v[42:43], v9 offset:17408
    ds_read_b128 a[128:131], v10 offset:0
    ds_read_b128 a[132:135], v10 offset:1024
    ds_read_b128 a[136:139], v10 offset:2048
    ds_read_b128 a[140:143], v10 offset:3072
    ds_read_b128 a[144:147], v10 offset:4096
    ds_read_b128 a[148:151], v10 offset:5120
    ds_read_b128 a[152:155], v10 offset:6144
    ds_read_b128 a[156:159], v10 offset:7168
    s_waitcnt lgkmcnt(0)
    s_waitcnt vmcnt(18)
    s_barrier
    s_waitcnt lgkmcnt(0)
    v_mfma_f32_16x16x32_bf16 v[64:67], v[32:35], a[128:131], 0
    ds_read_b64_tr_b16 v[44:45], v9 offset:24576
    v_mfma_f32_16x16x32_bf16 v[68:71], v[32:35], a[132:135], 0
    ds_read_b64_tr_b16 v[46:47], v9 offset:25600
    v_mfma_f32_16x16x32_bf16 v[72:75], v[32:35], a[136:139], 0
    v_mfma_f32_16x16x32_bf16 v[76:79], v[32:35], a[140:143], 0
    v_mfma_f32_16x16x32_bf16 v[80:83], v[32:35], a[144:147], 0
    v_mfma_f32_16x16x32_bf16 v[84:87], v[32:35], a[148:151], 0
    s_add_u32 m0, s48, s36
    v_mfma_f32_16x16x32_bf16 v[88:91], v[32:35], a[152:155], 0
    buffer_load_dwordx4 v12, s[8:11], s33 offen lds
    v_mfma_f32_16x16x32_bf16 v[92:95], v[32:35], a[156:159], 0
    v_mfma_f32_16x16x32_bf16 a[0:3], v[36:39], a[128:131], 0
    ds_read_b64_tr_b16 v[48:49], v8 offset:16640
    v_mfma_f32_16x16x32_bf16 a[4:7], v[36:39], a[132:135], 0
    ds_read_b64_tr_b16 v[50:51], v8 offset:17664
    v_mfma_f32_16x16x32_bf16 a[8:11], v[36:39], a[136:139], 0
    v_mfma_f32_16x16x32_bf16 a[12:15], v[36:39], a[140:143], 0
    v_mfma_f32_16x16x32_bf16 a[16:19], v[36:39], a[144:147], 0
    v_mfma_f32_16x16x32_bf16 a[20:23], v[36:39], a[148:151], 0
    s_add_u32 m0, s48, s37
    v_mfma_f32_16x16x32_bf16 a[24:27], v[36:39], a[152:155], 0
    buffer_load_dwordx4 v13, s[8:11], s33 offen lds
    v_mfma_f32_16x16x32_bf16 a[28:31], v[36:39], a[156:159], 0
    v_mfma_f32_16x16x32_bf16 v[96:99], v[40:43], a[128:131], 0
    ds_read_b64_tr_b16 v[52:53], v8 offset:24832
    v_mfma_f32_16x16x32_bf16 v[100:103], v[40:43], a[132:135], 0
    ds_read_b64_tr_b16 v[54:55], v8 offset:25856
    v_mfma_f32_16x16x32_bf16 v[104:107], v[40:43], a[136:139], 0
    v_mfma_f32_16x16x32_bf16 v[108:111], v[40:43], a[140:143], 0
    v_mfma_f32_16x16x32_bf16 v[112:115], v[40:43], a[144:147], 0
    v_mfma_f32_16x16x32_bf16 v[116:119], v[40:43], a[148:151], 0
    s_add_u32 m0, s48, s38
    v_mfma_f32_16x16x32_bf16 v[120:123], v[40:43], a[152:155], 0
    buffer_load_dwordx4 v14, s[8:11], s33 offen lds
    v_mfma_f32_16x16x32_bf16 v[124:127], v[40:43], a[156:159], 0
    s_waitcnt lgkmcnt(4)
    v_mfma_f32_16x16x32_bf16 a[32:35], v[44:47], a[128:131], 0
    ds_read_b64_tr_b16 v[56:57], v9 offset:16640
    v_mfma_f32_16x16x32_bf16 a[36:39], v[44:47], a[132:135], 0
    ds_read_b64_tr_b16 v[58:59], v9 offset:17664
    v_mfma_f32_16x16x32_bf16 a[40:43], v[44:47], a[136:139], 0
    v_mfma_f32_16x16x32_bf16 a[44:47], v[44:47], a[140:143], 0
    s_add_u32 s49, s47, 32768
    s_cmp_eq_u32 s49, 131072
    s_cselect_b32 s62, 0, s49
    s_sub_u32 s49, s62, s47
    s_mov_b32 s47, s62
    v_mfma_f32_16x16x32_bf16 a[48:51], v[44:47], a[144:147], 0
    v_mfma_f32_16x16x32_bf16 a[52:55], v[44:47], a[148:151], 0
    s_add_u32 m0, s48, s39
    v_mfma_f32_16x16x32_bf16 a[56:59], v[44:47], a[152:155], 0
    buffer_load_dwordx4 v15, s[8:11], s33 offen lds
    v_mfma_f32_16x16x32_bf16 a[60:63], v[44:47], a[156:159], 0
    s_waitcnt lgkmcnt(4)
    v_mfma_f32_16x16x32_bf16 v[128:131], v[48:51], a[128:131], 0
    ds_read_b64_tr_b16 v[60:61], v9 offset:24832
    v_mfma_f32_16x16x32_bf16 v[132:135], v[48:51], a[132:135], 0
    ds_read_b64_tr_b16 v[62:63], v9 offset:25856
    v_mfma_f32_16x16x32_bf16 v[136:139], v[48:51], a[136:139], 0
    v_add_u32 v8, s49, v8
    v_mfma_f32_16x16x32_bf16 v[140:143], v[48:51], a[140:143], 0
    v_add_u32 v9, s49, v9
    v_mfma_f32_16x16x32_bf16 v[144:147], v[48:51], a[144:147], 0
    v_add_u32 v10, s49, v10
    v_mfma_f32_16x16x32_bf16 v[148:151], v[48:51], a[148:151], 0
    s_add_u32 m0, s48, s40
    v_mfma_f32_16x16x32_bf16 v[152:155], v[48:51], a[152:155], 0
    buffer_load_dwordx4 v16, s[12:15], s34 offen lds
    v_mfma_f32_16x16x32_bf16 v[156:159], v[48:51], a[156:159], 0
    v_mfma_f32_16x16x32_bf16 a[192:195], v[48:51], v[192:195], 0
    s_waitcnt lgkmcnt(4)
    v_mfma_f32_16x16x32_bf16 a[64:67], v[52:55], a[128:131], 0
    ds_read_b64_tr_b16 v[32:33], v8 offset:16384
    v_mfma_f32_16x16x32_bf16 a[68:71], v[52:55], a[132:135], 0
    ds_read_b64_tr_b16 v[34:35], v8 offset:17408
    v_mfma_f32_16x16x32_bf16 a[72:75], v[52:55], a[136:139], 0
    ds_read_b128 a[160:163], v10 offset:0
    v_mfma_f32_16x16x32_bf16 a[76:79], v[52:55], a[140:143], 0
    ds_read_b128 a[164:167], v10 offset:1024
    v_mfma_f32_16x16x32_bf16 a[80:83], v[52:55], a[144:147], 0
    ds_read_b128 a[168:171], v10 offset:2048
    v_mfma_f32_16x16x32_bf16 a[84:87], v[52:55], a[148:151], 0
    s_add_u32 m0, s48, s41
    v_mfma_f32_16x16x32_bf16 a[88:91], v[52:55], a[152:155], 0
    buffer_load_dwordx4 v17, s[12:15], s34 offen lds
    v_mfma_f32_16x16x32_bf16 a[92:95], v[52:55], a[156:159], 0
    v_mfma_f32_16x16x32_bf16 a[196:199], v[52:55], v[192:195], 0
    s_waitcnt lgkmcnt(7)
    v_mfma_f32_16x16x32_bf16 v[160:163], v[56:59], a[128:131], 0
    ds_read_b64_tr_b16 v[36:37], v8 offset:24576
    v_mfma_f32_16x16x32_bf16 v[164:167], v[56:59], a[132:135], 0
    ds_read_b64_tr_b16 v[38:39], v8 offset:25600
    v_mfma_f32_16x16x32_bf16 v[168:171], v[56:59], a[136:139], 0
    ds_read_b128 a[172:175], v10 offset:3072
    v_mfma_f32_16x16x32_bf16 v[172:175], v[56:59], a[140:143], 0
    ds_read_b128 a[176:179], v10 offset:4096
    v_mfma_f32_16x16x32_bf16 v[176:179], v[56:59], a[144:147], 0
    ds_read_b128 a[180:183], v10 offset:5120
    v_mfma_f32_16x16x32_bf16 v[180:183], v[56:59], a[148:151], 0
    s_add_u32 m0, s48, s42
    v_mfma_f32_16x16x32_bf16 v[184:187], v[56:59], a[152:155], 0
    buffer_load_dwordx4 v18, s[12:15], s34 offen lds
    v_mfma_f32_16x16x32_bf16 v[188:191], v[56:59], a[156:159], 0
    v_mfma_f32_16x16x32_bf16 a[200:203], v[56:59], v[192:195], 0
    s_waitcnt lgkmcnt(10)
    v_mfma_f32_16x16x32_bf16 a[96:99], v[60:63], a[128:131], 0
    ds_read_b64_tr_b16 v[40:41], v9 offset:16384
    v_mfma_f32_16x16x32_bf16 a[100:103], v[60:63], a[132:135], 0
    ds_read_b64_tr_b16 v[42:43], v9 offset:17408
    v_mfma_f32_16x16x32_bf16 a[104:107], v[60:63], a[136:139], 0
    ds_read_b128 a[184:187], v10 offset:6144
    v_mfma_f32_16x16x32_bf16 a[108:111], v[60:63], a[140:143], 0
    ds_read_b128 a[188:191], v10 offset:7168
    v_mfma_f32_16x16x32_bf16 a[112:115], v[60:63], a[144:147], 0
    v_mfma_f32_16x16x32_bf16 a[116:119], v[60:63], a[148:151], 0
    s_add_u32 m0, s48, s43
    v_mfma_f32_16x16x32_bf16 a[120:123], v[60:63], a[152:155], 0
    buffer_load_dwordx4 v19, s[12:15], s34 offen lds
    buffer_load_dword v25, v23, s[16:19], s24 offen
    v_mfma_f32_16x16x32_bf16 a[124:127], v[60:63], a[156:159], 0
    v_mfma_f32_16x16x32_bf16 a[204:207], v[60:63], v[192:195], 0
    s_add_u32 s33, s33, 64
    s_add_u32 s34, s34, 229376
    s_add_u32 s48, s48, 32768
    s_cmp_eq_u32 s48, 131072
    s_cselect_b32 s48, 0, s48
    s_waitcnt vmcnt(19)
    s_barrier
    s_waitcnt lgkmcnt(0)
    v_mfma_f32_16x16x32_bf16 v[64:67], v[32:35], a[160:163], v[64:67]
    ds_read_b64_tr_b16 v[44:45], v9 offset:24576
    v_mfma_f32_16x16x32_bf16 v[68:71], v[32:35], a[164:167], v[68:71]
    ds_read_b64_tr_b16 v[46:47], v9 offset:25600
    v_mfma_f32_16x16x32_bf16 v[72:75], v[32:35], a[168:171], v[72:75]
    v_mfma_f32_16x16x32_bf16 v[76:79], v[32:35], a[172:175], v[76:79]
    v_mfma_f32_16x16x32_bf16 v[80:83], v[32:35], a[176:179], v[80:83]
    v_mfma_f32_16x16x32_bf16 v[84:87], v[32:35], a[180:183], v[84:87]
    s_add_u32 m0, s48, s36
    v_mfma_f32_16x16x32_bf16 v[88:91], v[32:35], a[184:187], v[88:91]
    buffer_load_dwordx4 v12, s[8:11], s33 offen lds
    v_mfma_f32_16x16x32_bf16 v[92:95], v[32:35], a[188:191], v[92:95]
    v_mfma_f32_16x16x32_bf16 a[0:3], v[36:39], a[160:163], a[0:3]
    ds_read_b64_tr_b16 v[48:49], v8 offset:16640
    v_mfma_f32_16x16x32_bf16 a[4:7], v[36:39], a[164:167], a[4:7]
    ds_read_b64_tr_b16 v[50:51], v8 offset:17664
    v_mfma_f32_16x16x32_bf16 a[8:11], v[36:39], a[168:171], a[8:11]
    v_mfma_f32_16x16x32_bf16 a[12:15], v[36:39], a[172:175], a[12:15]
    v_mfma_f32_16x16x32_bf16 a[16:19], v[36:39], a[176:179], a[16:19]
    v_mfma_f32_16x16x32_bf16 a[20:23], v[36:39], a[180:183], a[20:23]
    s_add_u32 m0, s48, s37
    v_mfma_f32_16x16x32_bf16 a[24:27], v[36:39], a[184:187], a[24:27]
    buffer_load_dwordx4 v13, s[8:11], s33 offen lds
    v_mfma_f32_16x16x32_bf16 a[28:31], v[36:39], a[188:191], a[28:31]
    v_mfma_f32_16x16x32_bf16 v[96:99], v[40:43], a[160:163], v[96:99]
    ds_read_b64_tr_b16 v[52:53], v8 offset:24832
    v_mfma_f32_16x16x32_bf16 v[100:103], v[40:43], a[164:167], v[100:103]
    ds_read_b64_tr_b16 v[54:55], v8 offset:25856
    v_mfma_f32_16x16x32_bf16 v[104:107], v[40:43], a[168:171], v[104:107]
    v_mfma_f32_16x16x32_bf16 v[108:111], v[40:43], a[172:175], v[108:111]
    v_mfma_f32_16x16x32_bf16 v[112:115], v[40:43], a[176:179], v[112:115]
    v_mfma_f32_16x16x32_bf16 v[116:119], v[40:43], a[180:183], v[116:119]
    s_add_u32 m0, s48, s38
    v_mfma_f32_16x16x32_bf16 v[120:123], v[40:43], a[184:187], v[120:123]
    buffer_load_dwordx4 v14, s[8:11], s33 offen lds
    v_mfma_f32_16x16x32_bf16 v[124:127], v[40:43], a[188:191], v[124:127]
    s_waitcnt lgkmcnt(4)
    v_mfma_f32_16x16x32_bf16 a[32:35], v[44:47], a[160:163], a[32:35]
    ds_read_b64_tr_b16 v[56:57], v9 offset:16640
    v_mfma_f32_16x16x32_bf16 a[36:39], v[44:47], a[164:167], a[36:39]
    ds_read_b64_tr_b16 v[58:59], v9 offset:17664
    v_mfma_f32_16x16x32_bf16 a[40:43], v[44:47], a[168:171], a[40:43]
    v_mfma_f32_16x16x32_bf16 a[44:47], v[44:47], a[172:175], a[44:47]
    s_add_u32 s49, s47, 32768
    s_cmp_eq_u32 s49, 131072
    s_cselect_b32 s62, 0, s49
    s_sub_u32 s49, s62, s47
    s_mov_b32 s47, s62
    v_mfma_f32_16x16x32_bf16 a[48:51], v[44:47], a[176:179], a[48:51]
    v_mfma_f32_16x16x32_bf16 a[52:55], v[44:47], a[180:183], a[52:55]
    s_add_u32 m0, s48, s39
    v_mfma_f32_16x16x32_bf16 a[56:59], v[44:47], a[184:187], a[56:59]
    buffer_load_dwordx4 v15, s[8:11], s33 offen lds
    v_mfma_f32_16x16x32_bf16 a[60:63], v[44:47], a[188:191], a[60:63]
    s_waitcnt lgkmcnt(4)
    v_mfma_f32_16x16x32_bf16 v[128:131], v[48:51], a[160:163], v[128:131]
    ds_read_b64_tr_b16 v[60:61], v9 offset:24832
    v_mfma_f32_16x16x32_bf16 v[132:135], v[48:51], a[164:167], v[132:135]
    ds_read_b64_tr_b16 v[62:63], v9 offset:25856
    v_mfma_f32_16x16x32_bf16 v[136:139], v[48:51], a[168:171], v[136:139]
    v_add_u32 v8, s49, v8
    v_mfma_f32_16x16x32_bf16 v[140:143], v[48:51], a[172:175], v[140:143]
    v_add_u32 v9, s49, v9
    v_mfma_f32_16x16x32_bf16 v[144:147], v[48:51], a[176:179], v[144:147]
    v_add_u32 v10, s49, v10
    v_mfma_f32_16x16x32_bf16 v[148:151], v[48:51], a[180:183], v[148:151]
    s_add_u32 m0, s48, s40
    v_mfma_f32_16x16x32_bf16 v[152:155], v[48:51], a[184:187], v[152:155]
    buffer_load_dwordx4 v16, s[12:15], s34 offen lds
    v_mfma_f32_16x16x32_bf16 v[156:159], v[48:51], a[188:191], v[156:159]
    v_mfma_f32_16x16x32_bf16 a[192:195], v[48:51], v[192:195], a[192:195]
    s_waitcnt lgkmcnt(4)
    v_mfma_f32_16x16x32_bf16 a[64:67], v[52:55], a[160:163], a[64:67]
    ds_read_b64_tr_b16 v[32:33], v8 offset:16384
    v_mfma_f32_16x16x32_bf16 a[68:71], v[52:55], a[164:167], a[68:71]
    ds_read_b64_tr_b16 v[34:35], v8 offset:17408
    v_mfma_f32_16x16x32_bf16 a[72:75], v[52:55], a[168:171], a[72:75]
    ds_read_b128 a[128:131], v10 offset:0
    v_mfma_f32_16x16x32_bf16 a[76:79], v[52:55], a[172:175], a[76:79]
    ds_read_b128 a[132:135], v10 offset:1024
    v_mfma_f32_16x16x32_bf16 a[80:83], v[52:55], a[176:179], a[80:83]
    ds_read_b128 a[136:139], v10 offset:2048
    v_mfma_f32_16x16x32_bf16 a[84:87], v[52:55], a[180:183], a[84:87]
    s_add_u32 m0, s48, s41
    v_mfma_f32_16x16x32_bf16 a[88:91], v[52:55], a[184:187], a[88:91]
    buffer_load_dwordx4 v17, s[12:15], s34 offen lds
    v_mfma_f32_16x16x32_bf16 a[92:95], v[52:55], a[188:191], a[92:95]
    v_mfma_f32_16x16x32_bf16 a[196:199], v[52:55], v[192:195], a[196:199]
    s_waitcnt lgkmcnt(7)
    v_mfma_f32_16x16x32_bf16 v[160:163], v[56:59], a[160:163], v[160:163]
    ds_read_b64_tr_b16 v[36:37], v8 offset:24576
    v_mfma_f32_16x16x32_bf16 v[164:167], v[56:59], a[164:167], v[164:167]
    ds_read_b64_tr_b16 v[38:39], v8 offset:25600
    v_mfma_f32_16x16x32_bf16 v[168:171], v[56:59], a[168:171], v[168:171]
    ds_read_b128 a[140:143], v10 offset:3072
    v_mfma_f32_16x16x32_bf16 v[172:175], v[56:59], a[172:175], v[172:175]
    ds_read_b128 a[144:147], v10 offset:4096
    v_mfma_f32_16x16x32_bf16 v[176:179], v[56:59], a[176:179], v[176:179]
    ds_read_b128 a[148:151], v10 offset:5120
    v_mfma_f32_16x16x32_bf16 v[180:183], v[56:59], a[180:183], v[180:183]
    s_add_u32 m0, s48, s42
    v_mfma_f32_16x16x32_bf16 v[184:187], v[56:59], a[184:187], v[184:187]
    buffer_load_dwordx4 v18, s[12:15], s34 offen lds
    v_mfma_f32_16x16x32_bf16 v[188:191], v[56:59], a[188:191], v[188:191]
    v_mfma_f32_16x16x32_bf16 a[200:203], v[56:59], v[192:195], a[200:203]
    s_waitcnt lgkmcnt(10)
    v_mfma_f32_16x16x32_bf16 a[96:99], v[60:63], a[160:163], a[96:99]
    ds_read_b64_tr_b16 v[40:41], v9 offset:16384
    v_mfma_f32_16x16x32_bf16 a[100:103], v[60:63], a[164:167], a[100:103]
    ds_read_b64_tr_b16 v[42:43], v9 offset:17408
    v_mfma_f32_16x16x32_bf16 a[104:107], v[60:63], a[168:171], a[104:107]
    ds_read_b128 a[152:155], v10 offset:6144
    v_mfma_f32_16x16x32_bf16 a[108:111], v[60:63], a[172:175], a[108:111]
    ds_read_b128 a[156:159], v10 offset:7168
    v_mfma_f32_16x16x32_bf16 a[112:115], v[60:63], a[176:179], a[112:115]
    v_mfma_f32_16x16x32_bf16 a[116:119], v[60:63], a[180:183], a[116:119]
    s_add_u32 m0, s48, s43
    v_mfma_f32_16x16x32_bf16 a[120:123], v[60:63], a[184:187], a[120:123]
    buffer_load_dwordx4 v19, s[12:15], s34 offen lds
    buffer_load_dword v25, v23, s[20:23], s24 offen
    v_mfma_f32_16x16x32_bf16 a[124:127], v[60:63], a[188:191], a[124:127]
    v_mfma_f32_16x16x32_bf16 a[204:207], v[60:63], v[192:195], a[204:207]
    s_add_u32 s33, s33, 64
    s_add_u32 s34, s34, 229376
    s_add_u32 s48, s48, 32768
    s_cmp_eq_u32 s48, 131072
    s_cselect_b32 s48, 0, s48
    s_add_u32 s24, s24, 458752
    s_mov_b32 s35, 15
k1_kernel_p1_loop:
    s_waitcnt vmcnt(10)
    s_barrier
    s_cmp_lg_u32 s35, 4
    s_cbranch_scc1 k1_kernel_p1_o6
    s_cmp_lg_u32 s32, 3
    s_cbranch_scc1 k1_kernel_p1_o6
    buffer_load_dword v31, v27, s[56:59], 0 offen sc1
k1_kernel_p1_o6:
    s_cmp_lg_u32 s35, 2
    s_cbranch_scc1 k1_kernel_p1_o8
    s_cmp_lg_u32 s32, 3
    s_cbranch_scc1 k1_kernel_p1_o8
    v_readfirstlane_b32 s60, v31
    s_nop 3
    s_cmp_lg_u32 s60, 0xffff
    s_cbranch_scc1 k1_kernel_p1_o8
    s_add_u32 s92, s4, 29360128
    s_addc_u32 s93, s5, 0
    s_mov_b32 s94, 16384
    s_mov_b32 s95, 0x00020000
    s_lshl_b32 s60, s44, 11
    v_lshlrev_b32 v3, 5, v2
    v_add_u32 v3, s60, v3
    buffer_load_dwordx4 v[240:243], v3, s[92:95], 0 offen sc1
    buffer_load_dwordx4 v[244:247], v3, s[92:95], 0 offen offset:16 sc1
    s_mov_b32 s50, 1
k1_kernel_p1_o8:
    s_waitcnt lgkmcnt(0)
    v_mfma_f32_16x16x32_bf16 v[64:67], v[32:35], a[128:131], v[64:67]
    ds_read_b64_tr_b16 v[44:45], v9 offset:24576
    v_mfma_f32_16x16x32_bf16 v[68:71], v[32:35], a[132:135], v[68:71]
    ds_read_b64_tr_b16 v[46:47], v9 offset:25600
    v_mfma_f32_16x16x32_bf16 v[72:75], v[32:35], a[136:139], v[72:75]
    v_mfma_f32_16x16x32_bf16 v[76:79], v[32:35], a[140:143], v[76:79]
    v_mfma_f32_16x16x32_bf16 v[80:83], v[32:35], a[144:147], v[80:83]
    v_mfma_f32_16x16x32_bf16 v[84:87], v[32:35], a[148:151], v[84:87]
    s_add_u32 m0, s48, s36
    v_mfma_f32_16x16x32_bf16 v[88:91], v[32:35], a[152:155], v[88:91]
    buffer_load_dwordx4 v12, s[8:11], s33 offen lds
    v_mfma_f32_16x16x32_bf16 v[92:95], v[32:35], a[156:159], v[92:95]
    v_mfma_f32_16x16x32_bf16 a[0:3], v[36:39], a[128:131], a[0:3]
    ds_read_b64_tr_b16 v[48:49], v8 offset:16640
    v_mfma_f32_16x16x32_bf16 a[4:7], v[36:39], a[132:135], a[4:7]
    ds_read_b64_tr_b16 v[50:51], v8 offset:17664
    v_mfma_f32_16x16x32_bf16 a[8:11], v[36:39], a[136:139], a[8:11]
    v_mfma_f32_16x16x32_bf16 a[12:15], v[36:39], a[140:143], a[12:15]
    v_mfma_f32_16x16x32_bf16 a[16:19], v[36:39], a[144:147], a[16:19]
    v_mfma_f32_16x16x32_bf16 a[20:23], v[36:39], a[148:151], a[20:23]
    s_add_u32 m0, s48, s37
    v_mfma_f32_16x16x32_bf16 a[24:27], v[36:39], a[152:155], a[24:27]
    buffer_load_dwordx4 v13, s[8:11], s33 offen lds
    v_mfma_f32_16x16x32_bf16 a[28:31], v[36:39], a[156:159], a[28:31]
    v_mfma_f32_16x16x32_bf16 v[96:99], v[40:43], a[128:131], v[96:99]
    ds_read_b64_tr_b16 v[52:53], v8 offset:24832
    v_mfma_f32_16x16x32_bf16 v[100:103], v[40:43], a[132:135], v[100:103]
    ds_read_b64_tr_b16 v[54:55], v8 offset:25856
    v_mfma_f32_16x16x32_bf16 v[104:107], v[40:43], a[136:139], v[104:107]
    v_mfma_f32_16x16x32_bf16 v[108:111], v[40:43], a[140:143], v[108:111]
    v_mfma_f32_16x16x32_bf16 v[112:115], v[40:43], a[144:147], v[112:115]
    v_mfma_f32_16x16x32_bf16 v[116:119], v[40:43], a[148:151], v[116:119]
    s_add_u32 m0, s48, s38
    v_mfma_f32_16x16x32_bf16 v[120:123], v[40:43], a[152:155], v[120:123]
    buffer_load_dwordx4 v14, s[8:11], s33 offen lds
    v_mfma_f32_16x16x32_bf16 v[124:127], v[40:43], a[156:159], v[124:127]
    s_waitcnt lgkmcnt(4)
    v_mfma_f32_16x16x32_bf16 a[32:35], v[44:47], a[128:131], a[32:35]
    ds_read_b64_tr_b16 v[56:57], v9 offset:16640
    v_mfma_f32_16x16x32_bf16 a[36:39], v[44:47], a[132:135], a[36:39]
    ds_read_b64_tr_b16 v[58:59], v9 offset:17664
    v_mfma_f32_16x16x32_bf16 a[40:43], v[44:47], a[136:139], a[40:43]
    v_mfma_f32_16x16x32_bf16 a[44:47], v[44:47], a[140:143], a[44:47]
    s_add_u32 s49, s47, 32768
    s_cmp_eq_u32 s49, 131072
    s_cselect_b32 s62, 0, s49
    s_sub_u32 s49, s62, s47
    s_mov_b32 s47, s62
    v_mfma_f32_16x16x32_bf16 a[48:51], v[44:47], a[144:147], a[48:51]
    v_mfma_f32_16x16x32_bf16 a[52:55], v[44:47], a[148:151], a[52:55]
    s_add_u32 m0, s48, s39
    v_mfma_f32_16x16x32_bf16 a[56:59], v[44:47], a[152:155], a[56:59]
    buffer_load_dwordx4 v15, s[8:11], s33 offen lds
    v_mfma_f32_16x16x32_bf16 a[60:63], v[44:47], a[156:159], a[60:63]
    s_waitcnt lgkmcnt(4)
    v_mfma_f32_16x16x32_bf16 v[128:131], v[48:51], a[128:131], v[128:131]
    ds_read_b64_tr_b16 v[60:61], v9 offset:24832
    v_mfma_f32_16x16x32_bf16 v[132:135], v[48:51], a[132:135], v[132:135]
    ds_read_b64_tr_b16 v[62:63], v9 offset:25856
    v_mfma_f32_16x16x32_bf16 v[136:139], v[48:51], a[136:139], v[136:139]
    v_add_u32 v8, s49, v8
    v_mfma_f32_16x16x32_bf16 v[140:143], v[48:51], a[140:143], v[140:143]
    v_add_u32 v9, s49, v9
    v_mfma_f32_16x16x32_bf16 v[144:147], v[48:51], a[144:147], v[144:147]
    v_add_u32 v10, s49, v10
    v_mfma_f32_16x16x32_bf16 v[148:151], v[48:51], a[148:151], v[148:151]
    s_add_u32 m0, s48, s40
    v_mfma_f32_16x16x32_bf16 v[152:155], v[48:51], a[152:155], v[152:155]
    buffer_load_dwordx4 v16, s[12:15], s34 offen lds
    v_mfma_f32_16x16x32_bf16 v[156:159], v[48:51], a[156:159], v[156:159]
    v_mfma_f32_16x16x32_bf16 a[192:195], v[48:51], v[192:195], a[192:195]
    s_waitcnt lgkmcnt(4)
    v_mfma_f32_16x16x32_bf16 a[64:67], v[52:55], a[128:131], a[64:67]
    ds_read_b64_tr_b16 v[32:33], v8 offset:16384
    v_mfma_f32_16x16x32_bf16 a[68:71], v[52:55], a[132:135], a[68:71]
    ds_read_b64_tr_b16 v[34:35], v8 offset:17408
    v_mfma_f32_16x16x32_bf16 a[72:75], v[52:55], a[136:139], a[72:75]
    ds_read_b128 a[160:163], v10 offset:0
    v_mfma_f32_16x16x32_bf16 a[76:79], v[52:55], a[140:143], a[76:79]
    ds_read_b128 a[164:167], v10 offset:1024
    v_mfma_f32_16x16x32_bf16 a[80:83], v[52:55], a[144:147], a[80:83]
    ds_read_b128 a[168:171], v10 offset:2048
    v_mfma_f32_16x16x32_bf16 a[84:87], v[52:55], a[148:151], a[84:87]
    s_add_u32 m0, s48, s41
    v_mfma_f32_16x16x32_bf16 a[88:91], v[52:55], a[152:155], a[88:91]
    buffer_load_dwordx4 v17, s[12:15], s34 offen lds
    v_mfma_f32_16x16x32_bf16 a[92:95], v[52:55], a[156:159], a[92:95]
    v_mfma_f32_16x16x32_bf16 a[196:199], v[52:55], v[192:195], a[196:199]
    s_waitcnt lgkmcnt(7)
    v_mfma_f32_16x16x32_bf16 v[160:163], v[56:59], a[128:131], v[160:163]
    ds_read_b64_tr_b16 v[36:37], v8 offset:24576
    v_mfma_f32_16x16x32_bf16 v[164:167], v[56:59], a[132:135], v[164:167]
    ds_read_b64_tr_b16 v[38:39], v8 offset:25600
    v_mfma_f32_16x16x32_bf16 v[168:171], v[56:59], a[136:139], v[168:171]
    ds_read_b128 a[172:175], v10 offset:3072
    v_mfma_f32_16x16x32_bf16 v[172:175], v[56:59], a[140:143], v[172:175]
    ds_read_b128 a[176:179], v10 offset:4096
    v_mfma_f32_16x16x32_bf16 v[176:179], v[56:59], a[144:147], v[176:179]
    ds_read_b128 a[180:183], v10 offset:5120
    v_mfma_f32_16x16x32_bf16 v[180:183], v[56:59], a[148:151], v[180:183]
    s_add_u32 m0, s48, s42
    v_mfma_f32_16x16x32_bf16 v[184:187], v[56:59], a[152:155], v[184:187]
    buffer_load_dwordx4 v18, s[12:15], s34 offen lds
    v_mfma_f32_16x16x32_bf16 v[188:191], v[56:59], a[156:159], v[188:191]
    v_mfma_f32_16x16x32_bf16 a[200:203], v[56:59], v[192:195], a[200:203]
    s_waitcnt lgkmcnt(10)
    v_mfma_f32_16x16x32_bf16 a[96:99], v[60:63], a[128:131], a[96:99]
    ds_read_b64_tr_b16 v[40:41], v9 offset:16384
    v_mfma_f32_16x16x32_bf16 a[100:103], v[60:63], a[132:135], a[100:103]
    ds_read_b64_tr_b16 v[42:43], v9 offset:17408
    v_mfma_f32_16x16x32_bf16 a[104:107], v[60:63], a[136:139], a[104:107]
    ds_read_b128 a[184:187], v10 offset:6144
    v_mfma_f32_16x16x32_bf16 a[108:111], v[60:63], a[140:143], a[108:111]
    ds_read_b128 a[188:191], v10 offset:7168
    v_mfma_f32_16x16x32_bf16 a[112:115], v[60:63], a[144:147], a[112:115]
    v_mfma_f32_16x16x32_bf16 a[116:119], v[60:63], a[148:151], a[116:119]
    s_add_u32 m0, s48, s43
    v_mfma_f32_16x16x32_bf16 a[120:123], v[60:63], a[152:155], a[120:123]
    buffer_load_dwordx4 v19, s[12:15], s34 offen lds
    buffer_load_dword v25, v23, s[16:19], s24 offen
    v_mfma_f32_16x16x32_bf16 a[124:127], v[60:63], a[156:159], a[124:127]
    v_mfma_f32_16x16x32_bf16 a[204:207], v[60:63], v[192:195], a[204:207]
    s_add_u32 s33, s33, 64
    s_add_u32 s34, s34, 229376
    s_add_u32 s48, s48, 32768
    s_cmp_eq_u32 s48, 131072
    s_cselect_b32 s48, 0, s48
    s_waitcnt vmcnt(10)
    s_barrier
    s_waitcnt lgkmcnt(0)
    v_mfma_f32_16x16x32_bf16 v[64:67], v[32:35], a[160:163], v[64:67]
    ds_read_b64_tr_b16 v[44:45], v9 offset:24576
    v_mfma_f32_16x16x32_bf16 v[68:71], v[32:35], a[164:167], v[68:71]
    ds_read_b64_tr_b16 v[46:47], v9 offset:25600
    v_mfma_f32_16x16x32_bf16 v[72:75], v[32:35], a[168:171], v[72:75]
    v_mfma_f32_16x16x32_bf16 v[76:79], v[32:35], a[172:175], v[76:79]
    v_mfma_f32_16x16x32_bf16 v[80:83], v[32:35], a[176:179], v[80:83]
    v_mfma_f32_16x16x32_bf16 v[84:87], v[32:35], a[180:183], v[84:87]
    s_add_u32 m0, s48, s36
    v_mfma_f32_16x16x32_bf16 v[88:91], v[32:35], a[184:187], v[88:91]
    buffer_load_dwordx4 v12, s[8:11], s33 offen lds
    v_mfma_f32_16x16x32_bf16 v[92:95], v[32:35], a[188:191], v[92:95]
    v_mfma_f32_16x16x32_bf16 a[0:3], v[36:39], a[160:163], a[0:3]
    ds_read_b64_tr_b16 v[48:49], v8 offset:16640
    v_mfma_f32_16x16x32_bf16 a[4:7], v[36:39], a[164:167], a[4:7]
    ds_read_b64_tr_b16 v[50:51], v8 offset:17664
    v_mfma_f32_16x16x32_bf16 a[8:11], v[36:39], a[168:171], a[8:11]
    v_mfma_f32_16x16x32_bf16 a[12:15], v[36:39], a[172:175], a[12:15]
    v_mfma_f32_16x16x32_bf16 a[16:19], v[36:39], a[176:179], a[16:19]
    v_mfma_f32_16x16x32_bf16 a[20:23], v[36:39], a[180:183], a[20:23]
    s_add_u32 m0, s48, s37
    v_mfma_f32_16x16x32_bf16 a[24:27], v[36:39], a[184:187], a[24:27]
    buffer_load_dwordx4 v13, s[8:11], s33 offen lds
    v_mfma_f32_16x16x32_bf16 a[28:31], v[36:39], a[188:191], a[28:31]
    v_mfma_f32_16x16x32_bf16 v[96:99], v[40:43], a[160:163], v[96:99]
    ds_read_b64_tr_b16 v[52:53], v8 offset:24832
    v_mfma_f32_16x16x32_bf16 v[100:103], v[40:43], a[164:167], v[100:103]
    ds_read_b64_tr_b16 v[54:55], v8 offset:25856
    v_mfma_f32_16x16x32_bf16 v[104:107], v[40:43], a[168:171], v[104:107]
    v_mfma_f32_16x16x32_bf16 v[108:111], v[40:43], a[172:175], v[108:111]
    v_mfma_f32_16x16x32_bf16 v[112:115], v[40:43], a[176:179], v[112:115]
    v_mfma_f32_16x16x32_bf16 v[116:119], v[40:43], a[180:183], v[116:119]
    s_add_u32 m0, s48, s38
    v_mfma_f32_16x16x32_bf16 v[120:123], v[40:43], a[184:187], v[120:123]
    buffer_load_dwordx4 v14, s[8:11], s33 offen lds
    v_mfma_f32_16x16x32_bf16 v[124:127], v[40:43], a[188:191], v[124:127]
    s_waitcnt lgkmcnt(4)
    v_mfma_f32_16x16x32_bf16 a[32:35], v[44:47], a[160:163], a[32:35]
    ds_read_b64_tr_b16 v[56:57], v9 offset:16640
    v_mfma_f32_16x16x32_bf16 a[36:39], v[44:47], a[164:167], a[36:39]
    ds_read_b64_tr_b16 v[58:59], v9 offset:17664
    v_mfma_f32_16x16x32_bf16 a[40:43], v[44:47], a[168:171], a[40:43]
    v_mfma_f32_16x16x32_bf16 a[44:47], v[44:47], a[172:175], a[44:47]
    s_add_u32 s49, s47, 32768
    s_cmp_eq_u32 s49, 131072
    s_cselect_b32 s62, 0, s49
    s_sub_u32 s49, s62, s47
    s_mov_b32 s47, s62
    v_mfma_f32_16x16x32_bf16 a[48:51], v[44:47], a[176:179], a[48:51]
    v_mfma_f32_16x16x32_bf16 a[52:55], v[44:47], a[180:183], a[52:55]
    s_add_u32 m0, s48, s39
    v_mfma_f32_16x16x32_bf16 a[56:59], v[44:47], a[184:187], a[56:59]
    buffer_load_dwordx4 v15, s[8:11], s33 offen lds
    v_mfma_f32_16x16x32_bf16 a[60:63], v[44:47], a[188:191], a[60:63]
    s_waitcnt lgkmcnt(4)
    v_mfma_f32_16x16x32_bf16 v[128:131], v[48:51], a[160:163], v[128:131]
    ds_read_b64_tr_b16 v[60:61], v9 offset:24832
    v_mfma_f32_16x16x32_bf16 v[132:135], v[48:51], a[164:167], v[132:135]
    ds_read_b64_tr_b16 v[62:63], v9 offset:25856
    v_mfma_f32_16x16x32_bf16 v[136:139], v[48:51], a[168:171], v[136:139]
    v_add_u32 v8, s49, v8
    v_mfma_f32_16x16x32_bf16 v[140:143], v[48:51], a[172:175], v[140:143]
    v_add_u32 v9, s49, v9
    v_mfma_f32_16x16x32_bf16 v[144:147], v[48:51], a[176:179], v[144:147]
    v_add_u32 v10, s49, v10
    v_mfma_f32_16x16x32_bf16 v[148:151], v[48:51], a[180:183], v[148:151]
    s_add_u32 m0, s48, s40
    v_mfma_f32_16x16x32_bf16 v[152:155], v[48:51], a[184:187], v[152:155]
    buffer_load_dwordx4 v16, s[12:15], s34 offen lds
    v_mfma_f32_16x16x32_bf16 v[156:159], v[48:51], a[188:191], v[156:159]
    v_mfma_f32_16x16x32_bf16 a[192:195], v[48:51], v[192:195], a[192:195]
    s_waitcnt lgkmcnt(4)
    v_mfma_f32_16x16x32_bf16 a[64:67], v[52:55], a[160:163], a[64:67]
    ds_read_b64_tr_b16 v[32:33], v8 offset:16384
    v_mfma_f32_16x16x32_bf16 a[68:71], v[52:55], a[164:167], a[68:71]
    ds_read_b64_tr_b16 v[34:35], v8 offset:17408
    v_mfma_f32_16x16x32_bf16 a[72:75], v[52:55], a[168:171], a[72:75]
    ds_read_b128 a[128:131], v10 offset:0
    v_mfma_f32_16x16x32_bf16 a[76:79], v[52:55], a[172:175], a[76:79]
    ds_read_b128 a[132:135], v10 offset:1024
    v_mfma_f32_16x16x32_bf16 a[80:83], v[52:55], a[176:179], a[80:83]
    ds_read_b128 a[136:139], v10 offset:2048
    v_mfma_f32_16x16x32_bf16 a[84:87], v[52:55], a[180:183], a[84:87]
    s_add_u32 m0, s48, s41
    v_mfma_f32_16x16x32_bf16 a[88:91], v[52:55], a[184:187], a[88:91]
    buffer_load_dwordx4 v17, s[12:15], s34 offen lds
    v_mfma_f32_16x16x32_bf16 a[92:95], v[52:55], a[188:191], a[92:95]
    v_mfma_f32_16x16x32_bf16 a[196:199], v[52:55], v[192:195], a[196:199]
    s_waitcnt lgkmcnt(7)
    v_mfma_f32_16x16x32_bf16 v[160:163], v[56:59], a[160:163], v[160:163]
    ds_read_b64_tr_b16 v[36:37], v8 offset:24576
    v_mfma_f32_16x16x32_bf16 v[164:167], v[56:59], a[164:167], v[164:167]
    ds_read_b64_tr_b16 v[38:39], v8 offset:25600
    v_mfma_f32_16x16x32_bf16 v[168:171], v[56:59], a[168:171], v[168:171]
    ds_read_b128 a[140:143], v10 offset:3072
    v_mfma_f32_16x16x32_bf16 v[172:175], v[56:59], a[172:175], v[172:175]
    ds_read_b128 a[144:147], v10 offset:4096
    v_mfma_f32_16x16x32_bf16 v[176:179], v[56:59], a[176:179], v[176:179]
    ds_read_b128 a[148:151], v10 offset:5120
    v_mfma_f32_16x16x32_bf16 v[180:183], v[56:59], a[180:183], v[180:183]
    s_add_u32 m0, s48, s42
    v_mfma_f32_16x16x32_bf16 v[184:187], v[56:59], a[184:187], v[184:187]
    buffer_load_dwordx4 v18, s[12:15], s34 offen lds
    v_mfma_f32_16x16x32_bf16 v[188:191], v[56:59], a[188:191], v[188:191]
    v_mfma_f32_16x16x32_bf16 a[200:203], v[56:59], v[192:195], a[200:203]
    s_waitcnt lgkmcnt(10)
    v_mfma_f32_16x16x32_bf16 a[96:99], v[60:63], a[160:163], a[96:99]
    ds_read_b64_tr_b16 v[40:41], v9 offset:16384
    v_mfma_f32_16x16x32_bf16 a[100:103], v[60:63], a[164:167], a[100:103]
    ds_read_b64_tr_b16 v[42:43], v9 offset:17408
    v_mfma_f32_16x16x32_bf16 a[104:107], v[60:63], a[168:171], a[104:107]
    ds_read_b128 a[152:155], v10 offset:6144
    v_mfma_f32_16x16x32_bf16 a[108:111], v[60:63], a[172:175], a[108:111]
    ds_read_b128 a[156:159], v10 offset:7168
    v_mfma_f32_16x16x32_bf16 a[112:115], v[60:63], a[176:179], a[112:115]
    v_mfma_f32_16x16x32_bf16 a[116:119], v[60:63], a[180:183], a[116:119]
    s_add_u32 m0, s48, s43
    v_mfma_f32_16x16x32_bf16 a[120:123], v[60:63], a[184:187], a[120:123]
    buffer_load_dwordx4 v19, s[12:15], s34 offen lds
    buffer_load_dword v25, v23, s[20:23], s24 offen
    v_mfma_f32_16x16x32_bf16 a[124:127], v[60:63], a[188:191], a[124:127]
    v_mfma_f32_16x16x32_bf16 a[204:207], v[60:63], v[192:195], a[204:207]
    s_add_u32 s33, s33, 64
    s_add_u32 s34, s34, 229376
    s_add_u32 s48, s48, 32768
    s_cmp_eq_u32 s48, 131072
    s_cselect_b32 s48, 0, s48
    s_add_u32 s24, s24, 458752
    s_sub_u32 s35, s35, 1
    s_cmp_lg_u32 s35, 0
    s_cbranch_scc1 k1_kernel_p1_loop
    v_lshrrev_b32 v3, 4, v2
    v_lshlrev_b32 v3, 4, v3
    s_and_b32 s60, s32, 1
    s_lshl_b32 s60, s60, 9
    s_add_u32 s60, s60, 131072
    v_add_u32 v3, s60, v3
    s_nop 7
    s_mov_b32 s60, 0x00010001
    s_mov_b32 s61, 0x00010001
    s_mov_b64 exec, s[60:61]
    ds_write_b128 v3, a[192:195] offset:256
    ds_write_b128 v3, a[196:199] offset:320
    ds_write_b128 v3, a[200:203] offset:384
    ds_write_b128 v3, a[204:207] offset:448
    s_mov_b64 exec, -1
    s_cmp_lg_u32 s32, 3
    s_cbranch_scc1 k1_kernel_epi
    s_cmp_eq_u32 s50, 1
    s_cbranch_scc1 k1_kernel_p1_fb
    s_mov_b32 s62, 200000
k1_kernel_p1_poll:
    buffer_load_dword v31, v27, s[56:59], 0 offen sc1
    s_waitcnt vmcnt(0)
    v_readfirstlane_b32 s60, v31
    s_nop 3
    s_cmp_eq_u32 s60, 0xffff
    s_cbranch_scc1 k1_kernel_p1_pd
    s_sleep 8
    s_sub_u32 s62, s62, 1
    s_cmp_lg_u32 s62, 0
    s_cbranch_scc1 k1_kernel_p1_poll
k1_kernel_p1_pd:
    s_add_u32 s92, s4, 29360128
    s_addc_u32 s93, s5, 0
    s_mov_b32 s94, 16384
    s_mov_b32 s95, 0x00020000
    s_lshl_b32 s60, s44, 11
    v_lshlrev_b32 v3, 5, v2
    v_add_u32 v3, s60, v3
    buffer_load_dwordx4 v[240:243], v3, s[92:95], 0 offen sc1
    buffer_load_dwordx4 v[244:247], v3, s[92:95], 0 offen offset:16 sc1
k1_kernel_p1_fb:
    s_waitcnt vmcnt(0)
    v_lshlrev_b32 v3, 5, v2
    v_add_u32 v3, 132096, v3
    ds_write_b128 v3, v[240:243]
    ds_write_b128 v3, v[244:247] offset:16
k1_kernel_epi:
    s_waitcnt lgkmcnt(0)
    s_barrier
    s_add_u32 s28, s4, 8388608
    s_addc_u32 s29, s5, 0
    s_mov_b32 s30, 14680064
    s_mov_b32 s31, 0x00020000
    v_lshrrev_b32 v7, 4, v2
    v_lshlrev_b32 v3, 4, v7
    s_and_b32 s60, s32, 1
    s_lshl_b32 s60, s60, 9
    s_add_u32 s60, s60, 131072
    v_add_u32 v3, s60, v3
    ds_read_b128 v[32:35], v3 offset:0
    ds_read_b128 v[36:39], v3 offset:64
    ds_read_b128 v[40:43], v3 offset:128
    ds_read_b128 v[44:47], v3 offset:192
    ds_read_b128 v[48:51], v3 offset:256
    ds_read_b128 v[52:55], v3 offset:320
    ds_read_b128 v[56:59], v3 offset:384
    ds_read_b128 v[60:63], v3 offset:448
    v_and_b32 v5, 15, v2
    s_lshr_b32 s60, s32, 1
    s_lshl_b32 s60, s60, 10
    s_add_u32 s60, s60, 132096
    v_lshl_add_u32 v5, v5, 3, s60
    ds_read_b64 v[208:209], v5 offset:0
    ds_read_b64 v[210:211], v5 offset:128
    ds_read_b64 v[212:213], v5 offset:256
    ds_read_b64 v[214:215], v5 offset:384
    ds_read_b64 v[216:217], v5 offset:512
    ds_read_b64 v[218:219], v5 offset:640
    ds_read_b64 v[220:221], v5 offset:768
    ds_read_b64 v[222:223], v5 offset:896
    s_lshl_b32 s54, s44, 4
    s_lshr_b32 s55, s32, 1
    s_lshl_b32 s55, s55, 3
    s_add_u32 s54, s54, s55
    s_mul_i32 s54, s54, 112
    s_lshl_b32 s55, s45, 2
    s_add_u32 s54, s54, s55
    s_and_b32 s55, s32, 1
    s_lshl_b32 s55, s55, 1
    s_add_u32 s54, s54, s55
    s_lshl_b32 s54, s54, 10
    v_add_u32 v3, s54, v26
    s_mov_b32 s56, 0xbfb8aa3b
    s_waitcnt lgkmcnt(0)
    v_sub_f32 v8, 0, v208
    v_rcp_f32 v10, v209
    v_mul_f32 v12, v209, v209
    v_mul_f32 v10, s56, v10
    v_accvgpr_read_b32 v228, a0
    v_accvgpr_read_b32 v229, a1
    v_accvgpr_read_b32 v230, a2
    v_accvgpr_read_b32 v231, a3
    v_pk_fma_f32 v[64:65], v[32:33], v[8:9], v[64:65] op_sel_hi:[1,0,1]
    v_pk_fma_f32 v[66:67], v[34:35], v[8:9], v[66:67] op_sel_hi:[1,0,1]
    v_pk_mul_f32 v[224:225], v[64:65], v[10:11] op_sel_hi:[1,0]
    v_pk_mul_f32 v[226:227], v[66:67], v[10:11] op_sel_hi:[1,0]
    v_exp_f32 v224, v224
    v_exp_f32 v225, v225
    v_exp_f32 v226, v226
    v_exp_f32 v227, v227
    v_pk_fma_f32 v[228:229], v[36:37], v[8:9], v[228:229] op_sel_hi:[1,0,1]
    v_pk_fma_f32 v[230:231], v[38:39], v[8:9], v[230:231] op_sel_hi:[1,0,1]
    v_pk_fma_f32 v[224:225], v[224:225], v[12:13], v[12:13] op_sel_hi:[1,0,0]
    v_pk_fma_f32 v[226:227], v[226:227], v[12:13], v[12:13] op_sel_hi:[1,0,0]
    v_pk_mul_f32 v[228:229], v[228:229], v[64:65]
    v_pk_mul_f32 v[230:231], v[230:231], v[66:67]
    v_rcp_f32 v224, v224
    v_rcp_f32 v225, v225
    v_rcp_f32 v226, v226
    v_rcp_f32 v227, v227
    s_nop 0
    v_pk_mul_f32 v[228:229], v[228:229], v[224:225]
    v_pk_mul_f32 v[230:231], v[230:231], v[226:227]
    v_cvt_pk_bf16_f32 v240, v228, v229
    v_cvt_pk_bf16_f32 v241, v230, v231
    v_accvgpr_read_b32 v236, a32
    v_accvgpr_read_b32 v237, a33
    v_accvgpr_read_b32 v238, a34
    v_accvgpr_read_b32 v239, a35
    v_pk_fma_f32 v[96:97], v[40:41], v[8:9], v[96:97] op_sel_hi:[1,0,1]
    v_pk_fma_f32 v[98:99], v[42:43], v[8:9], v[98:99] op_sel_hi:[1,0,1]
    v_pk_mul_f32 v[232:233], v[96:97], v[10:11] op_sel_hi:[1,0]
    v_pk_mul_f32 v[234:235], v[98:99], v[10:11] op_sel_hi:[1,0]
    v_exp_f32 v232, v232
    v_exp_f32 v233, v233
    v_exp_f32 v234, v234
    v_exp_f32 v235, v235
    v_pk_fma_f32 v[236:237], v[44:45], v[8:9], v[236:237] op_sel_hi:[1,0,1]
    v_pk_fma_f32 v[238:239], v[46:47], v[8:9], v[238:239] op_sel_hi:[1,0,1]
    v_pk_fma_f32 v[232:233], v[232:233], v[12:13], v[12:13] op_sel_hi:[1,0,0]
    v_pk_fma_f32 v[234:235], v[234:235], v[12:13], v[12:13] op_sel_hi:[1,0,0]
    v_pk_mul_f32 v[236:237], v[236:237], v[96:97]
    v_pk_mul_f32 v[238:239], v[238:239], v[98:99]
    v_rcp_f32 v232, v232
    v_rcp_f32 v233, v233
    v_rcp_f32 v234, v234
    v_rcp_f32 v235, v235
    s_nop 0
    v_pk_mul_f32 v[236:237], v[236:237], v[232:233]
    v_pk_mul_f32 v[238:239], v[238:239], v[234:235]
    v_cvt_pk_bf16_f32 v242, v236, v237
    v_cvt_pk_bf16_f32 v243, v238, v239
    buffer_store_dwordx4 v[240:243], v3, s[28:31], 0 offen offset:0
    v_accvgpr_read_b32 v228, a64
    v_accvgpr_read_b32 v229, a65
    v_accvgpr_read_b32 v230, a66
    v_accvgpr_read_b32 v231, a67
    v_pk_fma_f32 v[128:129], v[48:49], v[8:9], v[128:129] op_sel_hi:[1,0,1]
    v_pk_fma_f32 v[130:131], v[50:51], v[8:9], v[130:131] op_sel_hi:[1,0,1]
    v_pk_mul_f32 v[224:225], v[128:129], v[10:11] op_sel_hi:[1,0]
    v_pk_mul_f32 v[226:227], v[130:131], v[10:11] op_sel_hi:[1,0]
    v_exp_f32 v224, v224
    v_exp_f32 v225, v225
    v_exp_f32 v226, v226
    v_exp_f32 v227, v227
    v_pk_fma_f32 v[228:229], v[52:53], v[8:9], v[228:229] op_sel_hi:[1,0,1]
    v_pk_fma_f32 v[230:231], v[54:55], v[8:9], v[230:231] op_sel_hi:[1,0,1]
    v_pk_fma_f32 v[224:225], v[224:225], v[12:13], v[12:13] op_sel_hi:[1,0,0]
    v_pk_fma_f32 v[226:227], v[226:227], v[12:13], v[12:13] op_sel_hi:[1,0,0]
    v_pk_mul_f32 v[228:229], v[228:229], v[128:129]
    v_pk_mul_f32 v[230:231], v[230:231], v[130:131]
    v_rcp_f32 v224, v224
    v_rcp_f32 v225, v225
    v_rcp_f32 v226, v226
    v_rcp_f32 v227, v227
    s_nop 0
    v_pk_mul_f32 v[228:229], v[228:229], v[224:225]
    v_pk_mul_f32 v[230:231], v[230:231], v[226:227]
    v_cvt_pk_bf16_f32 v244, v228, v229
    v_cvt_pk_bf16_f32 v245, v230, v231
    v_accvgpr_read_b32 v236, a96
    v_accvgpr_read_b32 v237, a97
    v_accvgpr_read_b32 v238, a98
    v_accvgpr_read_b32 v239, a99
    v_pk_fma_f32 v[160:161], v[56:57], v[8:9], v[160:161] op_sel_hi:[1,0,1]
    v_pk_fma_f32 v[162:163], v[58:59], v[8:9], v[162:163] op_sel_hi:[1,0,1]
    v_pk_mul_f32 v[232:233], v[160:161], v[10:11] op_sel_hi:[1,0]
    v_pk_mul_f32 v[234:235], v[162:163], v[10:11] op_sel_hi:[1,0]
    v_exp_f32 v232, v232
    v_exp_f32 v233, v233
    v_exp_f32 v234, v234
    v_exp_f32 v235, v235
    v_pk_fma_f32 v[236:237], v[60:61], v[8:9], v[236:237] op_sel_hi:[1,0,1]
    v_pk_fma_f32 v[238:239], v[62:63], v[8:9], v[238:239] op_sel_hi:[1,0,1]
    v_pk_fma_f32 v[232:233], v[232:233], v[12:13], v[12:13] op_sel_hi:[1,0,0]
    v_pk_fma_f32 v[234:235], v[234:235], v[12:13], v[12:13] op_sel_hi:[1,0,0]
    v_pk_mul_f32 v[236:237], v[236:237], v[160:161]
    v_pk_mul_f32 v[238:239], v[238:239], v[162:163]
    v_rcp_f32 v232, v232
    v_rcp_f32 v233, v233
    v_rcp_f32 v234, v234
    v_rcp_f32 v235, v235
    s_nop 0
    v_pk_mul_f32 v[236:237], v[236:237], v[232:233]
    v_pk_mul_f32 v[238:239], v[238:239], v[234:235]
    v_cvt_pk_bf16_f32 v246, v236, v237
    v_cvt_pk_bf16_f32 v247, v238, v239
    buffer_store_dwordx4 v[244:247], v3, s[28:31], 0 offen offset:1024
    v_add_u32 v3, 114688, v3
    v_sub_f32 v8, 0, v210
    v_rcp_f32 v10, v211
    v_mul_f32 v12, v211, v211
    v_mul_f32 v10, s56, v10
    v_accvgpr_read_b32 v228, a4
    v_accvgpr_read_b32 v229, a5
    v_accvgpr_read_b32 v230, a6
    v_accvgpr_read_b32 v231, a7
    v_pk_fma_f32 v[68:69], v[32:33], v[8:9], v[68:69] op_sel_hi:[1,0,1]
    v_pk_fma_f32 v[70:71], v[34:35], v[8:9], v[70:71] op_sel_hi:[1,0,1]
    v_pk_mul_f32 v[224:225], v[68:69], v[10:11] op_sel_hi:[1,0]
    v_pk_mul_f32 v[226:227], v[70:71], v[10:11] op_sel_hi:[1,0]
    v_exp_f32 v224, v224
    v_exp_f32 v225, v225
    v_exp_f32 v226, v226
    v_exp_f32 v227, v227
    v_pk_fma_f32 v[228:229], v[36:37], v[8:9], v[228:229] op_sel_hi:[1,0,1]
    v_pk_fma_f32 v[230:231], v[38:39], v[8:9], v[230:231] op_sel_hi:[1,0,1]
    v_pk_fma_f32 v[224:225], v[224:225], v[12:13], v[12:13] op_sel_hi:[1,0,0]
    v_pk_fma_f32 v[226:227], v[226:227], v[12:13], v[12:13] op_sel_hi:[1,0,0]
    v_pk_mul_f32 v[228:229], v[228:229], v[68:69]
    v_pk_mul_f32 v[230:231], v[230:231], v[70:71]
    v_rcp_f32 v224, v224
    v_rcp_f32 v225, v225
    v_rcp_f32 v226, v226
    v_rcp_f32 v227, v227
    s_nop 0
    v_pk_mul_f32 v[228:229], v[228:229], v[224:225]
    v_pk_mul_f32 v[230:231], v[230:231], v[226:227]
    v_cvt_pk_bf16_f32 v240, v228, v229
    v_cvt_pk_bf16_f32 v241, v230, v231
    v_accvgpr_read_b32 v236, a36
    v_accvgpr_read_b32 v237, a37
    v_accvgpr_read_b32 v238, a38
    v_accvgpr_read_b32 v239, a39
    v_pk_fma_f32 v[100:101], v[40:41], v[8:9], v[100:101] op_sel_hi:[1,0,1]
    v_pk_fma_f32 v[102:103], v[42:43], v[8:9], v[102:103] op_sel_hi:[1,0,1]
    v_pk_mul_f32 v[232:233], v[100:101], v[10:11] op_sel_hi:[1,0]
    v_pk_mul_f32 v[234:235], v[102:103], v[10:11] op_sel_hi:[1,0]
    v_exp_f32 v232, v232
    v_exp_f32 v233, v233
    v_exp_f32 v234, v234
    v_exp_f32 v235, v235
    v_pk_fma_f32 v[236:237], v[44:45], v[8:9], v[236:237] op_sel_hi:[1,0,1]
    v_pk_fma_f32 v[238:239], v[46:47], v[8:9], v[238:239] op_sel_hi:[1,0,1]
    v_pk_fma_f32 v[232:233], v[232:233], v[12:13], v[12:13] op_sel_hi:[1,0,0]
    v_pk_fma_f32 v[234:235], v[234:235], v[12:13], v[12:13] op_sel_hi:[1,0,0]
    v_pk_mul_f32 v[236:237], v[236:237], v[100:101]
    v_pk_mul_f32 v[238:239], v[238:239], v[102:103]
    v_rcp_f32 v232, v232
    v_rcp_f32 v233, v233
    v_rcp_f32 v234, v234
    v_rcp_f32 v235, v235
    s_nop 0
    v_pk_mul_f32 v[236:237], v[236:237], v[232:233]
    v_pk_mul_f32 v[238:239], v[238:239], v[234:235]
    v_cvt_pk_bf16_f32 v242, v236, v237
    v_cvt_pk_bf16_f32 v243, v238, v239
    buffer_store_dwordx4 v[240:243], v3, s[28:31], 0 offen offset:0
    v_accvgpr_read_b32 v228, a68
    v_accvgpr_read_b32 v229, a69
    v_accvgpr_read_b32 v230, a70
    v_accvgpr_read_b32 v231, a71
    v_pk_fma_f32 v[132:133], v[48:49], v[8:9], v[132:133] op_sel_hi:[1,0,1]
    v_pk_fma_f32 v[134:135], v[50:51], v[8:9], v[134:135] op_sel_hi:[1,0,1]
    v_pk_mul_f32 v[224:225], v[132:133], v[10:11] op_sel_hi:[1,0]
    v_pk_mul_f32 v[226:227], v[134:135], v[10:11] op_sel_hi:[1,0]
    v_exp_f32 v224, v224
    v_exp_f32 v225, v225
    v_exp_f32 v226, v226
    v_exp_f32 v227, v227
    v_pk_fma_f32 v[228:229], v[52:53], v[8:9], v[228:229] op_sel_hi:[1,0,1]
    v_pk_fma_f32 v[230:231], v[54:55], v[8:9], v[230:231] op_sel_hi:[1,0,1]
    v_pk_fma_f32 v[224:225], v[224:225], v[12:13], v[12:13] op_sel_hi:[1,0,0]
    v_pk_fma_f32 v[226:227], v[226:227], v[12:13], v[12:13] op_sel_hi:[1,0,0]
    v_pk_mul_f32 v[228:229], v[228:229], v[132:133]
    v_pk_mul_f32 v[230:231], v[230:231], v[134:135]
    v_rcp_f32 v224, v224
    v_rcp_f32 v225, v225
    v_rcp_f32 v226, v226
    v_rcp_f32 v227, v227
    s_nop 0
    v_pk_mul_f32 v[228:229], v[228:229], v[224:225]
    v_pk_mul_f32 v[230:231], v[230:231], v[226:227]
    v_cvt_pk_bf16_f32 v244, v228, v229
    v_cvt_pk_bf16_f32 v245, v230, v231
    v_accvgpr_read_b32 v236, a100
    v_accvgpr_read_b32 v237, a101
    v_accvgpr_read_b32 v238, a102
    v_accvgpr_read_b32 v239, a103
    v_pk_fma_f32 v[164:165], v[56:57], v[8:9], v[164:165] op_sel_hi:[1,0,1]
    v_pk_fma_f32 v[166:167], v[58:59], v[8:9], v[166:167] op_sel_hi:[1,0,1]
    v_pk_mul_f32 v[232:233], v[164:165], v[10:11] op_sel_hi:[1,0]
    v_pk_mul_f32 v[234:235], v[166:167], v[10:11] op_sel_hi:[1,0]
    v_exp_f32 v232, v232
    v_exp_f32 v233, v233
    v_exp_f32 v234, v234
    v_exp_f32 v235, v235
    v_pk_fma_f32 v[236:237], v[60:61], v[8:9], v[236:237] op_sel_hi:[1,0,1]
    v_pk_fma_f32 v[238:239], v[62:63], v[8:9], v[238:239] op_sel_hi:[1,0,1]
    v_pk_fma_f32 v[232:233], v[232:233], v[12:13], v[12:13] op_sel_hi:[1,0,0]
    v_pk_fma_f32 v[234:235], v[234:235], v[12:13], v[12:13] op_sel_hi:[1,0,0]
    v_pk_mul_f32 v[236:237], v[236:237], v[164:165]
    v_pk_mul_f32 v[238:239], v[238:239], v[166:167]
    v_rcp_f32 v232, v232
    v_rcp_f32 v233, v233
    v_rcp_f32 v234, v234
    v_rcp_f32 v235, v235
    s_nop 0
    v_pk_mul_f32 v[236:237], v[236:237], v[232:233]
    v_pk_mul_f32 v[238:239], v[238:239], v[234:235]
    v_cvt_pk_bf16_f32 v246, v236, v237
    v_cvt_pk_bf16_f32 v247, v238, v239
    buffer_store_dwordx4 v[244:247], v3, s[28:31], 0 offen offset:1024
    v_add_u32 v3, 114688, v3
    v_sub_f32 v8, 0, v212
    v_rcp_f32 v10, v213
    v_mul_f32 v12, v213, v213
    v_mul_f32 v10, s56, v10
    v_accvgpr_read_b32 v228, a8
    v_accvgpr_read_b32 v229, a9
    v_accvgpr_read_b32 v230, a10
    v_accvgpr_read_b32 v231, a11
    v_pk_fma_f32 v[72:73], v[32:33], v[8:9], v[72:73] op_sel_hi:[1,0,1]
    v_pk_fma_f32 v[74:75], v[34:35], v[8:9], v[74:75] op_sel_hi:[1,0,1]
    v_pk_mul_f32 v[224:225], v[72:73], v[10:11] op_sel_hi:[1,0]
    v_pk_mul_f32 v[226:227], v[74:75], v[10:11] op_sel_hi:[1,0]
    v_exp_f32 v224, v224
    v_exp_f32 v225, v225
    v_exp_f32 v226, v226
    v_exp_f32 v227, v227
    v_pk_fma_f32 v[228:229], v[36:37], v[8:9], v[228:229] op_sel_hi:[1,0,1]
    v_pk_fma_f32 v[230:231], v[38:39], v[8:9], v[230:231] op_sel_hi:[1,0,1]
    v_pk_fma_f32 v[224:225], v[224:225], v[12:13], v[12:13] op_sel_hi:[1,0,0]
    v_pk_fma_f32 v[226:227], v[226:227], v[12:13], v[12:13] op_sel_hi:[1,0,0]
    v_pk_mul_f32 v[228:229], v[228:229], v[72:73]
    v_pk_mul_f32 v[230:231], v[230:231], v[74:75]
    v_rcp_f32 v224, v224
    v_rcp_f32 v225, v225
    v_rcp_f32 v226, v226
    v_rcp_f32 v227, v227
    s_nop 0
    v_pk_mul_f32 v[228:229], v[228:229], v[224:225]
    v_pk_mul_f32 v[230:231], v[230:231], v[226:227]
    v_cvt_pk_bf16_f32 v240, v228, v229
    v_cvt_pk_bf16_f32 v241, v230, v231
    v_accvgpr_read_b32 v236, a40
    v_accvgpr_read_b32 v237, a41
    v_accvgpr_read_b32 v238, a42
    v_accvgpr_read_b32 v239, a43
    v_pk_fma_f32 v[104:105], v[40:41], v[8:9], v[104:105] op_sel_hi:[1,0,1]
    v_pk_fma_f32 v[106:107], v[42:43], v[8:9], v[106:107] op_sel_hi:[1,0,1]
    v_pk_mul_f32 v[232:233], v[104:105], v[10:11] op_sel_hi:[1,0]
    v_pk_mul_f32 v[234:235], v[106:107], v[10:11] op_sel_hi:[1,0]
    v_exp_f32 v232, v232
    v_exp_f32 v233, v233
    v_exp_f32 v234, v234
    v_exp_f32 v235, v235
    v_pk_fma_f32 v[236:237], v[44:45], v[8:9], v[236:237] op_sel_hi:[1,0,1]
    v_pk_fma_f32 v[238:239], v[46:47], v[8:9], v[238:239] op_sel_hi:[1,0,1]
    v_pk_fma_f32 v[232:233], v[232:233], v[12:13], v[12:13] op_sel_hi:[1,0,0]
    v_pk_fma_f32 v[234:235], v[234:235], v[12:13], v[12:13] op_sel_hi:[1,0,0]
    v_pk_mul_f32 v[236:237], v[236:237], v[104:105]
    v_pk_mul_f32 v[238:239], v[238:239], v[106:107]
    v_rcp_f32 v232, v232
    v_rcp_f32 v233, v233
    v_rcp_f32 v234, v234
    v_rcp_f32 v235, v235
    s_nop 0
    v_pk_mul_f32 v[236:237], v[236:237], v[232:233]
    v_pk_mul_f32 v[238:239], v[238:239], v[234:235]
    v_cvt_pk_bf16_f32 v242, v236, v237
    v_cvt_pk_bf16_f32 v243, v238, v239
    buffer_store_dwordx4 v[240:243], v3, s[28:31], 0 offen offset:0
    v_accvgpr_read_b32 v228, a72
    v_accvgpr_read_b32 v229, a73
    v_accvgpr_read_b32 v230, a74
    v_accvgpr_read_b32 v231, a75
    v_pk_fma_f32 v[136:137], v[48:49], v[8:9], v[136:137] op_sel_hi:[1,0,1]
    v_pk_fma_f32 v[138:139], v[50:51], v[8:9], v[138:139] op_sel_hi:[1,0,1]
    v_pk_mul_f32 v[224:225], v[136:137], v[10:11] op_sel_hi:[1,0]
    v_pk_mul_f32 v[226:227], v[138:139], v[10:11] op_sel_hi:[1,0]
    v_exp_f32 v224, v224
    v_exp_f32 v225, v225
    v_exp_f32 v226, v226
    v_exp_f32 v227, v227
    v_pk_fma_f32 v[228:229], v[52:53], v[8:9], v[228:229] op_sel_hi:[1,0,1]
    v_pk_fma_f32 v[230:231], v[54:55], v[8:9], v[230:231] op_sel_hi:[1,0,1]
    v_pk_fma_f32 v[224:225], v[224:225], v[12:13], v[12:13] op_sel_hi:[1,0,0]
    v_pk_fma_f32 v[226:227], v[226:227], v[12:13], v[12:13] op_sel_hi:[1,0,0]
    v_pk_mul_f32 v[228:229], v[228:229], v[136:137]
    v_pk_mul_f32 v[230:231], v[230:231], v[138:139]
    v_rcp_f32 v224, v224
    v_rcp_f32 v225, v225
    v_rcp_f32 v226, v226
    v_rcp_f32 v227, v227
    s_nop 0
    v_pk_mul_f32 v[228:229], v[228:229], v[224:225]
    v_pk_mul_f32 v[230:231], v[230:231], v[226:227]
    v_cvt_pk_bf16_f32 v244, v228, v229
    v_cvt_pk_bf16_f32 v245, v230, v231
    v_accvgpr_read_b32 v236, a104
    v_accvgpr_read_b32 v237, a105
    v_accvgpr_read_b32 v238, a106
    v_accvgpr_read_b32 v239, a107
    v_pk_fma_f32 v[168:169], v[56:57], v[8:9], v[168:169] op_sel_hi:[1,0,1]
    v_pk_fma_f32 v[170:171], v[58:59], v[8:9], v[170:171] op_sel_hi:[1,0,1]
    v_pk_mul_f32 v[232:233], v[168:169], v[10:11] op_sel_hi:[1,0]
    v_pk_mul_f32 v[234:235], v[170:171], v[10:11] op_sel_hi:[1,0]
    v_exp_f32 v232, v232
    v_exp_f32 v233, v233
    v_exp_f32 v234, v234
    v_exp_f32 v235, v235
    v_pk_fma_f32 v[236:237], v[60:61], v[8:9], v[236:237] op_sel_hi:[1,0,1]
    v_pk_fma_f32 v[238:239], v[62:63], v[8:9], v[238:239] op_sel_hi:[1,0,1]
    v_pk_fma_f32 v[232:233], v[232:233], v[12:13], v[12:13] op_sel_hi:[1,0,0]
    v_pk_fma_f32 v[234:235], v[234:235], v[12:13], v[12:13] op_sel_hi:[1,0,0]
    v_pk_mul_f32 v[236:237], v[236:237], v[168:169]
    v_pk_mul_f32 v[238:239], v[238:239], v[170:171]
    v_rcp_f32 v232, v232
    v_rcp_f32 v233, v233
    v_rcp_f32 v234, v234
    v_rcp_f32 v235, v235
    s_nop 0
    v_pk_mul_f32 v[236:237], v[236:237], v[232:233]
    v_pk_mul_f32 v[238:239], v[238:239], v[234:235]
    v_cvt_pk_bf16_f32 v246, v236, v237
    v_cvt_pk_bf16_f32 v247, v238, v239
    buffer_store_dwordx4 v[244:247], v3, s[28:31], 0 offen offset:1024
    v_add_u32 v3, 114688, v3
    v_sub_f32 v8, 0, v214
    v_rcp_f32 v10, v215
    v_mul_f32 v12, v215, v215
    v_mul_f32 v10, s56, v10
    v_accvgpr_read_b32 v228, a12
    v_accvgpr_read_b32 v229, a13
    v_accvgpr_read_b32 v230, a14
    v_accvgpr_read_b32 v231, a15
    v_pk_fma_f32 v[76:77], v[32:33], v[8:9], v[76:77] op_sel_hi:[1,0,1]
    v_pk_fma_f32 v[78:79], v[34:35], v[8:9], v[78:79] op_sel_hi:[1,0,1]
    v_pk_mul_f32 v[224:225], v[76:77], v[10:11] op_sel_hi:[1,0]
    v_pk_mul_f32 v[226:227], v[78:79], v[10:11] op_sel_hi:[1,0]
    v_exp_f32 v224, v224
    v_exp_f32 v225, v225
    v_exp_f32 v226, v226
    v_exp_f32 v227, v227
    v_pk_fma_f32 v[228:229], v[36:37], v[8:9], v[228:229] op_sel_hi:[1,0,1]
    v_pk_fma_f32 v[230:231], v[38:39], v[8:9], v[230:231] op_sel_hi:[1,0,1]
    v_pk_fma_f32 v[224:225], v[224:225], v[12:13], v[12:13] op_sel_hi:[1,0,0]
    v_pk_fma_f32 v[226:227], v[226:227], v[12:13], v[12:13] op_sel_hi:[1,0,0]
    v_pk_mul_f32 v[228:229], v[228:229], v[76:77]
    v_pk_mul_f32 v[230:231], v[230:231], v[78:79]
    v_rcp_f32 v224, v224
    v_rcp_f32 v225, v225
    v_rcp_f32 v226, v226
    v_rcp_f32 v227, v227
    s_nop 0
    v_pk_mul_f32 v[228:229], v[228:229], v[224:225]
    v_pk_mul_f32 v[230:231], v[230:231], v[226:227]
    v_cvt_pk_bf16_f32 v240, v228, v229
    v_cvt_pk_bf16_f32 v241, v230, v231
    v_accvgpr_read_b32 v236, a44
    v_accvgpr_read_b32 v237, a45
    v_accvgpr_read_b32 v238, a46
    v_accvgpr_read_b32 v239, a47
    v_pk_fma_f32 v[108:109], v[40:41], v[8:9], v[108:109] op_sel_hi:[1,0,1]
    v_pk_fma_f32 v[110:111], v[42:43], v[8:9], v[110:111] op_sel_hi:[1,0,1]
    v_pk_mul_f32 v[232:233], v[108:109], v[10:11] op_sel_hi:[1,0]
    v_pk_mul_f32 v[234:235], v[110:111], v[10:11] op_sel_hi:[1,0]
    v_exp_f32 v232, v232
    v_exp_f32 v233, v233
    v_exp_f32 v234, v234
    v_exp_f32 v235, v235
    v_pk_fma_f32 v[236:237], v[44:45], v[8:9], v[236:237] op_sel_hi:[1,0,1]
    v_pk_fma_f32 v[238:239], v[46:47], v[8:9], v[238:239] op_sel_hi:[1,0,1]
    v_pk_fma_f32 v[232:233], v[232:233], v[12:13], v[12:13] op_sel_hi:[1,0,0]
    v_pk_fma_f32 v[234:235], v[234:235], v[12:13], v[12:13] op_sel_hi:[1,0,0]
    v_pk_mul_f32 v[236:237], v[236:237], v[108:109]
    v_pk_mul_f32 v[238:239], v[238:239], v[110:111]
    v_rcp_f32 v232, v232
    v_rcp_f32 v233, v233
    v_rcp_f32 v234, v234
    v_rcp_f32 v235, v235
    s_nop 0
    v_pk_mul_f32 v[236:237], v[236:237], v[232:233]
    v_pk_mul_f32 v[238:239], v[238:239], v[234:235]
    v_cvt_pk_bf16_f32 v242, v236, v237
    v_cvt_pk_bf16_f32 v243, v238, v239
    buffer_store_dwordx4 v[240:243], v3, s[28:31], 0 offen offset:0
    v_accvgpr_read_b32 v228, a76
    v_accvgpr_read_b32 v229, a77
    v_accvgpr_read_b32 v230, a78
    v_accvgpr_read_b32 v231, a79
    v_pk_fma_f32 v[140:141], v[48:49], v[8:9], v[140:141] op_sel_hi:[1,0,1]
    v_pk_fma_f32 v[142:143], v[50:51], v[8:9], v[142:143] op_sel_hi:[1,0,1]
    v_pk_mul_f32 v[224:225], v[140:141], v[10:11] op_sel_hi:[1,0]
    v_pk_mul_f32 v[226:227], v[142:143], v[10:11] op_sel_hi:[1,0]
    v_exp_f32 v224, v224
    v_exp_f32 v225, v225
    v_exp_f32 v226, v226
    v_exp_f32 v227, v227
    v_pk_fma_f32 v[228:229], v[52:53], v[8:9], v[228:229] op_sel_hi:[1,0,1]
    v_pk_fma_f32 v[230:231], v[54:55], v[8:9], v[230:231] op_sel_hi:[1,0,1]
    v_pk_fma_f32 v[224:225], v[224:225], v[12:13], v[12:13] op_sel_hi:[1,0,0]
    v_pk_fma_f32 v[226:227], v[226:227], v[12:13], v[12:13] op_sel_hi:[1,0,0]
    v_pk_mul_f32 v[228:229], v[228:229], v[140:141]
    v_pk_mul_f32 v[230:231], v[230:231], v[142:143]
    v_rcp_f32 v224, v224
    v_rcp_f32 v225, v225
    v_rcp_f32 v226, v226
    v_rcp_f32 v227, v227
    s_nop 0
    v_pk_mul_f32 v[228:229], v[228:229], v[224:225]
    v_pk_mul_f32 v[230:231], v[230:231], v[226:227]
    v_cvt_pk_bf16_f32 v244, v228, v229
    v_cvt_pk_bf16_f32 v245, v230, v231
    v_accvgpr_read_b32 v236, a108
    v_accvgpr_read_b32 v237, a109
    v_accvgpr_read_b32 v238, a110
    v_accvgpr_read_b32 v239, a111
    v_pk_fma_f32 v[172:173], v[56:57], v[8:9], v[172:173] op_sel_hi:[1,0,1]
    v_pk_fma_f32 v[174:175], v[58:59], v[8:9], v[174:175] op_sel_hi:[1,0,1]
    v_pk_mul_f32 v[232:233], v[172:173], v[10:11] op_sel_hi:[1,0]
    v_pk_mul_f32 v[234:235], v[174:175], v[10:11] op_sel_hi:[1,0]
    v_exp_f32 v232, v232
    v_exp_f32 v233, v233
    v_exp_f32 v234, v234
    v_exp_f32 v235, v235
    v_pk_fma_f32 v[236:237], v[60:61], v[8:9], v[236:237] op_sel_hi:[1,0,1]
    v_pk_fma_f32 v[238:239], v[62:63], v[8:9], v[238:239] op_sel_hi:[1,0,1]
    v_pk_fma_f32 v[232:233], v[232:233], v[12:13], v[12:13] op_sel_hi:[1,0,0]
    v_pk_fma_f32 v[234:235], v[234:235], v[12:13], v[12:13] op_sel_hi:[1,0,0]
    v_pk_mul_f32 v[236:237], v[236:237], v[172:173]
    v_pk_mul_f32 v[238:239], v[238:239], v[174:175]
    v_rcp_f32 v232, v232
    v_rcp_f32 v233, v233
    v_rcp_f32 v234, v234
    v_rcp_f32 v235, v235
    s_nop 0
    v_pk_mul_f32 v[236:237], v[236:237], v[232:233]
    v_pk_mul_f32 v[238:239], v[238:239], v[234:235]
    v_cvt_pk_bf16_f32 v246, v236, v237
    v_cvt_pk_bf16_f32 v247, v238, v239
    buffer_store_dwordx4 v[244:247], v3, s[28:31], 0 offen offset:1024
    v_add_u32 v3, 114688, v3
    v_sub_f32 v8, 0, v216
    v_rcp_f32 v10, v217
    v_mul_f32 v12, v217, v217
    v_mul_f32 v10, s56, v10
    v_accvgpr_read_b32 v228, a16
    v_accvgpr_read_b32 v229, a17
    v_accvgpr_read_b32 v230, a18
    v_accvgpr_read_b32 v231, a19
    v_pk_fma_f32 v[80:81], v[32:33], v[8:9], v[80:81] op_sel_hi:[1,0,1]
    v_pk_fma_f32 v[82:83], v[34:35], v[8:9], v[82:83] op_sel_hi:[1,0,1]
    v_pk_mul_f32 v[224:225], v[80:81], v[10:11] op_sel_hi:[1,0]
    v_pk_mul_f32 v[226:227], v[82:83], v[10:11] op_sel_hi:[1,0]
    v_exp_f32 v224, v224
    v_exp_f32 v225, v225
    v_exp_f32 v226, v226
    v_exp_f32 v227, v227
    v_pk_fma_f32 v[228:229], v[36:37], v[8:9], v[228:229] op_sel_hi:[1,0,1]
    v_pk_fma_f32 v[230:231], v[38:39], v[8:9], v[230:231] op_sel_hi:[1,0,1]
    v_pk_fma_f32 v[224:225], v[224:225], v[12:13], v[12:13] op_sel_hi:[1,0,0]
    v_pk_fma_f32 v[226:227], v[226:227], v[12:13], v[12:13] op_sel_hi:[1,0,0]
    v_pk_mul_f32 v[228:229], v[228:229], v[80:81]
    v_pk_mul_f32 v[230:231], v[230:231], v[82:83]
    v_rcp_f32 v224, v224
    v_rcp_f32 v225, v225
    v_rcp_f32 v226, v226
    v_rcp_f32 v227, v227
    s_nop 0
    v_pk_mul_f32 v[228:229], v[228:229], v[224:225]
    v_pk_mul_f32 v[230:231], v[230:231], v[226:227]
    v_cvt_pk_bf16_f32 v240, v228, v229
    v_cvt_pk_bf16_f32 v241, v230, v231
    v_accvgpr_read_b32 v236, a48
    v_accvgpr_read_b32 v237, a49
    v_accvgpr_read_b32 v238, a50
    v_accvgpr_read_b32 v239, a51
    v_pk_fma_f32 v[112:113], v[40:41], v[8:9], v[112:113] op_sel_hi:[1,0,1]
    v_pk_fma_f32 v[114:115], v[42:43], v[8:9], v[114:115] op_sel_hi:[1,0,1]
    v_pk_mul_f32 v[232:233], v[112:113], v[10:11] op_sel_hi:[1,0]
    v_pk_mul_f32 v[234:235], v[114:115], v[10:11] op_sel_hi:[1,0]
    v_exp_f32 v232, v232
    v_exp_f32 v233, v233
    v_exp_f32 v234, v234
    v_exp_f32 v235, v235
    v_pk_fma_f32 v[236:237], v[44:45], v[8:9], v[236:237] op_sel_hi:[1,0,1]
    v_pk_fma_f32 v[238:239], v[46:47], v[8:9], v[238:239] op_sel_hi:[1,0,1]
    v_pk_fma_f32 v[232:233], v[232:233], v[12:13], v[12:13] op_sel_hi:[1,0,0]
    v_pk_fma_f32 v[234:235], v[234:235], v[12:13], v[12:13] op_sel_hi:[1,0,0]
    v_pk_mul_f32 v[236:237], v[236:237], v[112:113]
    v_pk_mul_f32 v[238:239], v[238:239], v[114:115]
    v_rcp_f32 v232, v232
    v_rcp_f32 v233, v233
    v_rcp_f32 v234, v234
    v_rcp_f32 v235, v235
    s_nop 0
    v_pk_mul_f32 v[236:237], v[236:237], v[232:233]
    v_pk_mul_f32 v[238:239], v[238:239], v[234:235]
    v_cvt_pk_bf16_f32 v242, v236, v237
    v_cvt_pk_bf16_f32 v243, v238, v239
    buffer_store_dwordx4 v[240:243], v3, s[28:31], 0 offen offset:0
    v_accvgpr_read_b32 v228, a80
    v_accvgpr_read_b32 v229, a81
    v_accvgpr_read_b32 v230, a82
    v_accvgpr_read_b32 v231, a83
    v_pk_fma_f32 v[144:145], v[48:49], v[8:9], v[144:145] op_sel_hi:[1,0,1]
    v_pk_fma_f32 v[146:147], v[50:51], v[8:9], v[146:147] op_sel_hi:[1,0,1]
    v_pk_mul_f32 v[224:225], v[144:145], v[10:11] op_sel_hi:[1,0]
    v_pk_mul_f32 v[226:227], v[146:147], v[10:11] op_sel_hi:[1,0]
    v_exp_f32 v224, v224
    v_exp_f32 v225, v225
    v_exp_f32 v226, v226
    v_exp_f32 v227, v227
    v_pk_fma_f32 v[228:229], v[52:53], v[8:9], v[228:229] op_sel_hi:[1,0,1]
    v_pk_fma_f32 v[230:231], v[54:55], v[8:9], v[230:231] op_sel_hi:[1,0,1]
    v_pk_fma_f32 v[224:225], v[224:225], v[12:13], v[12:13] op_sel_hi:[1,0,0]
    v_pk_fma_f32 v[226:227], v[226:227], v[12:13], v[12:13] op_sel_hi:[1,0,0]
    v_pk_mul_f32 v[228:229], v[228:229], v[144:145]
    v_pk_mul_f32 v[230:231], v[230:231], v[146:147]
    v_rcp_f32 v224, v224
    v_rcp_f32 v225, v225
    v_rcp_f32 v226, v226
    v_rcp_f32 v227, v227
    s_nop 0
    v_pk_mul_f32 v[228:229], v[228:229], v[224:225]
    v_pk_mul_f32 v[230:231], v[230:231], v[226:227]
    v_cvt_pk_bf16_f32 v244, v228, v229
    v_cvt_pk_bf16_f32 v245, v230, v231
    v_accvgpr_read_b32 v236, a112
    v_accvgpr_read_b32 v237, a113
    v_accvgpr_read_b32 v238, a114
    v_accvgpr_read_b32 v239, a115
    v_pk_fma_f32 v[176:177], v[56:57], v[8:9], v[176:177] op_sel_hi:[1,0,1]
    v_pk_fma_f32 v[178:179], v[58:59], v[8:9], v[178:179] op_sel_hi:[1,0,1]
    v_pk_mul_f32 v[232:233], v[176:177], v[10:11] op_sel_hi:[1,0]
    v_pk_mul_f32 v[234:235], v[178:179], v[10:11] op_sel_hi:[1,0]
    v_exp_f32 v232, v232
    v_exp_f32 v233, v233
    v_exp_f32 v234, v234
    v_exp_f32 v235, v235
    v_pk_fma_f32 v[236:237], v[60:61], v[8:9], v[236:237] op_sel_hi:[1,0,1]
    v_pk_fma_f32 v[238:239], v[62:63], v[8:9], v[238:239] op_sel_hi:[1,0,1]
    v_pk_fma_f32 v[232:233], v[232:233], v[12:13], v[12:13] op_sel_hi:[1,0,0]
    v_pk_fma_f32 v[234:235], v[234:235], v[12:13], v[12:13] op_sel_hi:[1,0,0]
    v_pk_mul_f32 v[236:237], v[236:237], v[176:177]
    v_pk_mul_f32 v[238:239], v[238:239], v[178:179]
    v_rcp_f32 v232, v232
    v_rcp_f32 v233, v233
    v_rcp_f32 v234, v234
    v_rcp_f32 v235, v235
    s_nop 0
    v_pk_mul_f32 v[236:237], v[236:237], v[232:233]
    v_pk_mul_f32 v[238:239], v[238:239], v[234:235]
    v_cvt_pk_bf16_f32 v246, v236, v237
    v_cvt_pk_bf16_f32 v247, v238, v239
    buffer_store_dwordx4 v[244:247], v3, s[28:31], 0 offen offset:1024
    v_add_u32 v3, 114688, v3
    v_sub_f32 v8, 0, v218
    v_rcp_f32 v10, v219
    v_mul_f32 v12, v219, v219
    v_mul_f32 v10, s56, v10
    v_accvgpr_read_b32 v228, a20
    v_accvgpr_read_b32 v229, a21
    v_accvgpr_read_b32 v230, a22
    v_accvgpr_read_b32 v231, a23
    v_pk_fma_f32 v[84:85], v[32:33], v[8:9], v[84:85] op_sel_hi:[1,0,1]
    v_pk_fma_f32 v[86:87], v[34:35], v[8:9], v[86:87] op_sel_hi:[1,0,1]
    v_pk_mul_f32 v[224:225], v[84:85], v[10:11] op_sel_hi:[1,0]
    v_pk_mul_f32 v[226:227], v[86:87], v[10:11] op_sel_hi:[1,0]
    v_exp_f32 v224, v224
    v_exp_f32 v225, v225
    v_exp_f32 v226, v226
    v_exp_f32 v227, v227
    v_pk_fma_f32 v[228:229], v[36:37], v[8:9], v[228:229] op_sel_hi:[1,0,1]
    v_pk_fma_f32 v[230:231], v[38:39], v[8:9], v[230:231] op_sel_hi:[1,0,1]
    v_pk_fma_f32 v[224:225], v[224:225], v[12:13], v[12:13] op_sel_hi:[1,0,0]
    v_pk_fma_f32 v[226:227], v[226:227], v[12:13], v[12:13] op_sel_hi:[1,0,0]
    v_pk_mul_f32 v[228:229], v[228:229], v[84:85]
    v_pk_mul_f32 v[230:231], v[230:231], v[86:87]
    v_rcp_f32 v224, v224
    v_rcp_f32 v225, v225
    v_rcp_f32 v226, v226
    v_rcp_f32 v227, v227
    s_nop 0
    v_pk_mul_f32 v[228:229], v[228:229], v[224:225]
    v_pk_mul_f32 v[230:231], v[230:231], v[226:227]
    v_cvt_pk_bf16_f32 v240, v228, v229
    v_cvt_pk_bf16_f32 v241, v230, v231
    v_accvgpr_read_b32 v236, a52
    v_accvgpr_read_b32 v237, a53
    v_accvgpr_read_b32 v238, a54
    v_accvgpr_read_b32 v239, a55
    v_pk_fma_f32 v[116:117], v[40:41], v[8:9], v[116:117] op_sel_hi:[1,0,1]
    v_pk_fma_f32 v[118:119], v[42:43], v[8:9], v[118:119] op_sel_hi:[1,0,1]
    v_pk_mul_f32 v[232:233], v[116:117], v[10:11] op_sel_hi:[1,0]
    v_pk_mul_f32 v[234:235], v[118:119], v[10:11] op_sel_hi:[1,0]
    v_exp_f32 v232, v232
    v_exp_f32 v233, v233
    v_exp_f32 v234, v234
    v_exp_f32 v235, v235
    v_pk_fma_f32 v[236:237], v[44:45], v[8:9], v[236:237] op_sel_hi:[1,0,1]
    v_pk_fma_f32 v[238:239], v[46:47], v[8:9], v[238:239] op_sel_hi:[1,0,1]
    v_pk_fma_f32 v[232:233], v[232:233], v[12:13], v[12:13] op_sel_hi:[1,0,0]
    v_pk_fma_f32 v[234:235], v[234:235], v[12:13], v[12:13] op_sel_hi:[1,0,0]
    v_pk_mul_f32 v[236:237], v[236:237], v[116:117]
    v_pk_mul_f32 v[238:239], v[238:239], v[118:119]
    v_rcp_f32 v232, v232
    v_rcp_f32 v233, v233
    v_rcp_f32 v234, v234
    v_rcp_f32 v235, v235
    s_nop 0
    v_pk_mul_f32 v[236:237], v[236:237], v[232:233]
    v_pk_mul_f32 v[238:239], v[238:239], v[234:235]
    v_cvt_pk_bf16_f32 v242, v236, v237
    v_cvt_pk_bf16_f32 v243, v238, v239
    buffer_store_dwordx4 v[240:243], v3, s[28:31], 0 offen offset:0
    v_accvgpr_read_b32 v228, a84
    v_accvgpr_read_b32 v229, a85
    v_accvgpr_read_b32 v230, a86
    v_accvgpr_read_b32 v231, a87
    v_pk_fma_f32 v[148:149], v[48:49], v[8:9], v[148:149] op_sel_hi:[1,0,1]
    v_pk_fma_f32 v[150:151], v[50:51], v[8:9], v[150:151] op_sel_hi:[1,0,1]
    v_pk_mul_f32 v[224:225], v[148:149], v[10:11] op_sel_hi:[1,0]
    v_pk_mul_f32 v[226:227], v[150:151], v[10:11] op_sel_hi:[1,0]
    v_exp_f32 v224, v224
    v_exp_f32 v225, v225
    v_exp_f32 v226, v226
    v_exp_f32 v227, v227
    v_pk_fma_f32 v[228:229], v[52:53], v[8:9], v[228:229] op_sel_hi:[1,0,1]
    v_pk_fma_f32 v[230:231], v[54:55], v[8:9], v[230:231] op_sel_hi:[1,0,1]
    v_pk_fma_f32 v[224:225], v[224:225], v[12:13], v[12:13] op_sel_hi:[1,0,0]
    v_pk_fma_f32 v[226:227], v[226:227], v[12:13], v[12:13] op_sel_hi:[1,0,0]
    v_pk_mul_f32 v[228:229], v[228:229], v[148:149]
    v_pk_mul_f32 v[230:231], v[230:231], v[150:151]
    v_rcp_f32 v224, v224
    v_rcp_f32 v225, v225
    v_rcp_f32 v226, v226
    v_rcp_f32 v227, v227
    s_nop 0
    v_pk_mul_f32 v[228:229], v[228:229], v[224:225]
    v_pk_mul_f32 v[230:231], v[230:231], v[226:227]
    v_cvt_pk_bf16_f32 v244, v228, v229
    v_cvt_pk_bf16_f32 v245, v230, v231
    v_accvgpr_read_b32 v236, a116
    v_accvgpr_read_b32 v237, a117
    v_accvgpr_read_b32 v238, a118
    v_accvgpr_read_b32 v239, a119
    v_pk_fma_f32 v[180:181], v[56:57], v[8:9], v[180:181] op_sel_hi:[1,0,1]
    v_pk_fma_f32 v[182:183], v[58:59], v[8:9], v[182:183] op_sel_hi:[1,0,1]
    v_pk_mul_f32 v[232:233], v[180:181], v[10:11] op_sel_hi:[1,0]
    v_pk_mul_f32 v[234:235], v[182:183], v[10:11] op_sel_hi:[1,0]
    v_exp_f32 v232, v232
    v_exp_f32 v233, v233
    v_exp_f32 v234, v234
    v_exp_f32 v235, v235
    v_pk_fma_f32 v[236:237], v[60:61], v[8:9], v[236:237] op_sel_hi:[1,0,1]
    v_pk_fma_f32 v[238:239], v[62:63], v[8:9], v[238:239] op_sel_hi:[1,0,1]
    v_pk_fma_f32 v[232:233], v[232:233], v[12:13], v[12:13] op_sel_hi:[1,0,0]
    v_pk_fma_f32 v[234:235], v[234:235], v[12:13], v[12:13] op_sel_hi:[1,0,0]
    v_pk_mul_f32 v[236:237], v[236:237], v[180:181]
    v_pk_mul_f32 v[238:239], v[238:239], v[182:183]
    v_rcp_f32 v232, v232
    v_rcp_f32 v233, v233
    v_rcp_f32 v234, v234
    v_rcp_f32 v235, v235
    s_nop 0
    v_pk_mul_f32 v[236:237], v[236:237], v[232:233]
    v_pk_mul_f32 v[238:239], v[238:239], v[234:235]
    v_cvt_pk_bf16_f32 v246, v236, v237
    v_cvt_pk_bf16_f32 v247, v238, v239
    buffer_store_dwordx4 v[244:247], v3, s[28:31], 0 offen offset:1024
    v_add_u32 v3, 114688, v3
    v_sub_f32 v8, 0, v220
    v_rcp_f32 v10, v221
    v_mul_f32 v12, v221, v221
    v_mul_f32 v10, s56, v10
    v_accvgpr_read_b32 v228, a24
    v_accvgpr_read_b32 v229, a25
    v_accvgpr_read_b32 v230, a26
    v_accvgpr_read_b32 v231, a27
    v_pk_fma_f32 v[88:89], v[32:33], v[8:9], v[88:89] op_sel_hi:[1,0,1]
    v_pk_fma_f32 v[90:91], v[34:35], v[8:9], v[90:91] op_sel_hi:[1,0,1]
    v_pk_mul_f32 v[224:225], v[88:89], v[10:11] op_sel_hi:[1,0]
    v_pk_mul_f32 v[226:227], v[90:91], v[10:11] op_sel_hi:[1,0]
    v_exp_f32 v224, v224
    v_exp_f32 v225, v225
    v_exp_f32 v226, v226
    v_exp_f32 v227, v227
    v_pk_fma_f32 v[228:229], v[36:37], v[8:9], v[228:229] op_sel_hi:[1,0,1]
    v_pk_fma_f32 v[230:231], v[38:39], v[8:9], v[230:231] op_sel_hi:[1,0,1]
    v_pk_fma_f32 v[224:225], v[224:225], v[12:13], v[12:13] op_sel_hi:[1,0,0]
    v_pk_fma_f32 v[226:227], v[226:227], v[12:13], v[12:13] op_sel_hi:[1,0,0]
    v_pk_mul_f32 v[228:229], v[228:229], v[88:89]
    v_pk_mul_f32 v[230:231], v[230:231], v[90:91]
    v_rcp_f32 v224, v224
    v_rcp_f32 v225, v225
    v_rcp_f32 v226, v226
    v_rcp_f32 v227, v227
    s_nop 0
    v_pk_mul_f32 v[228:229], v[228:229], v[224:225]
    v_pk_mul_f32 v[230:231], v[230:231], v[226:227]
    v_cvt_pk_bf16_f32 v240, v228, v229
    v_cvt_pk_bf16_f32 v241, v230, v231
    v_accvgpr_read_b32 v236, a56
    v_accvgpr_read_b32 v237, a57
    v_accvgpr_read_b32 v238, a58
    v_accvgpr_read_b32 v239, a59
    v_pk_fma_f32 v[120:121], v[40:41], v[8:9], v[120:121] op_sel_hi:[1,0,1]
    v_pk_fma_f32 v[122:123], v[42:43], v[8:9], v[122:123] op_sel_hi:[1,0,1]
    v_pk_mul_f32 v[232:233], v[120:121], v[10:11] op_sel_hi:[1,0]
    v_pk_mul_f32 v[234:235], v[122:123], v[10:11] op_sel_hi:[1,0]
    v_exp_f32 v232, v232
    v_exp_f32 v233, v233
    v_exp_f32 v234, v234
    v_exp_f32 v235, v235
    v_pk_fma_f32 v[236:237], v[44:45], v[8:9], v[236:237] op_sel_hi:[1,0,1]
    v_pk_fma_f32 v[238:239], v[46:47], v[8:9], v[238:239] op_sel_hi:[1,0,1]
    v_pk_fma_f32 v[232:233], v[232:233], v[12:13], v[12:13] op_sel_hi:[1,0,0]
    v_pk_fma_f32 v[234:235], v[234:235], v[12:13], v[12:13] op_sel_hi:[1,0,0]
    v_pk_mul_f32 v[236:237], v[236:237], v[120:121]
    v_pk_mul_f32 v[238:239], v[238:239], v[122:123]
    v_rcp_f32 v232, v232
    v_rcp_f32 v233, v233
    v_rcp_f32 v234, v234
    v_rcp_f32 v235, v235
    s_nop 0
    v_pk_mul_f32 v[236:237], v[236:237], v[232:233]
    v_pk_mul_f32 v[238:239], v[238:239], v[234:235]
    v_cvt_pk_bf16_f32 v242, v236, v237
    v_cvt_pk_bf16_f32 v243, v238, v239
    buffer_store_dwordx4 v[240:243], v3, s[28:31], 0 offen offset:0
    v_accvgpr_read_b32 v228, a88
    v_accvgpr_read_b32 v229, a89
    v_accvgpr_read_b32 v230, a90
    v_accvgpr_read_b32 v231, a91
    v_pk_fma_f32 v[152:153], v[48:49], v[8:9], v[152:153] op_sel_hi:[1,0,1]
    v_pk_fma_f32 v[154:155], v[50:51], v[8:9], v[154:155] op_sel_hi:[1,0,1]
    v_pk_mul_f32 v[224:225], v[152:153], v[10:11] op_sel_hi:[1,0]
    v_pk_mul_f32 v[226:227], v[154:155], v[10:11] op_sel_hi:[1,0]
    v_exp_f32 v224, v224
    v_exp_f32 v225, v225
    v_exp_f32 v226, v226
    v_exp_f32 v227, v227
    v_pk_fma_f32 v[228:229], v[52:53], v[8:9], v[228:229] op_sel_hi:[1,0,1]
    v_pk_fma_f32 v[230:231], v[54:55], v[8:9], v[230:231] op_sel_hi:[1,0,1]
    v_pk_fma_f32 v[224:225], v[224:225], v[12:13], v[12:13] op_sel_hi:[1,0,0]
    v_pk_fma_f32 v[226:227], v[226:227], v[12:13], v[12:13] op_sel_hi:[1,0,0]
    v_pk_mul_f32 v[228:229], v[228:229], v[152:153]
    v_pk_mul_f32 v[230:231], v[230:231], v[154:155]
    v_rcp_f32 v224, v224
    v_rcp_f32 v225, v225
    v_rcp_f32 v226, v226
    v_rcp_f32 v227, v227
    s_nop 0
    v_pk_mul_f32 v[228:229], v[228:229], v[224:225]
    v_pk_mul_f32 v[230:231], v[230:231], v[226:227]
    v_cvt_pk_bf16_f32 v244, v228, v229
    v_cvt_pk_bf16_f32 v245, v230, v231
    v_accvgpr_read_b32 v236, a120
    v_accvgpr_read_b32 v237, a121
    v_accvgpr_read_b32 v238, a122
    v_accvgpr_read_b32 v239, a123
    v_pk_fma_f32 v[184:185], v[56:57], v[8:9], v[184:185] op_sel_hi:[1,0,1]
    v_pk_fma_f32 v[186:187], v[58:59], v[8:9], v[186:187] op_sel_hi:[1,0,1]
    v_pk_mul_f32 v[232:233], v[184:185], v[10:11] op_sel_hi:[1,0]
    v_pk_mul_f32 v[234:235], v[186:187], v[10:11] op_sel_hi:[1,0]
    v_exp_f32 v232, v232
    v_exp_f32 v233, v233
    v_exp_f32 v234, v234
    v_exp_f32 v235, v235
    v_pk_fma_f32 v[236:237], v[60:61], v[8:9], v[236:237] op_sel_hi:[1,0,1]
    v_pk_fma_f32 v[238:239], v[62:63], v[8:9], v[238:239] op_sel_hi:[1,0,1]
    v_pk_fma_f32 v[232:233], v[232:233], v[12:13], v[12:13] op_sel_hi:[1,0,0]
    v_pk_fma_f32 v[234:235], v[234:235], v[12:13], v[12:13] op_sel_hi:[1,0,0]
    v_pk_mul_f32 v[236:237], v[236:237], v[184:185]
    v_pk_mul_f32 v[238:239], v[238:239], v[186:187]
    v_rcp_f32 v232, v232
    v_rcp_f32 v233, v233
    v_rcp_f32 v234, v234
    v_rcp_f32 v235, v235
    s_nop 0
    v_pk_mul_f32 v[236:237], v[236:237], v[232:233]
    v_pk_mul_f32 v[238:239], v[238:239], v[234:235]
    v_cvt_pk_bf16_f32 v246, v236, v237
    v_cvt_pk_bf16_f32 v247, v238, v239
    buffer_store_dwordx4 v[244:247], v3, s[28:31], 0 offen offset:1024
    v_add_u32 v3, 114688, v3
    v_sub_f32 v8, 0, v222
    v_rcp_f32 v10, v223
    v_mul_f32 v12, v223, v223
    v_mul_f32 v10, s56, v10
    v_accvgpr_read_b32 v228, a28
    v_accvgpr_read_b32 v229, a29
    v_accvgpr_read_b32 v230, a30
    v_accvgpr_read_b32 v231, a31
    v_pk_fma_f32 v[92:93], v[32:33], v[8:9], v[92:93] op_sel_hi:[1,0,1]
    v_pk_fma_f32 v[94:95], v[34:35], v[8:9], v[94:95] op_sel_hi:[1,0,1]
    v_pk_mul_f32 v[224:225], v[92:93], v[10:11] op_sel_hi:[1,0]
    v_pk_mul_f32 v[226:227], v[94:95], v[10:11] op_sel_hi:[1,0]
    v_exp_f32 v224, v224
    v_exp_f32 v225, v225
    v_exp_f32 v226, v226
    v_exp_f32 v227, v227
    v_pk_fma_f32 v[228:229], v[36:37], v[8:9], v[228:229] op_sel_hi:[1,0,1]
    v_pk_fma_f32 v[230:231], v[38:39], v[8:9], v[230:231] op_sel_hi:[1,0,1]
    v_pk_fma_f32 v[224:225], v[224:225], v[12:13], v[12:13] op_sel_hi:[1,0,0]
    v_pk_fma_f32 v[226:227], v[226:227], v[12:13], v[12:13] op_sel_hi:[1,0,0]
    v_pk_mul_f32 v[228:229], v[228:229], v[92:93]
    v_pk_mul_f32 v[230:231], v[230:231], v[94:95]
    v_rcp_f32 v224, v224
    v_rcp_f32 v225, v225
    v_rcp_f32 v226, v226
    v_rcp_f32 v227, v227
    s_nop 0
    v_pk_mul_f32 v[228:229], v[228:229], v[224:225]
    v_pk_mul_f32 v[230:231], v[230:231], v[226:227]
    v_cvt_pk_bf16_f32 v240, v228, v229
    v_cvt_pk_bf16_f32 v241, v230, v231
    v_accvgpr_read_b32 v236, a60
    v_accvgpr_read_b32 v237, a61
    v_accvgpr_read_b32 v238, a62
    v_accvgpr_read_b32 v239, a63
    v_pk_fma_f32 v[124:125], v[40:41], v[8:9], v[124:125] op_sel_hi:[1,0,1]
    v_pk_fma_f32 v[126:127], v[42:43], v[8:9], v[126:127] op_sel_hi:[1,0,1]
    v_pk_mul_f32 v[232:233], v[124:125], v[10:11] op_sel_hi:[1,0]
    v_pk_mul_f32 v[234:235], v[126:127], v[10:11] op_sel_hi:[1,0]
    v_exp_f32 v232, v232
    v_exp_f32 v233, v233
    v_exp_f32 v234, v234
    v_exp_f32 v235, v235
    v_pk_fma_f32 v[236:237], v[44:45], v[8:9], v[236:237] op_sel_hi:[1,0,1]
    v_pk_fma_f32 v[238:239], v[46:47], v[8:9], v[238:239] op_sel_hi:[1,0,1]
    v_pk_fma_f32 v[232:233], v[232:233], v[12:13], v[12:13] op_sel_hi:[1,0,0]
    v_pk_fma_f32 v[234:235], v[234:235], v[12:13], v[12:13] op_sel_hi:[1,0,0]
    v_pk_mul_f32 v[236:237], v[236:237], v[124:125]
    v_pk_mul_f32 v[238:239], v[238:239], v[126:127]
    v_rcp_f32 v232, v232
    v_rcp_f32 v233, v233
    v_rcp_f32 v234, v234
    v_rcp_f32 v235, v235
    s_nop 0
    v_pk_mul_f32 v[236:237], v[236:237], v[232:233]
    v_pk_mul_f32 v[238:239], v[238:239], v[234:235]
    v_cvt_pk_bf16_f32 v242, v236, v237
    v_cvt_pk_bf16_f32 v243, v238, v239
    buffer_store_dwordx4 v[240:243], v3, s[28:31], 0 offen offset:0
    v_accvgpr_read_b32 v228, a92
    v_accvgpr_read_b32 v229, a93
    v_accvgpr_read_b32 v230, a94
    v_accvgpr_read_b32 v231, a95
    v_pk_fma_f32 v[156:157], v[48:49], v[8:9], v[156:157] op_sel_hi:[1,0,1]
    v_pk_fma_f32 v[158:159], v[50:51], v[8:9], v[158:159] op_sel_hi:[1,0,1]
    v_pk_mul_f32 v[224:225], v[156:157], v[10:11] op_sel_hi:[1,0]
    v_pk_mul_f32 v[226:227], v[158:159], v[10:11] op_sel_hi:[1,0]
    v_exp_f32 v224, v224
    v_exp_f32 v225, v225
    v_exp_f32 v226, v226
    v_exp_f32 v227, v227
    v_pk_fma_f32 v[228:229], v[52:53], v[8:9], v[228:229] op_sel_hi:[1,0,1]
    v_pk_fma_f32 v[230:231], v[54:55], v[8:9], v[230:231] op_sel_hi:[1,0,1]
    v_pk_fma_f32 v[224:225], v[224:225], v[12:13], v[12:13] op_sel_hi:[1,0,0]
    v_pk_fma_f32 v[226:227], v[226:227], v[12:13], v[12:13] op_sel_hi:[1,0,0]
    v_pk_mul_f32 v[228:229], v[228:229], v[156:157]
    v_pk_mul_f32 v[230:231], v[230:231], v[158:159]
    v_rcp_f32 v224, v224
    v_rcp_f32 v225, v225
    v_rcp_f32 v226, v226
    v_rcp_f32 v227, v227
    s_nop 0
    v_pk_mul_f32 v[228:229], v[228:229], v[224:225]
    v_pk_mul_f32 v[230:231], v[230:231], v[226:227]
    v_cvt_pk_bf16_f32 v244, v228, v229
    v_cvt_pk_bf16_f32 v245, v230, v231
    v_accvgpr_read_b32 v236, a124
    v_accvgpr_read_b32 v237, a125
    v_accvgpr_read_b32 v238, a126
    v_accvgpr_read_b32 v239, a127
    v_pk_fma_f32 v[188:189], v[56:57], v[8:9], v[188:189] op_sel_hi:[1,0,1]
    v_pk_fma_f32 v[190:191], v[58:59], v[8:9], v[190:191] op_sel_hi:[1,0,1]
    v_pk_mul_f32 v[232:233], v[188:189], v[10:11] op_sel_hi:[1,0]
    v_pk_mul_f32 v[234:235], v[190:191], v[10:11] op_sel_hi:[1,0]
    v_exp_f32 v232, v232
    v_exp_f32 v233, v233
    v_exp_f32 v234, v234
    v_exp_f32 v235, v235
    v_pk_fma_f32 v[236:237], v[60:61], v[8:9], v[236:237] op_sel_hi:[1,0,1]
    v_pk_fma_f32 v[238:239], v[62:63], v[8:9], v[238:239] op_sel_hi:[1,0,1]
    v_pk_fma_f32 v[232:233], v[232:233], v[12:13], v[12:13] op_sel_hi:[1,0,0]
    v_pk_fma_f32 v[234:235], v[234:235], v[12:13], v[12:13] op_sel_hi:[1,0,0]
    v_pk_mul_f32 v[236:237], v[236:237], v[188:189]
    v_pk_mul_f32 v[238:239], v[238:239], v[190:191]
    v_rcp_f32 v232, v232
    v_rcp_f32 v233, v233
    v_rcp_f32 v234, v234
    v_rcp_f32 v235, v235
    s_nop 0
    v_pk_mul_f32 v[236:237], v[236:237], v[232:233]
    v_pk_mul_f32 v[238:239], v[238:239], v[234:235]
    v_cvt_pk_bf16_f32 v246, v236, v237
    v_cvt_pk_bf16_f32 v247, v238, v239
    buffer_store_dwordx4 v[244:247], v3, s[28:31], 0 offen offset:1024
    s_endpgm
k1_kernel_helper:
    s_load_dwordx4 s[80:83], s[0:1], 16
    s_load_dwordx2 s[84:85], s[0:1], 32
    s_load_dwordx2 s[86:87], s[0:1], 72
    s_lshl_b32 s33, s2, 2
    s_add_u32 s33, s33, s32
    s_lshl_b32 s34, s33, 13
    v_lshlrev_b32 v3, 7, v2
    v_add_u32 v3, s34, v3
    s_waitcnt lgkmcnt(0)
    s_mov_b32 s8, s92
    s_mov_b32 s9, s93
    s_mov_b32 s10, 4194304
    s_mov_b32 s11, 0x00020000
    s_mov_b32 s12, s52
    s_mov_b32 s13, s53
    s_mov_b32 s14, 7340032
    s_mov_b32 s15, 0x00020000
    s_mov_b32 s16, s54
    s_mov_b32 s17, s55
    s_mov_b32 s18, 7340032
    s_mov_b32 s19, 0x00020000
    s_lshl_b32 s35, s33, 4
    v_and_b32 v4, 15, v2
    v_add_u32 v4, s35, v4
    v_lshlrev_b32 v4, 11, v4
    v_lshrrev_b32 v5, 4, v2
    v_lshl_add_u32 v4, v5, 4, v4
    buffer_load_dwordx4 v[64:67], v4, s[8:11], 0 offen offset:0
    buffer_load_dwordx4 v[68:71], v4, s[8:11], 0 offen offset:64
    buffer_load_dwordx4 v[72:75], v4, s[8:11], 0 offen offset:128
    buffer_load_dwordx4 v[76:79], v4, s[8:11], 0 offen offset:192
    buffer_load_dwordx4 v[80:83], v4, s[8:11], 0 offen offset:256
    buffer_load_dwordx4 v[84:87], v4, s[8:11], 0 offen offset:320
    buffer_load_dwordx4 v[88:91], v4, s[8:11], 0 offen offset:384
    buffer_load_dwordx4 v[92:95], v4, s[8:11], 0 offen offset:448
    buffer_load_dwordx4 v[96:99], v4, s[8:11], 0 offen offset:512
    buffer_load_dwordx4 v[100:103], v4, s[8:11], 0 offen offset:576
    buffer_load_dwordx4 v[104:107], v4, s[8:11], 0 offen offset:640
    buffer_load_dwordx4 v[108:111], v4, s[8:11], 0 offen offset:704
    buffer_load_dwordx4 v[112:115], v4, s[8:11], 0 offen offset:768
    buffer_load_dwordx4 v[116:119], v4, s[8:11], 0 offen offset:832
    buffer_load_dwordx4 v[120:123], v4, s[8:11], 0 offen offset:896
    buffer_load_dwordx4 v[124:127], v4, s[8:11], 0 offen offset:960
    buffer_load_dwordx4 v[128:131], v4, s[8:11], 0 offen offset:1024
    buffer_load_dwordx4 v[132:135], v4, s[8:11], 0 offen offset:1088
    buffer_load_dwordx4 v[136:139], v4, s[8:11], 0 offen offset:1152
    buffer_load_dwordx4 v[140:143], v4, s[8:11], 0 offen offset:1216
    buffer_load_dwordx4 v[144:147], v4, s[8:11], 0 offen offset:1280
    buffer_load_dwordx4 v[148:151], v4, s[8:11], 0 offen offset:1344
    buffer_load_dwordx4 v[152:155], v4, s[8:11], 0 offen offset:1408
    buffer_load_dwordx4 v[156:159], v4, s[8:11], 0 offen offset:1472
    buffer_load_dwordx4 v[160:163], v4, s[8:11], 0 offen offset:1536
    buffer_load_dwordx4 v[164:167], v4, s[8:11], 0 offen offset:1600
    buffer_load_dwordx4 v[168:171], v4, s[8:11], 0 offen offset:1664
    buffer_load_dwordx4 v[172:175], v4, s[8:11], 0 offen offset:1728
    buffer_load_dwordx4 v[176:179], v4, s[8:11], 0 offen offset:1792
    buffer_load_dwordx4 v[180:183], v4, s[8:11], 0 offen offset:1856
    buffer_load_dwordx4 v[184:187], v4, s[8:11], 0 offen offset:1920
    buffer_load_dwordx4 v[188:191], v4, s[8:11], 0 offen offset:1984
    s_mov_b32 s20, s94
    s_mov_b32 s21, s95
    s_mov_b32 s22, 4194304
    s_mov_b32 s23, 0x00020000
    s_mov_b32 s24, s80
    s_mov_b32 s25, s81
    s_mov_b32 s26, 4194304
    s_mov_b32 s27, 0x00020000
    v_mov_b32 v32, 0
    v_mov_b32 v33, 0
    v_mov_b32 v34, 0
    v_mov_b32 v35, 0
    s_waitcnt vmcnt(28)
    v_lshlrev_b32 v40, 16, v64
    v_and_b32 v41, 0xffff0000, v64
    v_pk_add_f32 v[32:33], v[32:33], v[40:41]
    v_lshlrev_b32 v42, 16, v65
    v_and_b32 v43, 0xffff0000, v65
    v_pk_add_f32 v[34:35], v[34:35], v[42:43]
    v_lshlrev_b32 v44, 16, v66
    v_and_b32 v45, 0xffff0000, v66
    v_pk_add_f32 v[32:33], v[32:33], v[44:45]
    v_lshlrev_b32 v46, 16, v67
    v_and_b32 v47, 0xffff0000, v67
    v_pk_add_f32 v[34:35], v[34:35], v[46:47]
    v_lshlrev_b32 v40, 16, v68
    v_and_b32 v41, 0xffff0000, v68
    v_pk_add_f32 v[32:33], v[32:33], v[40:41]
    v_lshlrev_b32 v42, 16, v69
    v_and_b32 v43, 0xffff0000, v69
    v_pk_add_f32 v[34:35], v[34:35], v[42:43]
    v_lshlrev_b32 v44, 16, v70
    v_and_b32 v45, 0xffff0000, v70
    v_pk_add_f32 v[32:33], v[32:33], v[44:45]
    v_lshlrev_b32 v46, 16, v71
    v_and_b32 v47, 0xffff0000, v71
    v_pk_add_f32 v[34:35], v[34:35], v[46:47]
    v_lshlrev_b32 v40, 16, v72
    v_and_b32 v41, 0xffff0000, v72
    v_pk_add_f32 v[32:33], v[32:33], v[40:41]
    v_lshlrev_b32 v42, 16, v73
    v_and_b32 v43, 0xffff0000, v73
    v_pk_add_f32 v[34:35], v[34:35], v[42:43]
    v_lshlrev_b32 v44, 16, v74
    v_and_b32 v45, 0xffff0000, v74
    v_pk_add_f32 v[32:33], v[32:33], v[44:45]
    v_lshlrev_b32 v46, 16, v75
    v_and_b32 v47, 0xffff0000, v75
    v_pk_add_f32 v[34:35], v[34:35], v[46:47]
    v_lshlrev_b32 v40, 16, v76
    v_and_b32 v41, 0xffff0000, v76
    v_pk_add_f32 v[32:33], v[32:33], v[40:41]
    v_lshlrev_b32 v42, 16, v77
    v_and_b32 v43, 0xffff0000, v77
    v_pk_add_f32 v[34:35], v[34:35], v[42:43]
    v_lshlrev_b32 v44, 16, v78
    v_and_b32 v45, 0xffff0000, v78
    v_pk_add_f32 v[32:33], v[32:33], v[44:45]
    v_lshlrev_b32 v46, 16, v79
    v_and_b32 v47, 0xffff0000, v79
    v_pk_add_f32 v[34:35], v[34:35], v[46:47]
    s_waitcnt vmcnt(24)
    v_lshlrev_b32 v40, 16, v80
    v_and_b32 v41, 0xffff0000, v80
    v_pk_add_f32 v[32:33], v[32:33], v[40:41]
    v_lshlrev_b32 v42, 16, v81
    v_and_b32 v43, 0xffff0000, v81
    v_pk_add_f32 v[34:35], v[34:35], v[42:43]
    v_lshlrev_b32 v44, 16, v82
    v_and_b32 v45, 0xffff0000, v82
    v_pk_add_f32 v[32:33], v[32:33], v[44:45]
    v_lshlrev_b32 v46, 16, v83
    v_and_b32 v47, 0xffff0000, v83
    v_pk_add_f32 v[34:35], v[34:35], v[46:47]
    v_lshlrev_b32 v40, 16, v84
    v_and_b32 v41, 0xffff0000, v84
    v_pk_add_f32 v[32:33], v[32:33], v[40:41]
    v_lshlrev_b32 v42, 16, v85
    v_and_b32 v43, 0xffff0000, v85
    v_pk_add_f32 v[34:35], v[34:35], v[42:43]
    v_lshlrev_b32 v44, 16, v86
    v_and_b32 v45, 0xffff0000, v86
    v_pk_add_f32 v[32:33], v[32:33], v[44:45]
    v_lshlrev_b32 v46, 16, v87
    v_and_b32 v47, 0xffff0000, v87
    v_pk_add_f32 v[34:35], v[34:35], v[46:47]
    v_lshlrev_b32 v40, 16, v88
    v_and_b32 v41, 0xffff0000, v88
    v_pk_add_f32 v[32:33], v[32:33], v[40:41]
    v_lshlrev_b32 v42, 16, v89
    v_and_b32 v43, 0xffff0000, v89
    v_pk_add_f32 v[34:35], v[34:35], v[42:43]
    v_lshlrev_b32 v44, 16, v90
    v_and_b32 v45, 0xffff0000, v90
    v_pk_add_f32 v[32:33], v[32:33], v[44:45]
    v_lshlrev_b32 v46, 16, v91
    v_and_b32 v47, 0xffff0000, v91
    v_pk_add_f32 v[34:35], v[34:35], v[46:47]
    v_lshlrev_b32 v40, 16, v92
    v_and_b32 v41, 0xffff0000, v92
    v_pk_add_f32 v[32:33], v[32:33], v[40:41]
    v_lshlrev_b32 v42, 16, v93
    v_and_b32 v43, 0xffff0000, v93
    v_pk_add_f32 v[34:35], v[34:35], v[42:43]
    v_lshlrev_b32 v44, 16, v94
    v_and_b32 v45, 0xffff0000, v94
    v_pk_add_f32 v[32:33], v[32:33], v[44:45]
    v_lshlrev_b32 v46, 16, v95
    v_and_b32 v47, 0xffff0000, v95
    v_pk_add_f32 v[34:35], v[34:35], v[46:47]
    s_waitcnt vmcnt(20)
    v_lshlrev_b32 v40, 16, v96
    v_and_b32 v41, 0xffff0000, v96
    v_pk_add_f32 v[32:33], v[32:33], v[40:41]
    v_lshlrev_b32 v42, 16, v97
    v_and_b32 v43, 0xffff0000, v97
    v_pk_add_f32 v[34:35], v[34:35], v[42:43]
    v_lshlrev_b32 v44, 16, v98
    v_and_b32 v45, 0xffff0000, v98
    v_pk_add_f32 v[32:33], v[32:33], v[44:45]
    v_lshlrev_b32 v46, 16, v99
    v_and_b32 v47, 0xffff0000, v99
    v_pk_add_f32 v[34:35], v[34:35], v[46:47]
    v_lshlrev_b32 v40, 16, v100
    v_and_b32 v41, 0xffff0000, v100
    v_pk_add_f32 v[32:33], v[32:33], v[40:41]
    v_lshlrev_b32 v42, 16, v101
    v_and_b32 v43, 0xffff0000, v101
    v_pk_add_f32 v[34:35], v[34:35], v[42:43]
    v_lshlrev_b32 v44, 16, v102
    v_and_b32 v45, 0xffff0000, v102
    v_pk_add_f32 v[32:33], v[32:33], v[44:45]
    v_lshlrev_b32 v46, 16, v103
    v_and_b32 v47, 0xffff0000, v103
    v_pk_add_f32 v[34:35], v[34:35], v[46:47]
    v_lshlrev_b32 v40, 16, v104
    v_and_b32 v41, 0xffff0000, v104
    v_pk_add_f32 v[32:33], v[32:33], v[40:41]
    v_lshlrev_b32 v42, 16, v105
    v_and_b32 v43, 0xffff0000, v105
    v_pk_add_f32 v[34:35], v[34:35], v[42:43]
    v_lshlrev_b32 v44, 16, v106
    v_and_b32 v45, 0xffff0000, v106
    v_pk_add_f32 v[32:33], v[32:33], v[44:45]
    v_lshlrev_b32 v46, 16, v107
    v_and_b32 v47, 0xffff0000, v107
    v_pk_add_f32 v[34:35], v[34:35], v[46:47]
    v_lshlrev_b32 v40, 16, v108
    v_and_b32 v41, 0xffff0000, v108
    v_pk_add_f32 v[32:33], v[32:33], v[40:41]
    v_lshlrev_b32 v42, 16, v109
    v_and_b32 v43, 0xffff0000, v109
    v_pk_add_f32 v[34:35], v[34:35], v[42:43]
    v_lshlrev_b32 v44, 16, v110
    v_and_b32 v45, 0xffff0000, v110
    v_pk_add_f32 v[32:33], v[32:33], v[44:45]
    v_lshlrev_b32 v46, 16, v111
    v_and_b32 v47, 0xffff0000, v111
    v_pk_add_f32 v[34:35], v[34:35], v[46:47]
    s_waitcnt vmcnt(16)
    v_lshlrev_b32 v40, 16, v112
    v_and_b32 v41, 0xffff0000, v112
    v_pk_add_f32 v[32:33], v[32:33], v[40:41]
    v_lshlrev_b32 v42, 16, v113
    v_and_b32 v43, 0xffff0000, v113
    v_pk_add_f32 v[34:35], v[34:35], v[42:43]
    v_lshlrev_b32 v44, 16, v114
    v_and_b32 v45, 0xffff0000, v114
    v_pk_add_f32 v[32:33], v[32:33], v[44:45]
    v_lshlrev_b32 v46, 16, v115
    v_and_b32 v47, 0xffff0000, v115
    v_pk_add_f32 v[34:35], v[34:35], v[46:47]
    v_lshlrev_b32 v40, 16, v116
    v_and_b32 v41, 0xffff0000, v116
    v_pk_add_f32 v[32:33], v[32:33], v[40:41]
    v_lshlrev_b32 v42, 16, v117
    v_and_b32 v43, 0xffff0000, v117
    v_pk_add_f32 v[34:35], v[34:35], v[42:43]
    v_lshlrev_b32 v44, 16, v118
    v_and_b32 v45, 0xffff0000, v118
    v_pk_add_f32 v[32:33], v[32:33], v[44:45]
    v_lshlrev_b32 v46, 16, v119
    v_and_b32 v47, 0xffff0000, v119
    v_pk_add_f32 v[34:35], v[34:35], v[46:47]
    v_lshlrev_b32 v40, 16, v120
    v_and_b32 v41, 0xffff0000, v120
    v_pk_add_f32 v[32:33], v[32:33], v[40:41]
    v_lshlrev_b32 v42, 16, v121
    v_and_b32 v43, 0xffff0000, v121
    v_pk_add_f32 v[34:35], v[34:35], v[42:43]
    v_lshlrev_b32 v44, 16, v122
    v_and_b32 v45, 0xffff0000, v122
    v_pk_add_f32 v[32:33], v[32:33], v[44:45]
    v_lshlrev_b32 v46, 16, v123
    v_and_b32 v47, 0xffff0000, v123
    v_pk_add_f32 v[34:35], v[34:35], v[46:47]
    v_lshlrev_b32 v40, 16, v124
    v_and_b32 v41, 0xffff0000, v124
    v_pk_add_f32 v[32:33], v[32:33], v[40:41]
    v_lshlrev_b32 v42, 16, v125
    v_and_b32 v43, 0xffff0000, v125
    v_pk_add_f32 v[34:35], v[34:35], v[42:43]
    v_lshlrev_b32 v44, 16, v126
    v_and_b32 v45, 0xffff0000, v126
    v_pk_add_f32 v[32:33], v[32:33], v[44:45]
    v_lshlrev_b32 v46, 16, v127
    v_and_b32 v47, 0xffff0000, v127
    v_pk_add_f32 v[34:35], v[34:35], v[46:47]
    s_waitcnt vmcnt(12)
    v_lshlrev_b32 v40, 16, v128
    v_and_b32 v41, 0xffff0000, v128
    v_pk_add_f32 v[32:33], v[32:33], v[40:41]
    v_lshlrev_b32 v42, 16, v129
    v_and_b32 v43, 0xffff0000, v129
    v_pk_add_f32 v[34:35], v[34:35], v[42:43]
    v_lshlrev_b32 v44, 16, v130
    v_and_b32 v45, 0xffff0000, v130
    v_pk_add_f32 v[32:33], v[32:33], v[44:45]
    v_lshlrev_b32 v46, 16, v131
    v_and_b32 v47, 0xffff0000, v131
    v_pk_add_f32 v[34:35], v[34:35], v[46:47]
    v_lshlrev_b32 v40, 16, v132
    v_and_b32 v41, 0xffff0000, v132
    v_pk_add_f32 v[32:33], v[32:33], v[40:41]
    v_lshlrev_b32 v42, 16, v133
    v_and_b32 v43, 0xffff0000, v133
    v_pk_add_f32 v[34:35], v[34:35], v[42:43]
    v_lshlrev_b32 v44, 16, v134
    v_and_b32 v45, 0xffff0000, v134
    v_pk_add_f32 v[32:33], v[32:33], v[44:45]
    v_lshlrev_b32 v46, 16, v135
    v_and_b32 v47, 0xffff0000, v135
    v_pk_add_f32 v[34:35], v[34:35], v[46:47]
    v_lshlrev_b32 v40, 16, v136
    v_and_b32 v41, 0xffff0000, v136
    v_pk_add_f32 v[32:33], v[32:33], v[40:41]
    v_lshlrev_b32 v42, 16, v137
    v_and_b32 v43, 0xffff0000, v137
    v_pk_add_f32 v[34:35], v[34:35], v[42:43]
    v_lshlrev_b32 v44, 16, v138
    v_and_b32 v45, 0xffff0000, v138
    v_pk_add_f32 v[32:33], v[32:33], v[44:45]
    v_lshlrev_b32 v46, 16, v139
    v_and_b32 v47, 0xffff0000, v139
    v_pk_add_f32 v[34:35], v[34:35], v[46:47]
    v_lshlrev_b32 v40, 16, v140
    v_and_b32 v41, 0xffff0000, v140
    v_pk_add_f32 v[32:33], v[32:33], v[40:41]
    v_lshlrev_b32 v42, 16, v141
    v_and_b32 v43, 0xffff0000, v141
    v_pk_add_f32 v[34:35], v[34:35], v[42:43]
    v_lshlrev_b32 v44, 16, v142
    v_and_b32 v45, 0xffff0000, v142
    v_pk_add_f32 v[32:33], v[32:33], v[44:45]
    v_lshlrev_b32 v46, 16, v143
    v_and_b32 v47, 0xffff0000, v143
    v_pk_add_f32 v[34:35], v[34:35], v[46:47]
    s_waitcnt vmcnt(8)
    v_lshlrev_b32 v40, 16, v144
    v_and_b32 v41, 0xffff0000, v144
    v_pk_add_f32 v[32:33], v[32:33], v[40:41]
    v_lshlrev_b32 v42, 16, v145
    v_and_b32 v43, 0xffff0000, v145
    v_pk_add_f32 v[34:35], v[34:35], v[42:43]
    v_lshlrev_b32 v44, 16, v146
    v_and_b32 v45, 0xffff0000, v146
    v_pk_add_f32 v[32:33], v[32:33], v[44:45]
    v_lshlrev_b32 v46, 16, v147
    v_and_b32 v47, 0xffff0000, v147
    v_pk_add_f32 v[34:35], v[34:35], v[46:47]
    v_lshlrev_b32 v40, 16, v148
    v_and_b32 v41, 0xffff0000, v148
    v_pk_add_f32 v[32:33], v[32:33], v[40:41]
    v_lshlrev_b32 v42, 16, v149
    v_and_b32 v43, 0xffff0000, v149
    v_pk_add_f32 v[34:35], v[34:35], v[42:43]
    v_lshlrev_b32 v44, 16, v150
    v_and_b32 v45, 0xffff0000, v150
    v_pk_add_f32 v[32:33], v[32:33], v[44:45]
    v_lshlrev_b32 v46, 16, v151
    v_and_b32 v47, 0xffff0000, v151
    v_pk_add_f32 v[34:35], v[34:35], v[46:47]
    v_lshlrev_b32 v40, 16, v152
    v_and_b32 v41, 0xffff0000, v152
    v_pk_add_f32 v[32:33], v[32:33], v[40:41]
    v_lshlrev_b32 v42, 16, v153
    v_and_b32 v43, 0xffff0000, v153
    v_pk_add_f32 v[34:35], v[34:35], v[42:43]
    v_lshlrev_b32 v44, 16, v154
    v_and_b32 v45, 0xffff0000, v154
    v_pk_add_f32 v[32:33], v[32:33], v[44:45]
    v_lshlrev_b32 v46, 16, v155
    v_and_b32 v47, 0xffff0000, v155
    v_pk_add_f32 v[34:35], v[34:35], v[46:47]
    v_lshlrev_b32 v40, 16, v156
    v_and_b32 v41, 0xffff0000, v156
    v_pk_add_f32 v[32:33], v[32:33], v[40:41]
    v_lshlrev_b32 v42, 16, v157
    v_and_b32 v43, 0xffff0000, v157
    v_pk_add_f32 v[34:35], v[34:35], v[42:43]
    v_lshlrev_b32 v44, 16, v158
    v_and_b32 v45, 0xffff0000, v158
    v_pk_add_f32 v[32:33], v[32:33], v[44:45]
    v_lshlrev_b32 v46, 16, v159
    v_and_b32 v47, 0xffff0000, v159
    v_pk_add_f32 v[34:35], v[34:35], v[46:47]
    s_waitcnt vmcnt(4)
    v_lshlrev_b32 v40, 16, v160
    v_and_b32 v41, 0xffff0000, v160
    v_pk_add_f32 v[32:33], v[32:33], v[40:41]
    v_lshlrev_b32 v42, 16, v161
    v_and_b32 v43, 0xffff0000, v161
    v_pk_add_f32 v[34:35], v[34:35], v[42:43]
    v_lshlrev_b32 v44, 16, v162
    v_and_b32 v45, 0xffff0000, v162
    v_pk_add_f32 v[32:33], v[32:33], v[44:45]
    v_lshlrev_b32 v46, 16, v163
    v_and_b32 v47, 0xffff0000, v163
    v_pk_add_f32 v[34:35], v[34:35], v[46:47]
    v_lshlrev_b32 v40, 16, v164
    v_and_b32 v41, 0xffff0000, v164
    v_pk_add_f32 v[32:33], v[32:33], v[40:41]
    v_lshlrev_b32 v42, 16, v165
    v_and_b32 v43, 0xffff0000, v165
    v_pk_add_f32 v[34:35], v[34:35], v[42:43]
    v_lshlrev_b32 v44, 16, v166
    v_and_b32 v45, 0xffff0000, v166
    v_pk_add_f32 v[32:33], v[32:33], v[44:45]
    v_lshlrev_b32 v46, 16, v167
    v_and_b32 v47, 0xffff0000, v167
    v_pk_add_f32 v[34:35], v[34:35], v[46:47]
    v_lshlrev_b32 v40, 16, v168
    v_and_b32 v41, 0xffff0000, v168
    v_pk_add_f32 v[32:33], v[32:33], v[40:41]
    v_lshlrev_b32 v42, 16, v169
    v_and_b32 v43, 0xffff0000, v169
    v_pk_add_f32 v[34:35], v[34:35], v[42:43]
    v_lshlrev_b32 v44, 16, v170
    v_and_b32 v45, 0xffff0000, v170
    v_pk_add_f32 v[32:33], v[32:33], v[44:45]
    v_lshlrev_b32 v46, 16, v171
    v_and_b32 v47, 0xffff0000, v171
    v_pk_add_f32 v[34:35], v[34:35], v[46:47]
    v_lshlrev_b32 v40, 16, v172
    v_and_b32 v41, 0xffff0000, v172
    v_pk_add_f32 v[32:33], v[32:33], v[40:41]
    v_lshlrev_b32 v42, 16, v173
    v_and_b32 v43, 0xffff0000, v173
    v_pk_add_f32 v[34:35], v[34:35], v[42:43]
    v_lshlrev_b32 v44, 16, v174
    v_and_b32 v45, 0xffff0000, v174
    v_pk_add_f32 v[32:33], v[32:33], v[44:45]
    v_lshlrev_b32 v46, 16, v175
    v_and_b32 v47, 0xffff0000, v175
    v_pk_add_f32 v[34:35], v[34:35], v[46:47]
    s_waitcnt vmcnt(0)
    v_lshlrev_b32 v40, 16, v176
    v_and_b32 v41, 0xffff0000, v176
    v_pk_add_f32 v[32:33], v[32:33], v[40:41]
    v_lshlrev_b32 v42, 16, v177
    v_and_b32 v43, 0xffff0000, v177
    v_pk_add_f32 v[34:35], v[34:35], v[42:43]
    v_lshlrev_b32 v44, 16, v178
    v_and_b32 v45, 0xffff0000, v178
    v_pk_add_f32 v[32:33], v[32:33], v[44:45]
    v_lshlrev_b32 v46, 16, v179
    v_and_b32 v47, 0xffff0000, v179
    v_pk_add_f32 v[34:35], v[34:35], v[46:47]
    v_lshlrev_b32 v40, 16, v180
    v_and_b32 v41, 0xffff0000, v180
    v_pk_add_f32 v[32:33], v[32:33], v[40:41]
    v_lshlrev_b32 v42, 16, v181
    v_and_b32 v43, 0xffff0000, v181
    v_pk_add_f32 v[34:35], v[34:35], v[42:43]
    v_lshlrev_b32 v44, 16, v182
    v_and_b32 v45, 0xffff0000, v182
    v_pk_add_f32 v[32:33], v[32:33], v[44:45]
    v_lshlrev_b32 v46, 16, v183
    v_and_b32 v47, 0xffff0000, v183
    v_pk_add_f32 v[34:35], v[34:35], v[46:47]
    v_lshlrev_b32 v40, 16, v184
    v_and_b32 v41, 0xffff0000, v184
    v_pk_add_f32 v[32:33], v[32:33], v[40:41]
    v_lshlrev_b32 v42, 16, v185
    v_and_b32 v43, 0xffff0000, v185
    v_pk_add_f32 v[34:35], v[34:35], v[42:43]
    v_lshlrev_b32 v44, 16, v186
    v_and_b32 v45, 0xffff0000, v186
    v_pk_add_f32 v[32:33], v[32:33], v[44:45]
    v_lshlrev_b32 v46, 16, v187
    v_and_b32 v47, 0xffff0000, v187
    v_pk_add_f32 v[34:35], v[34:35], v[46:47]
    v_lshlrev_b32 v40, 16, v188
    v_and_b32 v41, 0xffff0000, v188
    v_pk_add_f32 v[32:33], v[32:33], v[40:41]
    v_lshlrev_b32 v42, 16, v189
    v_and_b32 v43, 0xffff0000, v189
    v_pk_add_f32 v[34:35], v[34:35], v[42:43]
    v_lshlrev_b32 v44, 16, v190
    v_and_b32 v45, 0xffff0000, v190
    v_pk_add_f32 v[32:33], v[32:33], v[44:45]
    v_lshlrev_b32 v46, 16, v191
    v_and_b32 v47, 0xffff0000, v191
    v_pk_add_f32 v[34:35], v[34:35], v[46:47]
    v_pk_add_f32 v[32:33], v[32:33], v[34:35]
    v_add_f32 v48, v32, v33
    v_mov_b32 v49, v48
    s_nop 1
    v_permlane16_swap_b32 v48, v49
    s_nop 1
    v_add_f32 v48, v48, v49
    v_mov_b32 v49, v48
    s_nop 1
    v_permlane32_swap_b32 v48, v49
    s_nop 1
    v_add_f32 v48, v48, v49
    v_mul_f32 v48, 0x3a800000, v48
    v_sub_f32 v50, 0, v48
    v_mov_b32 v32, 0
    v_mov_b32 v33, 0
    v_mov_b32 v34, 0
    v_mov_b32 v35, 0
    v_lshlrev_b32 v40, 16, v64
    v_and_b32 v41, 0xffff0000, v64
    v_pk_add_f32 v[40:41], v[40:41], v[50:51] op_sel_hi:[1,0]
    v_pk_fma_f32 v[32:33], v[40:41], v[40:41], v[32:33]
    v_lshlrev_b32 v42, 16, v65
    v_and_b32 v43, 0xffff0000, v65
    v_pk_add_f32 v[42:43], v[42:43], v[50:51] op_sel_hi:[1,0]
    v_pk_fma_f32 v[34:35], v[42:43], v[42:43], v[34:35]
    v_lshlrev_b32 v44, 16, v66
    v_and_b32 v45, 0xffff0000, v66
    v_pk_add_f32 v[44:45], v[44:45], v[50:51] op_sel_hi:[1,0]
    v_pk_fma_f32 v[32:33], v[44:45], v[44:45], v[32:33]
    v_lshlrev_b32 v46, 16, v67
    v_and_b32 v47, 0xffff0000, v67
    v_pk_add_f32 v[46:47], v[46:47], v[50:51] op_sel_hi:[1,0]
    v_pk_fma_f32 v[34:35], v[46:47], v[46:47], v[34:35]
    v_lshlrev_b32 v40, 16, v68
    v_and_b32 v41, 0xffff0000, v68
    v_pk_add_f32 v[40:41], v[40:41], v[50:51] op_sel_hi:[1,0]
    v_pk_fma_f32 v[32:33], v[40:41], v[40:41], v[32:33]
    v_lshlrev_b32 v42, 16, v69
    v_and_b32 v43, 0xffff0000, v69
    v_pk_add_f32 v[42:43], v[42:43], v[50:51] op_sel_hi:[1,0]
    v_pk_fma_f32 v[34:35], v[42:43], v[42:43], v[34:35]
    v_lshlrev_b32 v44, 16, v70
    v_and_b32 v45, 0xffff0000, v70
    v_pk_add_f32 v[44:45], v[44:45], v[50:51] op_sel_hi:[1,0]
    v_pk_fma_f32 v[32:33], v[44:45], v[44:45], v[32:33]
    v_lshlrev_b32 v46, 16, v71
    v_and_b32 v47, 0xffff0000, v71
    v_pk_add_f32 v[46:47], v[46:47], v[50:51] op_sel_hi:[1,0]
    v_pk_fma_f32 v[34:35], v[46:47], v[46:47], v[34:35]
    v_lshlrev_b32 v40, 16, v72
    v_and_b32 v41, 0xffff0000, v72
    v_pk_add_f32 v[40:41], v[40:41], v[50:51] op_sel_hi:[1,0]
    v_pk_fma_f32 v[32:33], v[40:41], v[40:41], v[32:33]
    v_lshlrev_b32 v42, 16, v73
    v_and_b32 v43, 0xffff0000, v73
    v_pk_add_f32 v[42:43], v[42:43], v[50:51] op_sel_hi:[1,0]
    v_pk_fma_f32 v[34:35], v[42:43], v[42:43], v[34:35]
    v_lshlrev_b32 v44, 16, v74
    v_and_b32 v45, 0xffff0000, v74
    v_pk_add_f32 v[44:45], v[44:45], v[50:51] op_sel_hi:[1,0]
    v_pk_fma_f32 v[32:33], v[44:45], v[44:45], v[32:33]
    v_lshlrev_b32 v46, 16, v75
    v_and_b32 v47, 0xffff0000, v75
    v_pk_add_f32 v[46:47], v[46:47], v[50:51] op_sel_hi:[1,0]
    v_pk_fma_f32 v[34:35], v[46:47], v[46:47], v[34:35]
    v_lshlrev_b32 v40, 16, v76
    v_and_b32 v41, 0xffff0000, v76
    v_pk_add_f32 v[40:41], v[40:41], v[50:51] op_sel_hi:[1,0]
    v_pk_fma_f32 v[32:33], v[40:41], v[40:41], v[32:33]
    v_lshlrev_b32 v42, 16, v77
    v_and_b32 v43, 0xffff0000, v77
    v_pk_add_f32 v[42:43], v[42:43], v[50:51] op_sel_hi:[1,0]
    v_pk_fma_f32 v[34:35], v[42:43], v[42:43], v[34:35]
    v_lshlrev_b32 v44, 16, v78
    v_and_b32 v45, 0xffff0000, v78
    v_pk_add_f32 v[44:45], v[44:45], v[50:51] op_sel_hi:[1,0]
    v_pk_fma_f32 v[32:33], v[44:45], v[44:45], v[32:33]
    v_lshlrev_b32 v46, 16, v79
    v_and_b32 v47, 0xffff0000, v79
    v_pk_add_f32 v[46:47], v[46:47], v[50:51] op_sel_hi:[1,0]
    v_pk_fma_f32 v[34:35], v[46:47], v[46:47], v[34:35]
    v_lshlrev_b32 v40, 16, v80
    v_and_b32 v41, 0xffff0000, v80
    v_pk_add_f32 v[40:41], v[40:41], v[50:51] op_sel_hi:[1,0]
    v_pk_fma_f32 v[32:33], v[40:41], v[40:41], v[32:33]
    v_lshlrev_b32 v42, 16, v81
    v_and_b32 v43, 0xffff0000, v81
    v_pk_add_f32 v[42:43], v[42:43], v[50:51] op_sel_hi:[1,0]
    v_pk_fma_f32 v[34:35], v[42:43], v[42:43], v[34:35]
    v_lshlrev_b32 v44, 16, v82
    v_and_b32 v45, 0xffff0000, v82
    v_pk_add_f32 v[44:45], v[44:45], v[50:51] op_sel_hi:[1,0]
    v_pk_fma_f32 v[32:33], v[44:45], v[44:45], v[32:33]
    v_lshlrev_b32 v46, 16, v83
    v_and_b32 v47, 0xffff0000, v83
    v_pk_add_f32 v[46:47], v[46:47], v[50:51] op_sel_hi:[1,0]
    v_pk_fma_f32 v[34:35], v[46:47], v[46:47], v[34:35]
    v_lshlrev_b32 v40, 16, v84
    v_and_b32 v41, 0xffff0000, v84
    v_pk_add_f32 v[40:41], v[40:41], v[50:51] op_sel_hi:[1,0]
    v_pk_fma_f32 v[32:33], v[40:41], v[40:41], v[32:33]
    v_lshlrev_b32 v42, 16, v85
    v_and_b32 v43, 0xffff0000, v85
    v_pk_add_f32 v[42:43], v[42:43], v[50:51] op_sel_hi:[1,0]
    v_pk_fma_f32 v[34:35], v[42:43], v[42:43], v[34:35]
    v_lshlrev_b32 v44, 16, v86
    v_and_b32 v45, 0xffff0000, v86
    v_pk_add_f32 v[44:45], v[44:45], v[50:51] op_sel_hi:[1,0]
    v_pk_fma_f32 v[32:33], v[44:45], v[44:45], v[32:33]
    v_lshlrev_b32 v46, 16, v87
    v_and_b32 v47, 0xffff0000, v87
    v_pk_add_f32 v[46:47], v[46:47], v[50:51] op_sel_hi:[1,0]
    v_pk_fma_f32 v[34:35], v[46:47], v[46:47], v[34:35]
    v_lshlrev_b32 v40, 16, v88
    v_and_b32 v41, 0xffff0000, v88
    v_pk_add_f32 v[40:41], v[40:41], v[50:51] op_sel_hi:[1,0]
    v_pk_fma_f32 v[32:33], v[40:41], v[40:41], v[32:33]
    v_lshlrev_b32 v42, 16, v89
    v_and_b32 v43, 0xffff0000, v89
    v_pk_add_f32 v[42:43], v[42:43], v[50:51] op_sel_hi:[1,0]
    v_pk_fma_f32 v[34:35], v[42:43], v[42:43], v[34:35]
    v_lshlrev_b32 v44, 16, v90
    v_and_b32 v45, 0xffff0000, v90
    v_pk_add_f32 v[44:45], v[44:45], v[50:51] op_sel_hi:[1,0]
    v_pk_fma_f32 v[32:33], v[44:45], v[44:45], v[32:33]
    v_lshlrev_b32 v46, 16, v91
    v_and_b32 v47, 0xffff0000, v91
    v_pk_add_f32 v[46:47], v[46:47], v[50:51] op_sel_hi:[1,0]
    v_pk_fma_f32 v[34:35], v[46:47], v[46:47], v[34:35]
    v_lshlrev_b32 v40, 16, v92
    v_and_b32 v41, 0xffff0000, v92
    v_pk_add_f32 v[40:41], v[40:41], v[50:51] op_sel_hi:[1,0]
    v_pk_fma_f32 v[32:33], v[40:41], v[40:41], v[32:33]
    v_lshlrev_b32 v42, 16, v93
    v_and_b32 v43, 0xffff0000, v93
    v_pk_add_f32 v[42:43], v[42:43], v[50:51] op_sel_hi:[1,0]
    v_pk_fma_f32 v[34:35], v[42:43], v[42:43], v[34:35]
    v_lshlrev_b32 v44, 16, v94
    v_and_b32 v45, 0xffff0000, v94
    v_pk_add_f32 v[44:45], v[44:45], v[50:51] op_sel_hi:[1,0]
    v_pk_fma_f32 v[32:33], v[44:45], v[44:45], v[32:33]
    v_lshlrev_b32 v46, 16, v95
    v_and_b32 v47, 0xffff0000, v95
    v_pk_add_f32 v[46:47], v[46:47], v[50:51] op_sel_hi:[1,0]
    v_pk_fma_f32 v[34:35], v[46:47], v[46:47], v[34:35]
    v_lshlrev_b32 v40, 16, v96
    v_and_b32 v41, 0xffff0000, v96
    v_pk_add_f32 v[40:41], v[40:41], v[50:51] op_sel_hi:[1,0]
    v_pk_fma_f32 v[32:33], v[40:41], v[40:41], v[32:33]
    v_lshlrev_b32 v42, 16, v97
    v_and_b32 v43, 0xffff0000, v97
    v_pk_add_f32 v[42:43], v[42:43], v[50:51] op_sel_hi:[1,0]
    v_pk_fma_f32 v[34:35], v[42:43], v[42:43], v[34:35]
    v_lshlrev_b32 v44, 16, v98
    v_and_b32 v45, 0xffff0000, v98
    v_pk_add_f32 v[44:45], v[44:45], v[50:51] op_sel_hi:[1,0]
    v_pk_fma_f32 v[32:33], v[44:45], v[44:45], v[32:33]
    v_lshlrev_b32 v46, 16, v99
    v_and_b32 v47, 0xffff0000, v99
    v_pk_add_f32 v[46:47], v[46:47], v[50:51] op_sel_hi:[1,0]
    v_pk_fma_f32 v[34:35], v[46:47], v[46:47], v[34:35]
    v_lshlrev_b32 v40, 16, v100
    v_and_b32 v41, 0xffff0000, v100
    v_pk_add_f32 v[40:41], v[40:41], v[50:51] op_sel_hi:[1,0]
    v_pk_fma_f32 v[32:33], v[40:41], v[40:41], v[32:33]
    v_lshlrev_b32 v42, 16, v101
    v_and_b32 v43, 0xffff0000, v101
    v_pk_add_f32 v[42:43], v[42:43], v[50:51] op_sel_hi:[1,0]
    v_pk_fma_f32 v[34:35], v[42:43], v[42:43], v[34:35]
    v_lshlrev_b32 v44, 16, v102
    v_and_b32 v45, 0xffff0000, v102
    v_pk_add_f32 v[44:45], v[44:45], v[50:51] op_sel_hi:[1,0]
    v_pk_fma_f32 v[32:33], v[44:45], v[44:45], v[32:33]
    v_lshlrev_b32 v46, 16, v103
    v_and_b32 v47, 0xffff0000, v103
    v_pk_add_f32 v[46:47], v[46:47], v[50:51] op_sel_hi:[1,0]
    v_pk_fma_f32 v[34:35], v[46:47], v[46:47], v[34:35]
    v_lshlrev_b32 v40, 16, v104
    v_and_b32 v41, 0xffff0000, v104
    v_pk_add_f32 v[40:41], v[40:41], v[50:51] op_sel_hi:[1,0]
    v_pk_fma_f32 v[32:33], v[40:41], v[40:41], v[32:33]
    v_lshlrev_b32 v42, 16, v105
    v_and_b32 v43, 0xffff0000, v105
    v_pk_add_f32 v[42:43], v[42:43], v[50:51] op_sel_hi:[1,0]
    v_pk_fma_f32 v[34:35], v[42:43], v[42:43], v[34:35]
    v_lshlrev_b32 v44, 16, v106
    v_and_b32 v45, 0xffff0000, v106
    v_pk_add_f32 v[44:45], v[44:45], v[50:51] op_sel_hi:[1,0]
    v_pk_fma_f32 v[32:33], v[44:45], v[44:45], v[32:33]
    v_lshlrev_b32 v46, 16, v107
    v_and_b32 v47, 0xffff0000, v107
    v_pk_add_f32 v[46:47], v[46:47], v[50:51] op_sel_hi:[1,0]
    v_pk_fma_f32 v[34:35], v[46:47], v[46:47], v[34:35]
    v_lshlrev_b32 v40, 16, v108
    v_and_b32 v41, 0xffff0000, v108
    v_pk_add_f32 v[40:41], v[40:41], v[50:51] op_sel_hi:[1,0]
    v_pk_fma_f32 v[32:33], v[40:41], v[40:41], v[32:33]
    v_lshlrev_b32 v42, 16, v109
    v_and_b32 v43, 0xffff0000, v109
    v_pk_add_f32 v[42:43], v[42:43], v[50:51] op_sel_hi:[1,0]
    v_pk_fma_f32 v[34:35], v[42:43], v[42:43], v[34:35]
    v_lshlrev_b32 v44, 16, v110
    v_and_b32 v45, 0xffff0000, v110
    v_pk_add_f32 v[44:45], v[44:45], v[50:51] op_sel_hi:[1,0]
    v_pk_fma_f32 v[32:33], v[44:45], v[44:45], v[32:33]
    v_lshlrev_b32 v46, 16, v111
    v_and_b32 v47, 0xffff0000, v111
    v_pk_add_f32 v[46:47], v[46:47], v[50:51] op_sel_hi:[1,0]
    v_pk_fma_f32 v[34:35], v[46:47], v[46:47], v[34:35]
    v_lshlrev_b32 v40, 16, v112
    v_and_b32 v41, 0xffff0000, v112
    v_pk_add_f32 v[40:41], v[40:41], v[50:51] op_sel_hi:[1,0]
    v_pk_fma_f32 v[32:33], v[40:41], v[40:41], v[32:33]
    v_lshlrev_b32 v42, 16, v113
    v_and_b32 v43, 0xffff0000, v113
    v_pk_add_f32 v[42:43], v[42:43], v[50:51] op_sel_hi:[1,0]
    v_pk_fma_f32 v[34:35], v[42:43], v[42:43], v[34:35]
    v_lshlrev_b32 v44, 16, v114
    v_and_b32 v45, 0xffff0000, v114
    v_pk_add_f32 v[44:45], v[44:45], v[50:51] op_sel_hi:[1,0]
    v_pk_fma_f32 v[32:33], v[44:45], v[44:45], v[32:33]
    v_lshlrev_b32 v46, 16, v115
    v_and_b32 v47, 0xffff0000, v115
    v_pk_add_f32 v[46:47], v[46:47], v[50:51] op_sel_hi:[1,0]
    v_pk_fma_f32 v[34:35], v[46:47], v[46:47], v[34:35]
    v_lshlrev_b32 v40, 16, v116
    v_and_b32 v41, 0xffff0000, v116
    v_pk_add_f32 v[40:41], v[40:41], v[50:51] op_sel_hi:[1,0]
    v_pk_fma_f32 v[32:33], v[40:41], v[40:41], v[32:33]
    v_lshlrev_b32 v42, 16, v117
    v_and_b32 v43, 0xffff0000, v117
    v_pk_add_f32 v[42:43], v[42:43], v[50:51] op_sel_hi:[1,0]
    v_pk_fma_f32 v[34:35], v[42:43], v[42:43], v[34:35]
    v_lshlrev_b32 v44, 16, v118
    v_and_b32 v45, 0xffff0000, v118
    v_pk_add_f32 v[44:45], v[44:45], v[50:51] op_sel_hi:[1,0]
    v_pk_fma_f32 v[32:33], v[44:45], v[44:45], v[32:33]
    v_lshlrev_b32 v46, 16, v119
    v_and_b32 v47, 0xffff0000, v119
    v_pk_add_f32 v[46:47], v[46:47], v[50:51] op_sel_hi:[1,0]
    v_pk_fma_f32 v[34:35], v[46:47], v[46:47], v[34:35]
    v_lshlrev_b32 v40, 16, v120
    v_and_b32 v41, 0xffff0000, v120
    v_pk_add_f32 v[40:41], v[40:41], v[50:51] op_sel_hi:[1,0]
    v_pk_fma_f32 v[32:33], v[40:41], v[40:41], v[32:33]
    v_lshlrev_b32 v42, 16, v121
    v_and_b32 v43, 0xffff0000, v121
    v_pk_add_f32 v[42:43], v[42:43], v[50:51] op_sel_hi:[1,0]
    v_pk_fma_f32 v[34:35], v[42:43], v[42:43], v[34:35]
    v_lshlrev_b32 v44, 16, v122
    v_and_b32 v45, 0xffff0000, v122
    v_pk_add_f32 v[44:45], v[44:45], v[50:51] op_sel_hi:[1,0]
    v_pk_fma_f32 v[32:33], v[44:45], v[44:45], v[32:33]
    v_lshlrev_b32 v46, 16, v123
    v_and_b32 v47, 0xffff0000, v123
    v_pk_add_f32 v[46:47], v[46:47], v[50:51] op_sel_hi:[1,0]
    v_pk_fma_f32 v[34:35], v[46:47], v[46:47], v[34:35]
    v_lshlrev_b32 v40, 16, v124
    v_and_b32 v41, 0xffff0000, v124
    v_pk_add_f32 v[40:41], v[40:41], v[50:51] op_sel_hi:[1,0]
    v_pk_fma_f32 v[32:33], v[40:41], v[40:41], v[32:33]
    v_lshlrev_b32 v42, 16, v125
    v_and_b32 v43, 0xffff0000, v125
    v_pk_add_f32 v[42:43], v[42:43], v[50:51] op_sel_hi:[1,0]
    v_pk_fma_f32 v[34:35], v[42:43], v[42:43], v[34:35]
    v_lshlrev_b32 v44, 16, v126
    v_and_b32 v45, 0xffff0000, v126
    v_pk_add_f32 v[44:45], v[44:45], v[50:51] op_sel_hi:[1,0]
    v_pk_fma_f32 v[32:33], v[44:45], v[44:45], v[32:33]
    v_lshlrev_b32 v46, 16, v127
    v_and_b32 v47, 0xffff0000, v127
    v_pk_add_f32 v[46:47], v[46:47], v[50:51] op_sel_hi:[1,0]
    v_pk_fma_f32 v[34:35], v[46:47], v[46:47], v[34:35]
    v_lshlrev_b32 v40, 16, v128
    v_and_b32 v41, 0xffff0000, v128
    v_pk_add_f32 v[40:41], v[40:41], v[50:51] op_sel_hi:[1,0]
    v_pk_fma_f32 v[32:33], v[40:41], v[40:41], v[32:33]
    v_lshlrev_b32 v42, 16, v129
    v_and_b32 v43, 0xffff0000, v129
    v_pk_add_f32 v[42:43], v[42:43], v[50:51] op_sel_hi:[1,0]
    v_pk_fma_f32 v[34:35], v[42:43], v[42:43], v[34:35]
    v_lshlrev_b32 v44, 16, v130
    v_and_b32 v45, 0xffff0000, v130
    v_pk_add_f32 v[44:45], v[44:45], v[50:51] op_sel_hi:[1,0]
    v_pk_fma_f32 v[32:33], v[44:45], v[44:45], v[32:33]
    v_lshlrev_b32 v46, 16, v131
    v_and_b32 v47, 0xffff0000, v131
    v_pk_add_f32 v[46:47], v[46:47], v[50:51] op_sel_hi:[1,0]
    v_pk_fma_f32 v[34:35], v[46:47], v[46:47], v[34:35]
    v_lshlrev_b32 v40, 16, v132
    v_and_b32 v41, 0xffff0000, v132
    v_pk_add_f32 v[40:41], v[40:41], v[50:51] op_sel_hi:[1,0]
    v_pk_fma_f32 v[32:33], v[40:41], v[40:41], v[32:33]
    v_lshlrev_b32 v42, 16, v133
    v_and_b32 v43, 0xffff0000, v133
    v_pk_add_f32 v[42:43], v[42:43], v[50:51] op_sel_hi:[1,0]
    v_pk_fma_f32 v[34:35], v[42:43], v[42:43], v[34:35]
    v_lshlrev_b32 v44, 16, v134
    v_and_b32 v45, 0xffff0000, v134
    v_pk_add_f32 v[44:45], v[44:45], v[50:51] op_sel_hi:[1,0]
    v_pk_fma_f32 v[32:33], v[44:45], v[44:45], v[32:33]
    v_lshlrev_b32 v46, 16, v135
    v_and_b32 v47, 0xffff0000, v135
    v_pk_add_f32 v[46:47], v[46:47], v[50:51] op_sel_hi:[1,0]
    v_pk_fma_f32 v[34:35], v[46:47], v[46:47], v[34:35]
    v_lshlrev_b32 v40, 16, v136
    v_and_b32 v41, 0xffff0000, v136
    v_pk_add_f32 v[40:41], v[40:41], v[50:51] op_sel_hi:[1,0]
    v_pk_fma_f32 v[32:33], v[40:41], v[40:41], v[32:33]
    v_lshlrev_b32 v42, 16, v137
    v_and_b32 v43, 0xffff0000, v137
    v_pk_add_f32 v[42:43], v[42:43], v[50:51] op_sel_hi:[1,0]
    v_pk_fma_f32 v[34:35], v[42:43], v[42:43], v[34:35]
    v_lshlrev_b32 v44, 16, v138
    v_and_b32 v45, 0xffff0000, v138
    v_pk_add_f32 v[44:45], v[44:45], v[50:51] op_sel_hi:[1,0]
    v_pk_fma_f32 v[32:33], v[44:45], v[44:45], v[32:33]
    v_lshlrev_b32 v46, 16, v139
    v_and_b32 v47, 0xffff0000, v139
    v_pk_add_f32 v[46:47], v[46:47], v[50:51] op_sel_hi:[1,0]
    v_pk_fma_f32 v[34:35], v[46:47], v[46:47], v[34:35]
    v_lshlrev_b32 v40, 16, v140
    v_and_b32 v41, 0xffff0000, v140
    v_pk_add_f32 v[40:41], v[40:41], v[50:51] op_sel_hi:[1,0]
    v_pk_fma_f32 v[32:33], v[40:41], v[40:41], v[32:33]
    v_lshlrev_b32 v42, 16, v141
    v_and_b32 v43, 0xffff0000, v141
    v_pk_add_f32 v[42:43], v[42:43], v[50:51] op_sel_hi:[1,0]
    v_pk_fma_f32 v[34:35], v[42:43], v[42:43], v[34:35]
    v_lshlrev_b32 v44, 16, v142
    v_and_b32 v45, 0xffff0000, v142
    v_pk_add_f32 v[44:45], v[44:45], v[50:51] op_sel_hi:[1,0]
    v_pk_fma_f32 v[32:33], v[44:45], v[44:45], v[32:33]
    v_lshlrev_b32 v46, 16, v143
    v_and_b32 v47, 0xffff0000, v143
    v_pk_add_f32 v[46:47], v[46:47], v[50:51] op_sel_hi:[1,0]
    v_pk_fma_f32 v[34:35], v[46:47], v[46:47], v[34:35]
    v_lshlrev_b32 v40, 16, v144
    v_and_b32 v41, 0xffff0000, v144
    v_pk_add_f32 v[40:41], v[40:41], v[50:51] op_sel_hi:[1,0]
    v_pk_fma_f32 v[32:33], v[40:41], v[40:41], v[32:33]
    v_lshlrev_b32 v42, 16, v145
    v_and_b32 v43, 0xffff0000, v145
    v_pk_add_f32 v[42:43], v[42:43], v[50:51] op_sel_hi:[1,0]
    v_pk_fma_f32 v[34:35], v[42:43], v[42:43], v[34:35]
    v_lshlrev_b32 v44, 16, v146
    v_and_b32 v45, 0xffff0000, v146
    v_pk_add_f32 v[44:45], v[44:45], v[50:51] op_sel_hi:[1,0]
    v_pk_fma_f32 v[32:33], v[44:45], v[44:45], v[32:33]
    v_lshlrev_b32 v46, 16, v147
    v_and_b32 v47, 0xffff0000, v147
    v_pk_add_f32 v[46:47], v[46:47], v[50:51] op_sel_hi:[1,0]
    v_pk_fma_f32 v[34:35], v[46:47], v[46:47], v[34:35]
    v_lshlrev_b32 v40, 16, v148
    v_and_b32 v41, 0xffff0000, v148
    v_pk_add_f32 v[40:41], v[40:41], v[50:51] op_sel_hi:[1,0]
    v_pk_fma_f32 v[32:33], v[40:41], v[40:41], v[32:33]
    v_lshlrev_b32 v42, 16, v149
    v_and_b32 v43, 0xffff0000, v149
    v_pk_add_f32 v[42:43], v[42:43], v[50:51] op_sel_hi:[1,0]
    v_pk_fma_f32 v[34:35], v[42:43], v[42:43], v[34:35]
    v_lshlrev_b32 v44, 16, v150
    v_and_b32 v45, 0xffff0000, v150
    v_pk_add_f32 v[44:45], v[44:45], v[50:51] op_sel_hi:[1,0]
    v_pk_fma_f32 v[32:33], v[44:45], v[44:45], v[32:33]
    v_lshlrev_b32 v46, 16, v151
    v_and_b32 v47, 0xffff0000, v151
    v_pk_add_f32 v[46:47], v[46:47], v[50:51] op_sel_hi:[1,0]
    v_pk_fma_f32 v[34:35], v[46:47], v[46:47], v[34:35]
    v_lshlrev_b32 v40, 16, v152
    v_and_b32 v41, 0xffff0000, v152
    v_pk_add_f32 v[40:41], v[40:41], v[50:51] op_sel_hi:[1,0]
    v_pk_fma_f32 v[32:33], v[40:41], v[40:41], v[32:33]
    v_lshlrev_b32 v42, 16, v153
    v_and_b32 v43, 0xffff0000, v153
    v_pk_add_f32 v[42:43], v[42:43], v[50:51] op_sel_hi:[1,0]
    v_pk_fma_f32 v[34:35], v[42:43], v[42:43], v[34:35]
    v_lshlrev_b32 v44, 16, v154
    v_and_b32 v45, 0xffff0000, v154
    v_pk_add_f32 v[44:45], v[44:45], v[50:51] op_sel_hi:[1,0]
    v_pk_fma_f32 v[32:33], v[44:45], v[44:45], v[32:33]
    v_lshlrev_b32 v46, 16, v155
    v_and_b32 v47, 0xffff0000, v155
    v_pk_add_f32 v[46:47], v[46:47], v[50:51] op_sel_hi:[1,0]
    v_pk_fma_f32 v[34:35], v[46:47], v[46:47], v[34:35]
    v_lshlrev_b32 v40, 16, v156
    v_and_b32 v41, 0xffff0000, v156
    v_pk_add_f32 v[40:41], v[40:41], v[50:51] op_sel_hi:[1,0]
    v_pk_fma_f32 v[32:33], v[40:41], v[40:41], v[32:33]
    v_lshlrev_b32 v42, 16, v157
    v_and_b32 v43, 0xffff0000, v157
    v_pk_add_f32 v[42:43], v[42:43], v[50:51] op_sel_hi:[1,0]
    v_pk_fma_f32 v[34:35], v[42:43], v[42:43], v[34:35]
    v_lshlrev_b32 v44, 16, v158
    v_and_b32 v45, 0xffff0000, v158
    v_pk_add_f32 v[44:45], v[44:45], v[50:51] op_sel_hi:[1,0]
    v_pk_fma_f32 v[32:33], v[44:45], v[44:45], v[32:33]
    v_lshlrev_b32 v46, 16, v159
    v_and_b32 v47, 0xffff0000, v159
    v_pk_add_f32 v[46:47], v[46:47], v[50:51] op_sel_hi:[1,0]
    v_pk_fma_f32 v[34:35], v[46:47], v[46:47], v[34:35]
    v_lshlrev_b32 v40, 16, v160
    v_and_b32 v41, 0xffff0000, v160
    v_pk_add_f32 v[40:41], v[40:41], v[50:51] op_sel_hi:[1,0]
    v_pk_fma_f32 v[32:33], v[40:41], v[40:41], v[32:33]
    v_lshlrev_b32 v42, 16, v161
    v_and_b32 v43, 0xffff0000, v161
    v_pk_add_f32 v[42:43], v[42:43], v[50:51] op_sel_hi:[1,0]
    v_pk_fma_f32 v[34:35], v[42:43], v[42:43], v[34:35]
    v_lshlrev_b32 v44, 16, v162
    v_and_b32 v45, 0xffff0000, v162
    v_pk_add_f32 v[44:45], v[44:45], v[50:51] op_sel_hi:[1,0]
    v_pk_fma_f32 v[32:33], v[44:45], v[44:45], v[32:33]
    v_lshlrev_b32 v46, 16, v163
    v_and_b32 v47, 0xffff0000, v163
    v_pk_add_f32 v[46:47], v[46:47], v[50:51] op_sel_hi:[1,0]
    v_pk_fma_f32 v[34:35], v[46:47], v[46:47], v[34:35]
    v_lshlrev_b32 v40, 16, v164
    v_and_b32 v41, 0xffff0000, v164
    v_pk_add_f32 v[40:41], v[40:41], v[50:51] op_sel_hi:[1,0]
    v_pk_fma_f32 v[32:33], v[40:41], v[40:41], v[32:33]
    v_lshlrev_b32 v42, 16, v165
    v_and_b32 v43, 0xffff0000, v165
    v_pk_add_f32 v[42:43], v[42:43], v[50:51] op_sel_hi:[1,0]
    v_pk_fma_f32 v[34:35], v[42:43], v[42:43], v[34:35]
    v_lshlrev_b32 v44, 16, v166
    v_and_b32 v45, 0xffff0000, v166
    v_pk_add_f32 v[44:45], v[44:45], v[50:51] op_sel_hi:[1,0]
    v_pk_fma_f32 v[32:33], v[44:45], v[44:45], v[32:33]
    v_lshlrev_b32 v46, 16, v167
    v_and_b32 v47, 0xffff0000, v167
    v_pk_add_f32 v[46:47], v[46:47], v[50:51] op_sel_hi:[1,0]
    v_pk_fma_f32 v[34:35], v[46:47], v[46:47], v[34:35]
    v_lshlrev_b32 v40, 16, v168
    v_and_b32 v41, 0xffff0000, v168
    v_pk_add_f32 v[40:41], v[40:41], v[50:51] op_sel_hi:[1,0]
    v_pk_fma_f32 v[32:33], v[40:41], v[40:41], v[32:33]
    v_lshlrev_b32 v42, 16, v169
    v_and_b32 v43, 0xffff0000, v169
    v_pk_add_f32 v[42:43], v[42:43], v[50:51] op_sel_hi:[1,0]
    v_pk_fma_f32 v[34:35], v[42:43], v[42:43], v[34:35]
    v_lshlrev_b32 v44, 16, v170
    v_and_b32 v45, 0xffff0000, v170
    v_pk_add_f32 v[44:45], v[44:45], v[50:51] op_sel_hi:[1,0]
    v_pk_fma_f32 v[32:33], v[44:45], v[44:45], v[32:33]
    v_lshlrev_b32 v46, 16, v171
    v_and_b32 v47, 0xffff0000, v171
    v_pk_add_f32 v[46:47], v[46:47], v[50:51] op_sel_hi:[1,0]
    v_pk_fma_f32 v[34:35], v[46:47], v[46:47], v[34:35]
    v_lshlrev_b32 v40, 16, v172
    v_and_b32 v41, 0xffff0000, v172
    v_pk_add_f32 v[40:41], v[40:41], v[50:51] op_sel_hi:[1,0]
    v_pk_fma_f32 v[32:33], v[40:41], v[40:41], v[32:33]
    v_lshlrev_b32 v42, 16, v173
    v_and_b32 v43, 0xffff0000, v173
    v_pk_add_f32 v[42:43], v[42:43], v[50:51] op_sel_hi:[1,0]
    v_pk_fma_f32 v[34:35], v[42:43], v[42:43], v[34:35]
    v_lshlrev_b32 v44, 16, v174
    v_and_b32 v45, 0xffff0000, v174
    v_pk_add_f32 v[44:45], v[44:45], v[50:51] op_sel_hi:[1,0]
    v_pk_fma_f32 v[32:33], v[44:45], v[44:45], v[32:33]
    v_lshlrev_b32 v46, 16, v175
    v_and_b32 v47, 0xffff0000, v175
    v_pk_add_f32 v[46:47], v[46:47], v[50:51] op_sel_hi:[1,0]
    v_pk_fma_f32 v[34:35], v[46:47], v[46:47], v[34:35]
    v_lshlrev_b32 v40, 16, v176
    v_and_b32 v41, 0xffff0000, v176
    v_pk_add_f32 v[40:41], v[40:41], v[50:51] op_sel_hi:[1,0]
    v_pk_fma_f32 v[32:33], v[40:41], v[40:41], v[32:33]
    v_lshlrev_b32 v42, 16, v177
    v_and_b32 v43, 0xffff0000, v177
    v_pk_add_f32 v[42:43], v[42:43], v[50:51] op_sel_hi:[1,0]
    v_pk_fma_f32 v[34:35], v[42:43], v[42:43], v[34:35]
    v_lshlrev_b32 v44, 16, v178
    v_and_b32 v45, 0xffff0000, v178
    v_pk_add_f32 v[44:45], v[44:45], v[50:51] op_sel_hi:[1,0]
    v_pk_fma_f32 v[32:33], v[44:45], v[44:45], v[32:33]
    v_lshlrev_b32 v46, 16, v179
    v_and_b32 v47, 0xffff0000, v179
    v_pk_add_f32 v[46:47], v[46:47], v[50:51] op_sel_hi:[1,0]
    v_pk_fma_f32 v[34:35], v[46:47], v[46:47], v[34:35]
    v_lshlrev_b32 v40, 16, v180
    v_and_b32 v41, 0xffff0000, v180
    v_pk_add_f32 v[40:41], v[40:41], v[50:51] op_sel_hi:[1,0]
    v_pk_fma_f32 v[32:33], v[40:41], v[40:41], v[32:33]
    v_lshlrev_b32 v42, 16, v181
    v_and_b32 v43, 0xffff0000, v181
    v_pk_add_f32 v[42:43], v[42:43], v[50:51] op_sel_hi:[1,0]
    v_pk_fma_f32 v[34:35], v[42:43], v[42:43], v[34:35]
    v_lshlrev_b32 v44, 16, v182
    v_and_b32 v45, 0xffff0000, v182
    v_pk_add_f32 v[44:45], v[44:45], v[50:51] op_sel_hi:[1,0]
    v_pk_fma_f32 v[32:33], v[44:45], v[44:45], v[32:33]
    v_lshlrev_b32 v46, 16, v183
    v_and_b32 v47, 0xffff0000, v183
    v_pk_add_f32 v[46:47], v[46:47], v[50:51] op_sel_hi:[1,0]
    v_pk_fma_f32 v[34:35], v[46:47], v[46:47], v[34:35]
    v_lshlrev_b32 v40, 16, v184
    v_and_b32 v41, 0xffff0000, v184
    v_pk_add_f32 v[40:41], v[40:41], v[50:51] op_sel_hi:[1,0]
    v_pk_fma_f32 v[32:33], v[40:41], v[40:41], v[32:33]
    v_lshlrev_b32 v42, 16, v185
    v_and_b32 v43, 0xffff0000, v185
    v_pk_add_f32 v[42:43], v[42:43], v[50:51] op_sel_hi:[1,0]
    v_pk_fma_f32 v[34:35], v[42:43], v[42:43], v[34:35]
    v_lshlrev_b32 v44, 16, v186
    v_and_b32 v45, 0xffff0000, v186
    v_pk_add_f32 v[44:45], v[44:45], v[50:51] op_sel_hi:[1,0]
    v_pk_fma_f32 v[32:33], v[44:45], v[44:45], v[32:33]
    v_lshlrev_b32 v46, 16, v187
    v_and_b32 v47, 0xffff0000, v187
    v_pk_add_f32 v[46:47], v[46:47], v[50:51] op_sel_hi:[1,0]
    v_pk_fma_f32 v[34:35], v[46:47], v[46:47], v[34:35]
    v_lshlrev_b32 v40, 16, v188
    v_and_b32 v41, 0xffff0000, v188
    v_pk_add_f32 v[40:41], v[40:41], v[50:51] op_sel_hi:[1,0]
    v_pk_fma_f32 v[32:33], v[40:41], v[40:41], v[32:33]
    v_lshlrev_b32 v42, 16, v189
    v_and_b32 v43, 0xffff0000, v189
    v_pk_add_f32 v[42:43], v[42:43], v[50:51] op_sel_hi:[1,0]
    v_pk_fma_f32 v[34:35], v[42:43], v[42:43], v[34:35]
    v_lshlrev_b32 v44, 16, v190
    v_and_b32 v45, 0xffff0000, v190
    v_pk_add_f32 v[44:45], v[44:45], v[50:51] op_sel_hi:[1,0]
    v_pk_fma_f32 v[32:33], v[44:45], v[44:45], v[32:33]
    v_lshlrev_b32 v46, 16, v191
    v_and_b32 v47, 0xffff0000, v191
    v_pk_add_f32 v[46:47], v[46:47], v[50:51] op_sel_hi:[1,0]
    v_pk_fma_f32 v[34:35], v[46:47], v[46:47], v[34:35]
    v_pk_add_f32 v[32:33], v[32:33], v[34:35]
    v_add_f32 v51, v32, v33
    v_mov_b32 v49, v51
    s_nop 1
    v_permlane16_swap_b32 v51, v49
    s_nop 1
    v_add_f32 v51, v51, v49
    v_mov_b32 v49, v51
    s_nop 1
    v_permlane32_swap_b32 v51, v49
    s_nop 1
    v_add_f32 v51, v51, v49
    v_mul_f32 v51, 0x3a800000, v51
    v_cvt_pk_bf16_f32 v52, v48, v51
    v_lshlrev_b32 v20, 16, v52
    v_and_b32 v51, 0xffff0000, v52
    v_add_f32 v51, 0x3727c5ac, v51
    v_cvt_pk_bf16_f32 v52, v51, v51
    v_lshlrev_b32 v51, 16, v52
    v_sqrt_f32 v51, v51
    s_nop 0
    v_cvt_pk_bf16_f32 v52, v51, v51
    v_lshlrev_b32 v21, 16, v52
    s_add_u32 s28, s4, 29360128
    s_addc_u32 s29, s5, 0
    s_mov_b32 s30, 16384
    s_mov_b32 s31, 0x00020000
    s_lshl_b32 s36, s35, 3
    v_and_b32 v6, 15, v2
    v_lshlrev_b32 v6, 3, v6
    v_add_u32 v6, s36, v6
    s_mov_b64 exec, 0xffff
    buffer_store_dwordx2 v[20:21], v6, s[28:31], 0 offen sc1
    s_mov_b64 exec, -1
    s_waitcnt vmcnt(0)
    s_mov_b32 s56, s90
    s_mov_b32 s57, s91
    s_mov_b32 s58, 256
    s_mov_b32 s59, 0x00020000
    s_lshr_b32 s36, s2, 2
    s_lshl_b32 s36, s36, 2
    v_mov_b32 v6, s36
    s_and_b32 s36, s33, 15
    s_lshl_b32 s36, 1, s36
    v_mov_b32 v7, s36
    s_mov_b64 exec, 1
    buffer_atomic_or v7, v6, s[56:59], 0 offen sc1
    s_mov_b64 exec, -1
    s_mov_b32 s8, s84
    s_mov_b32 s9, s85
    s_mov_b32 s10, 4194304
    s_mov_b32 s11, 0x00020000
    s_mov_b32 s12, s86
    s_mov_b32 s13, s87
    s_mov_b32 s14, 7340032
    s_mov_b32 s15, 0x00020000
    s_add_u32 s28, s4, 30932992
    s_addc_u32 s29, s5, 0
    s_mov_b32 s30, 4096
    s_mov_b32 s31, 0x00020000
    s_lshl_b32 s36, s33, 5
    v_lshlrev_b32 v6, 2, v2
    v_add_u32 v6, s36, v6
    v_mov_b32 v7, 0
    s_mov_b64 exec, 0xff
    buffer_store_dword v7, v6, s[28:31], 0 offen
    s_mov_b64 exec, -1
    s_mov_b32 s16, s82
    s_mov_b32 s17, s83
    s_mov_b32 s18, 8192
    s_mov_b32 s19, 0x00020000
    s_add_u32 s28, s4, 4194304
    s_addc_u32 s29, s5, 0
    s_mov_b32 s30, 4194304
    s_mov_b32 s31, 0x00020000
    s_lshl_b32 s37, s2, 6
    s_lshl_b32 s38, s32, 4
    s_add_u32 s37, s37, s38
    v_lshrrev_b32 v5, 4, v2
    v_lshlrev_b32 v5, 2, v5
    v_add_u32 v5, s37, v5
    v_lshlrev_b32 v8, 11, v5
    v_and_b32 v9, 15, v2
    v_lshlrev_b32 v9, 4, v9
    v_add_u32 v8, v8, v9
    v_lshlrev_b32 v9, 2, v9
    v_and_b32 v10, 15, v2
    v_lshlrev_b32 v10, 10, v10
    v_lshrrev_b32 v5, 4, v2
    v_lshlrev_b32 v5, 3, v5
    v_sub_u32 v10, v10, v5
    s_lshl_b32 s38, s32, 5
    s_sub_u32 s38, 120, s38
    v_add_u32 v10, s38, v10
    s_lshl_b32 s38, s32, 12
    v_add_u32 v11, s38, v26
    v_lshrrev_b32 v12, 3, v2
    s_lshl_b32 s38, s32, 5
    v_add_u32 v12, s38, v12
    v_lshlrev_b32 v12, 12, v12
    v_and_b32 v13, 7, v2
    v_lshl_add_u32 v12, v13, 4, v12
    s_lshl_b32 s38, s2, 7
    s_sub_u32 s38, 3968, s38
    v_add_u32 v12, s38, v12
    s_mov_b32 s40, 0
    s_mov_b32 s41, 0
    s_mov_b32 s42, 0
    s_mov_b32 s43, 0
    s_mov_b32 s39, 4
    v_add_u32 v7, 0xffffe800, v8
    buffer_load_dwordx4 a[0:3], v7, s[20:23], s40 offen
    v_add_u32 v7, 0xfffff000, v8
    buffer_load_dwordx4 a[4:7], v7, s[20:23], s40 offen
    v_add_u32 v7, 0xfffff800, v8
    buffer_load_dwordx4 a[8:11], v7, s[20:23], s40 offen
    v_add_u32 v7, 0x0, v8
    buffer_load_dwordx4 a[12:15], v7, s[20:23], s40 offen
    v_add_u32 v7, 0x800, v8
    buffer_load_dwordx4 a[16:19], v7, s[20:23], s40 offen
    v_add_u32 v7, 0x1000, v8
    buffer_load_dwordx4 a[20:23], v7, s[20:23], s40 offen
    v_add_u32 v7, 0x1800, v8
    buffer_load_dwordx4 a[24:27], v7, s[20:23], s40 offen
    v_add_u32 v7, 0x0, v8
    buffer_load_dwordx4 a[28:31], v7, s[24:27], s40 offen
    v_add_u32 v7, 0x800, v8
    buffer_load_dwordx4 a[32:35], v7, s[24:27], s40 offen
    v_add_u32 v7, 0x1000, v8
    buffer_load_dwordx4 a[36:39], v7, s[24:27], s40 offen
    v_add_u32 v7, 0x1800, v8
    buffer_load_dwordx4 a[40:43], v7, s[24:27], s40 offen
    buffer_load_dwordx4 a[44:47], v9, s[16:19], s41 offen offset:0
    buffer_load_dwordx4 a[48:51], v9, s[16:19], s41 offen offset:16
    buffer_load_dwordx4 a[52:55], v9, s[16:19], s41 offen offset:32
    buffer_load_dwordx4 a[56:59], v9, s[16:19], s41 offen offset:48
    s_add_u32 s40, s40, 256
    s_add_u32 s41, s41, 1024
    v_add_u32 v7, 0xffffe800, v8
    buffer_load_dwordx4 a[64:67], v7, s[20:23], s40 offen
    v_add_u32 v7, 0xfffff000, v8
    buffer_load_dwordx4 a[68:71], v7, s[20:23], s40 offen
    v_add_u32 v7, 0xfffff800, v8
    buffer_load_dwordx4 a[72:75], v7, s[20:23], s40 offen
    v_add_u32 v7, 0x0, v8
    buffer_load_dwordx4 a[76:79], v7, s[20:23], s40 offen
    v_add_u32 v7, 0x800, v8
    buffer_load_dwordx4 a[80:83], v7, s[20:23], s40 offen
    v_add_u32 v7, 0x1000, v8
    buffer_load_dwordx4 a[84:87], v7, s[20:23], s40 offen
    v_add_u32 v7, 0x1800, v8
    buffer_load_dwordx4 a[88:91], v7, s[20:23], s40 offen
    v_add_u32 v7, 0x0, v8
    buffer_load_dwordx4 a[92:95], v7, s[24:27], s40 offen
    v_add_u32 v7, 0x800, v8
    buffer_load_dwordx4 a[96:99], v7, s[24:27], s40 offen
    v_add_u32 v7, 0x1000, v8
    buffer_load_dwordx4 a[100:103], v7, s[24:27], s40 offen
    v_add_u32 v7, 0x1800, v8
    buffer_load_dwordx4 a[104:107], v7, s[24:27], s40 offen
    buffer_load_dwordx4 a[108:111], v9, s[16:19], s41 offen offset:0
    buffer_load_dwordx4 a[112:115], v9, s[16:19], s41 offen offset:16
    buffer_load_dwordx4 a[116:119], v9, s[16:19], s41 offen offset:32
    buffer_load_dwordx4 a[120:123], v9, s[16:19], s41 offen offset:48
    s_add_u32 s40, s40, 256
    s_add_u32 s41, s41, 1024
    s_waitcnt vmcnt(0)
k1_kernel_kv:
    s_waitcnt vmcnt(27)
    v_accvgpr_read_b32 v128, a0
    v_accvgpr_read_b32 v129, a1
    v_accvgpr_read_b32 v130, a2
    v_accvgpr_read_b32 v131, a3
    v_accvgpr_read_b32 v132, a4
    v_accvgpr_read_b32 v133, a5
    v_accvgpr_read_b32 v134, a6
    v_accvgpr_read_b32 v135, a7
    v_accvgpr_read_b32 v136, a8
    v_accvgpr_read_b32 v137, a9
    v_accvgpr_read_b32 v138, a10
    v_accvgpr_read_b32 v139, a11
    v_accvgpr_read_b32 v140, a12
    v_accvgpr_read_b32 v141, a13
    v_accvgpr_read_b32 v142, a14
    v_accvgpr_read_b32 v143, a15
    v_accvgpr_read_b32 v144, a16
    v_accvgpr_read_b32 v145, a17
    v_accvgpr_read_b32 v146, a18
    v_accvgpr_read_b32 v147, a19
    v_accvgpr_read_b32 v148, a20
    v_accvgpr_read_b32 v149, a21
    v_accvgpr_read_b32 v150, a22
    v_accvgpr_read_b32 v151, a23
    v_accvgpr_read_b32 v152, a24
    v_accvgpr_read_b32 v153, a25
    v_accvgpr_read_b32 v154, a26
    v_accvgpr_read_b32 v155, a27
    v_accvgpr_read_b32 v156, a28
    v_accvgpr_read_b32 v157, a29
    v_accvgpr_read_b32 v158, a30
    v_accvgpr_read_b32 v159, a31
    v_accvgpr_read_b32 v160, a32
    v_accvgpr_read_b32 v161, a33
    v_accvgpr_read_b32 v162, a34
    v_accvgpr_read_b32 v163, a35
    v_accvgpr_read_b32 v164, a36
    v_accvgpr_read_b32 v165, a37
    v_accvgpr_read_b32 v166, a38
    v_accvgpr_read_b32 v167, a39
    v_accvgpr_read_b32 v168, a40
    v_accvgpr_read_b32 v169, a41
    v_accvgpr_read_b32 v170, a42
    v_accvgpr_read_b32 v171, a43
    v_accvgpr_read_b32 v172, a44
    v_accvgpr_read_b32 v173, a45
    v_accvgpr_read_b32 v174, a46
    v_accvgpr_read_b32 v175, a47
    v_accvgpr_read_b32 v176, a48
    v_accvgpr_read_b32 v177, a49
    v_accvgpr_read_b32 v178, a50
    v_accvgpr_read_b32 v179, a51
    v_accvgpr_read_b32 v180, a52
    v_accvgpr_read_b32 v181, a53
    v_accvgpr_read_b32 v182, a54
    v_accvgpr_read_b32 v183, a55
    v_accvgpr_read_b32 v184, a56
    v_accvgpr_read_b32 v185, a57
    v_accvgpr_read_b32 v186, a58
    v_accvgpr_read_b32 v187, a59
    v_add_u32 v7, 0xffffe800, v8
    buffer_load_dwordx4 a[0:3], v7, s[20:23], s40 offen
    v_add_u32 v7, 0xfffff000, v8
    buffer_load_dwordx4 a[4:7], v7, s[20:23], s40 offen
    v_add_u32 v7, 0xfffff800, v8
    buffer_load_dwordx4 a[8:11], v7, s[20:23], s40 offen
    v_add_u32 v7, 0x0, v8
    buffer_load_dwordx4 a[12:15], v7, s[20:23], s40 offen
    v_add_u32 v7, 0x800, v8
    buffer_load_dwordx4 a[16:19], v7, s[20:23], s40 offen
    v_add_u32 v7, 0x1000, v8
    buffer_load_dwordx4 a[20:23], v7, s[20:23], s40 offen
    v_add_u32 v7, 0x1800, v8
    buffer_load_dwordx4 a[24:27], v7, s[20:23], s40 offen
    v_add_u32 v7, 0x0, v8
    buffer_load_dwordx4 a[28:31], v7, s[24:27], s40 offen
    v_add_u32 v7, 0x800, v8
    buffer_load_dwordx4 a[32:35], v7, s[24:27], s40 offen
    v_add_u32 v7, 0x1000, v8
    buffer_load_dwordx4 a[36:39], v7, s[24:27], s40 offen
    v_add_u32 v7, 0x1800, v8
    buffer_load_dwordx4 a[40:43], v7, s[24:27], s40 offen
    buffer_load_dwordx4 a[44:47], v9, s[16:19], s41 offen offset:0
    buffer_load_dwordx4 a[48:51], v9, s[16:19], s41 offen offset:16
    buffer_load_dwordx4 a[52:55], v9, s[16:19], s41 offen offset:32
    buffer_load_dwordx4 a[56:59], v9, s[16:19], s41 offen offset:48
    s_add_u32 s40, s40, 256
    s_add_u32 s41, s41, 1024
    buffer_load_dword v62, v3, s[12:15], s43 offen
    buffer_load_dword v62, v3, s[8:11], s43 offen
    s_add_u32 s43, s43, 1048576
    v_lshlrev_b32 v192, 16, v172
    v_lshlrev_b32 v193, 16, v174
    v_and_b32 v194, 0xffff0000, v172
    v_and_b32 v195, 0xffff0000, v174
    v_lshlrev_b32 v196, 16, v173
    v_lshlrev_b32 v197, 16, v175
    v_and_b32 v198, 0xffff0000, v173
    v_and_b32 v199, 0xffff0000, v175
    v_lshlrev_b32 v200, 16, v128
    v_and_b32 v201, 0xffff0000, v128
    v_lshlrev_b32 v202, 16, v132
    v_and_b32 v203, 0xffff0000, v132
    v_lshlrev_b32 v204, 16, v136
    v_and_b32 v205, 0xffff0000, v136
    v_lshlrev_b32 v206, 16, v140
    v_and_b32 v207, 0xffff0000, v140
    v_lshlrev_b32 v208, 16, v144
    v_and_b32 v209, 0xffff0000, v144
    v_lshlrev_b32 v210, 16, v148
    v_and_b32 v211, 0xffff0000, v148
    v_lshlrev_b32 v212, 16, v152
    v_and_b32 v213, 0xffff0000, v152
    v_pk_mul_f32 v[214:215], v[200:201], v[198:199]
    v_pk_fma_f32 v[214:215], v[202:203], v[196:197], v[214:215]
    v_pk_fma_f32 v[214:215], v[204:205], v[194:195], v[214:215]
    v_pk_fma_f32 v[214:215], v[206:207], v[192:193], v[214:215]
    v_cvt_pk_bf16_f32 v214, v214, v215
    v_and_b32 v215, 0xffff0000, v214
    v_lshlrev_b32 v214, 16, v214
    v_lshlrev_b32 v14, 16, v156
    v_and_b32 v15, 0xffff0000, v156
    v_mul_f32 v216, v214, v14
    v_mul_f32 v220, v215, v15
    v_pk_mul_f32 v[214:215], v[202:203], v[198:199]
    v_pk_fma_f32 v[214:215], v[204:205], v[196:197], v[214:215]
    v_pk_fma_f32 v[214:215], v[206:207], v[194:195], v[214:215]
    v_pk_fma_f32 v[214:215], v[208:209], v[192:193], v[214:215]
    v_cvt_pk_bf16_f32 v214, v214, v215
    v_and_b32 v215, 0xffff0000, v214
    v_lshlrev_b32 v214, 16, v214
    v_lshlrev_b32 v14, 16, v160
    v_and_b32 v15, 0xffff0000, v160
    v_mul_f32 v217, v214, v14
    v_mul_f32 v221, v215, v15
    v_pk_mul_f32 v[214:215], v[204:205], v[198:199]
    v_pk_fma_f32 v[214:215], v[206:207], v[196:197], v[214:215]
    v_pk_fma_f32 v[214:215], v[208:209], v[194:195], v[214:215]
    v_pk_fma_f32 v[214:215], v[210:211], v[192:193], v[214:215]
    v_cvt_pk_bf16_f32 v214, v214, v215
    v_and_b32 v215, 0xffff0000, v214
    v_lshlrev_b32 v214, 16, v214
    v_lshlrev_b32 v14, 16, v164
    v_and_b32 v15, 0xffff0000, v164
    v_mul_f32 v218, v214, v14
    v_mul_f32 v222, v215, v15
    v_pk_mul_f32 v[214:215], v[206:207], v[198:199]
    v_pk_fma_f32 v[214:215], v[208:209], v[196:197], v[214:215]
    v_pk_fma_f32 v[214:215], v[210:211], v[194:195], v[214:215]
    v_pk_fma_f32 v[214:215], v[212:213], v[192:193], v[214:215]
    v_cvt_pk_bf16_f32 v214, v214, v215
    v_and_b32 v215, 0xffff0000, v214
    v_lshlrev_b32 v214, 16, v214
    v_lshlrev_b32 v14, 16, v168
    v_and_b32 v15, 0xffff0000, v168
    v_mul_f32 v219, v214, v14
    v_mul_f32 v223, v215, v15
    v_cvt_pk_bf16_f32 v224, v219, v218
    v_cvt_pk_bf16_f32 v225, v217, v216
    v_cvt_pk_bf16_f32 v226, v223, v222
    v_cvt_pk_bf16_f32 v227, v221, v220
    ds_write_b64 v10, v[224:225] offset:0
    ds_write_b64 v10, v[226:227] offset:128
    v_lshlrev_b32 v192, 16, v176
    v_lshlrev_b32 v193, 16, v178
    v_and_b32 v194, 0xffff0000, v176
    v_and_b32 v195, 0xffff0000, v178
    v_lshlrev_b32 v196, 16, v177
    v_lshlrev_b32 v197, 16, v179
    v_and_b32 v198, 0xffff0000, v177
    v_and_b32 v199, 0xffff0000, v179
    v_lshlrev_b32 v200, 16, v129
    v_and_b32 v201, 0xffff0000, v129
    v_lshlrev_b32 v202, 16, v133
    v_and_b32 v203, 0xffff0000, v133
    v_lshlrev_b32 v204, 16, v137
    v_and_b32 v205, 0xffff0000, v137
    v_lshlrev_b32 v206, 16, v141
    v_and_b32 v207, 0xffff0000, v141
    v_lshlrev_b32 v208, 16, v145
    v_and_b32 v209, 0xffff0000, v145
    v_lshlrev_b32 v210, 16, v149
    v_and_b32 v211, 0xffff0000, v149
    v_lshlrev_b32 v212, 16, v153
    v_and_b32 v213, 0xffff0000, v153
    v_pk_mul_f32 v[214:215], v[200:201], v[198:199]
    v_pk_fma_f32 v[214:215], v[202:203], v[196:197], v[214:215]
    v_pk_fma_f32 v[214:215], v[204:205], v[194:195], v[214:215]
    v_pk_fma_f32 v[214:215], v[206:207], v[192:193], v[214:215]
    v_cvt_pk_bf16_f32 v214, v214, v215
    v_and_b32 v215, 0xffff0000, v214
    v_lshlrev_b32 v214, 16, v214
    v_lshlrev_b32 v14, 16, v157
    v_and_b32 v15, 0xffff0000, v157
    v_mul_f32 v216, v214, v14
    v_mul_f32 v220, v215, v15
    v_pk_mul_f32 v[214:215], v[202:203], v[198:199]
    v_pk_fma_f32 v[214:215], v[204:205], v[196:197], v[214:215]
    v_pk_fma_f32 v[214:215], v[206:207], v[194:195], v[214:215]
    v_pk_fma_f32 v[214:215], v[208:209], v[192:193], v[214:215]
    v_cvt_pk_bf16_f32 v214, v214, v215
    v_and_b32 v215, 0xffff0000, v214
    v_lshlrev_b32 v214, 16, v214
    v_lshlrev_b32 v14, 16, v161
    v_and_b32 v15, 0xffff0000, v161
    v_mul_f32 v217, v214, v14
    v_mul_f32 v221, v215, v15
    v_pk_mul_f32 v[214:215], v[204:205], v[198:199]
    v_pk_fma_f32 v[214:215], v[206:207], v[196:197], v[214:215]
    v_pk_fma_f32 v[214:215], v[208:209], v[194:195], v[214:215]
    v_pk_fma_f32 v[214:215], v[210:211], v[192:193], v[214:215]
    v_cvt_pk_bf16_f32 v214, v214, v215
    v_and_b32 v215, 0xffff0000, v214
    v_lshlrev_b32 v214, 16, v214
    v_lshlrev_b32 v14, 16, v165
    v_and_b32 v15, 0xffff0000, v165
    v_mul_f32 v218, v214, v14
    v_mul_f32 v222, v215, v15
    v_pk_mul_f32 v[214:215], v[206:207], v[198:199]
    v_pk_fma_f32 v[214:215], v[208:209], v[196:197], v[214:215]
    v_pk_fma_f32 v[214:215], v[210:211], v[194:195], v[214:215]
    v_pk_fma_f32 v[214:215], v[212:213], v[192:193], v[214:215]
    v_cvt_pk_bf16_f32 v214, v214, v215
    v_and_b32 v215, 0xffff0000, v214
    v_lshlrev_b32 v214, 16, v214
    v_lshlrev_b32 v14, 16, v169
    v_and_b32 v15, 0xffff0000, v169
    v_mul_f32 v219, v214, v14
    v_mul_f32 v223, v215, v15
    v_cvt_pk_bf16_f32 v228, v219, v218
    v_cvt_pk_bf16_f32 v229, v217, v216
    v_cvt_pk_bf16_f32 v230, v223, v222
    v_cvt_pk_bf16_f32 v231, v221, v220
    ds_write_b64 v10, v[228:229] offset:256
    ds_write_b64 v10, v[230:231] offset:384
    v_lshlrev_b32 v192, 16, v180
    v_lshlrev_b32 v193, 16, v182
    v_and_b32 v194, 0xffff0000, v180
    v_and_b32 v195, 0xffff0000, v182
    v_lshlrev_b32 v196, 16, v181
    v_lshlrev_b32 v197, 16, v183
    v_and_b32 v198, 0xffff0000, v181
    v_and_b32 v199, 0xffff0000, v183
    v_lshlrev_b32 v200, 16, v130
    v_and_b32 v201, 0xffff0000, v130
    v_lshlrev_b32 v202, 16, v134
    v_and_b32 v203, 0xffff0000, v134
    v_lshlrev_b32 v204, 16, v138
    v_and_b32 v205, 0xffff0000, v138
    v_lshlrev_b32 v206, 16, v142
    v_and_b32 v207, 0xffff0000, v142
    v_lshlrev_b32 v208, 16, v146
    v_and_b32 v209, 0xffff0000, v146
    v_lshlrev_b32 v210, 16, v150
    v_and_b32 v211, 0xffff0000, v150
    v_lshlrev_b32 v212, 16, v154
    v_and_b32 v213, 0xffff0000, v154
    v_pk_mul_f32 v[214:215], v[200:201], v[198:199]
    v_pk_fma_f32 v[214:215], v[202:203], v[196:197], v[214:215]
    v_pk_fma_f32 v[214:215], v[204:205], v[194:195], v[214:215]
    v_pk_fma_f32 v[214:215], v[206:207], v[192:193], v[214:215]
    v_cvt_pk_bf16_f32 v214, v214, v215
    v_and_b32 v215, 0xffff0000, v214
    v_lshlrev_b32 v214, 16, v214
    v_lshlrev_b32 v14, 16, v158
    v_and_b32 v15, 0xffff0000, v158
    v_mul_f32 v216, v214, v14
    v_mul_f32 v220, v215, v15
    v_pk_mul_f32 v[214:215], v[202:203], v[198:199]
    v_pk_fma_f32 v[214:215], v[204:205], v[196:197], v[214:215]
    v_pk_fma_f32 v[214:215], v[206:207], v[194:195], v[214:215]
    v_pk_fma_f32 v[214:215], v[208:209], v[192:193], v[214:215]
    v_cvt_pk_bf16_f32 v214, v214, v215
    v_and_b32 v215, 0xffff0000, v214
    v_lshlrev_b32 v214, 16, v214
    v_lshlrev_b32 v14, 16, v162
    v_and_b32 v15, 0xffff0000, v162
    v_mul_f32 v217, v214, v14
    v_mul_f32 v221, v215, v15
    v_pk_mul_f32 v[214:215], v[204:205], v[198:199]
    v_pk_fma_f32 v[214:215], v[206:207], v[196:197], v[214:215]
    v_pk_fma_f32 v[214:215], v[208:209], v[194:195], v[214:215]
    v_pk_fma_f32 v[214:215], v[210:211], v[192:193], v[214:215]
    v_cvt_pk_bf16_f32 v214, v214, v215
    v_and_b32 v215, 0xffff0000, v214
    v_lshlrev_b32 v214, 16, v214
    v_lshlrev_b32 v14, 16, v166
    v_and_b32 v15, 0xffff0000, v166
    v_mul_f32 v218, v214, v14
    v_mul_f32 v222, v215, v15
    v_pk_mul_f32 v[214:215], v[206:207], v[198:199]
    v_pk_fma_f32 v[214:215], v[208:209], v[196:197], v[214:215]
    v_pk_fma_f32 v[214:215], v[210:211], v[194:195], v[214:215]
    v_pk_fma_f32 v[214:215], v[212:213], v[192:193], v[214:215]
    v_cvt_pk_bf16_f32 v214, v214, v215
    v_and_b32 v215, 0xffff0000, v214
    v_lshlrev_b32 v214, 16, v214
    v_lshlrev_b32 v14, 16, v170
    v_and_b32 v15, 0xffff0000, v170
    v_mul_f32 v219, v214, v14
    v_mul_f32 v223, v215, v15
    v_cvt_pk_bf16_f32 v224, v219, v218
    v_cvt_pk_bf16_f32 v225, v217, v216
    v_cvt_pk_bf16_f32 v226, v223, v222
    v_cvt_pk_bf16_f32 v227, v221, v220
    ds_write_b64 v10, v[224:225] offset:512
    ds_write_b64 v10, v[226:227] offset:640
    v_lshlrev_b32 v192, 16, v184
    v_lshlrev_b32 v193, 16, v186
    v_and_b32 v194, 0xffff0000, v184
    v_and_b32 v195, 0xffff0000, v186
    v_lshlrev_b32 v196, 16, v185
    v_lshlrev_b32 v197, 16, v187
    v_and_b32 v198, 0xffff0000, v185
    v_and_b32 v199, 0xffff0000, v187
    v_lshlrev_b32 v200, 16, v131
    v_and_b32 v201, 0xffff0000, v131
    v_lshlrev_b32 v202, 16, v135
    v_and_b32 v203, 0xffff0000, v135
    v_lshlrev_b32 v204, 16, v139
    v_and_b32 v205, 0xffff0000, v139
    v_lshlrev_b32 v206, 16, v143
    v_and_b32 v207, 0xffff0000, v143
    v_lshlrev_b32 v208, 16, v147
    v_and_b32 v209, 0xffff0000, v147
    v_lshlrev_b32 v210, 16, v151
    v_and_b32 v211, 0xffff0000, v151
    v_lshlrev_b32 v212, 16, v155
    v_and_b32 v213, 0xffff0000, v155
    v_pk_mul_f32 v[214:215], v[200:201], v[198:199]
    v_pk_fma_f32 v[214:215], v[202:203], v[196:197], v[214:215]
    v_pk_fma_f32 v[214:215], v[204:205], v[194:195], v[214:215]
    v_pk_fma_f32 v[214:215], v[206:207], v[192:193], v[214:215]
    v_cvt_pk_bf16_f32 v214, v214, v215
    v_and_b32 v215, 0xffff0000, v214
    v_lshlrev_b32 v214, 16, v214
    v_lshlrev_b32 v14, 16, v159
    v_and_b32 v15, 0xffff0000, v159
    v_mul_f32 v216, v214, v14
    v_mul_f32 v220, v215, v15
    v_pk_mul_f32 v[214:215], v[202:203], v[198:199]
    v_pk_fma_f32 v[214:215], v[204:205], v[196:197], v[214:215]
    v_pk_fma_f32 v[214:215], v[206:207], v[194:195], v[214:215]
    v_pk_fma_f32 v[214:215], v[208:209], v[192:193], v[214:215]
    v_cvt_pk_bf16_f32 v214, v214, v215
    v_and_b32 v215, 0xffff0000, v214
    v_lshlrev_b32 v214, 16, v214
    v_lshlrev_b32 v14, 16, v163
    v_and_b32 v15, 0xffff0000, v163
    v_mul_f32 v217, v214, v14
    v_mul_f32 v221, v215, v15
    v_pk_mul_f32 v[214:215], v[204:205], v[198:199]
    v_pk_fma_f32 v[214:215], v[206:207], v[196:197], v[214:215]
    v_pk_fma_f32 v[214:215], v[208:209], v[194:195], v[214:215]
    v_pk_fma_f32 v[214:215], v[210:211], v[192:193], v[214:215]
    v_cvt_pk_bf16_f32 v214, v214, v215
    v_and_b32 v215, 0xffff0000, v214
    v_lshlrev_b32 v214, 16, v214
    v_lshlrev_b32 v14, 16, v167
    v_and_b32 v15, 0xffff0000, v167
    v_mul_f32 v218, v214, v14
    v_mul_f32 v222, v215, v15
    v_pk_mul_f32 v[214:215], v[206:207], v[198:199]
    v_pk_fma_f32 v[214:215], v[208:209], v[196:197], v[214:215]
    v_pk_fma_f32 v[214:215], v[210:211], v[194:195], v[214:215]
    v_pk_fma_f32 v[214:215], v[212:213], v[192:193], v[214:215]
    v_cvt_pk_bf16_f32 v214, v214, v215
    v_and_b32 v215, 0xffff0000, v214
    v_lshlrev_b32 v214, 16, v214
    v_lshlrev_b32 v14, 16, v171
    v_and_b32 v15, 0xffff0000, v171
    v_mul_f32 v219, v214, v14
    v_mul_f32 v223, v215, v15
    v_cvt_pk_bf16_f32 v228, v219, v218
    v_cvt_pk_bf16_f32 v229, v217, v216
    v_cvt_pk_bf16_f32 v230, v223, v222
    v_cvt_pk_bf16_f32 v231, v221, v220
    ds_write_b64 v10, v[228:229] offset:768
    ds_write_b64 v10, v[230:231] offset:896
    s_waitcnt lgkmcnt(0)
    s_barrier
    ds_read_b128 v[240:243], v11 offset:0
    ds_read_b128 v[244:247], v11 offset:1024
    ds_read_b128 v[248:251], v11 offset:2048
    ds_read_b128 v[252:255], v11 offset:3072
    s_waitcnt lgkmcnt(0)
    s_barrier
    v_add_u32 v7, 0, v12
    buffer_store_dwordx4 v[240:243], v7, s[28:31], s42 offen
    v_add_u32 v7, 32768, v12
    buffer_store_dwordx4 v[244:247], v7, s[28:31], s42 offen
    v_add_u32 v7, 65536, v12
    buffer_store_dwordx4 v[248:251], v7, s[28:31], s42 offen
    v_add_u32 v7, 98304, v12
    buffer_store_dwordx4 v[252:255], v7, s[28:31], s42 offen
    s_add_u32 s42, s42, 524288
    s_waitcnt vmcnt(27)
    v_accvgpr_read_b32 v128, a64
    v_accvgpr_read_b32 v129, a65
    v_accvgpr_read_b32 v130, a66
    v_accvgpr_read_b32 v131, a67
    v_accvgpr_read_b32 v132, a68
    v_accvgpr_read_b32 v133, a69
    v_accvgpr_read_b32 v134, a70
    v_accvgpr_read_b32 v135, a71
    v_accvgpr_read_b32 v136, a72
    v_accvgpr_read_b32 v137, a73
    v_accvgpr_read_b32 v138, a74
    v_accvgpr_read_b32 v139, a75
    v_accvgpr_read_b32 v140, a76
    v_accvgpr_read_b32 v141, a77
    v_accvgpr_read_b32 v142, a78
    v_accvgpr_read_b32 v143, a79
    v_accvgpr_read_b32 v144, a80
    v_accvgpr_read_b32 v145, a81
    v_accvgpr_read_b32 v146, a82
    v_accvgpr_read_b32 v147, a83
    v_accvgpr_read_b32 v148, a84
    v_accvgpr_read_b32 v149, a85
    v_accvgpr_read_b32 v150, a86
    v_accvgpr_read_b32 v151, a87
    v_accvgpr_read_b32 v152, a88
    v_accvgpr_read_b32 v153, a89
    v_accvgpr_read_b32 v154, a90
    v_accvgpr_read_b32 v155, a91
    v_accvgpr_read_b32 v156, a92
    v_accvgpr_read_b32 v157, a93
    v_accvgpr_read_b32 v158, a94
    v_accvgpr_read_b32 v159, a95
    v_accvgpr_read_b32 v160, a96
    v_accvgpr_read_b32 v161, a97
    v_accvgpr_read_b32 v162, a98
    v_accvgpr_read_b32 v163, a99
    v_accvgpr_read_b32 v164, a100
    v_accvgpr_read_b32 v165, a101
    v_accvgpr_read_b32 v166, a102
    v_accvgpr_read_b32 v167, a103
    v_accvgpr_read_b32 v168, a104
    v_accvgpr_read_b32 v169, a105
    v_accvgpr_read_b32 v170, a106
    v_accvgpr_read_b32 v171, a107
    v_accvgpr_read_b32 v172, a108
    v_accvgpr_read_b32 v173, a109
    v_accvgpr_read_b32 v174, a110
    v_accvgpr_read_b32 v175, a111
    v_accvgpr_read_b32 v176, a112
    v_accvgpr_read_b32 v177, a113
    v_accvgpr_read_b32 v178, a114
    v_accvgpr_read_b32 v179, a115
    v_accvgpr_read_b32 v180, a116
    v_accvgpr_read_b32 v181, a117
    v_accvgpr_read_b32 v182, a118
    v_accvgpr_read_b32 v183, a119
    v_accvgpr_read_b32 v184, a120
    v_accvgpr_read_b32 v185, a121
    v_accvgpr_read_b32 v186, a122
    v_accvgpr_read_b32 v187, a123
    v_add_u32 v7, 0xffffe800, v8
    buffer_load_dwordx4 a[64:67], v7, s[20:23], s40 offen
    v_add_u32 v7, 0xfffff000, v8
    buffer_load_dwordx4 a[68:71], v7, s[20:23], s40 offen
    v_add_u32 v7, 0xfffff800, v8
    buffer_load_dwordx4 a[72:75], v7, s[20:23], s40 offen
    v_add_u32 v7, 0x0, v8
    buffer_load_dwordx4 a[76:79], v7, s[20:23], s40 offen
    v_add_u32 v7, 0x800, v8
    buffer_load_dwordx4 a[80:83], v7, s[20:23], s40 offen
    v_add_u32 v7, 0x1000, v8
    buffer_load_dwordx4 a[84:87], v7, s[20:23], s40 offen
    v_add_u32 v7, 0x1800, v8
    buffer_load_dwordx4 a[88:91], v7, s[20:23], s40 offen
    v_add_u32 v7, 0x0, v8
    buffer_load_dwordx4 a[92:95], v7, s[24:27], s40 offen
    v_add_u32 v7, 0x800, v8
    buffer_load_dwordx4 a[96:99], v7, s[24:27], s40 offen
    v_add_u32 v7, 0x1000, v8
    buffer_load_dwordx4 a[100:103], v7, s[24:27], s40 offen
    v_add_u32 v7, 0x1800, v8
    buffer_load_dwordx4 a[104:107], v7, s[24:27], s40 offen
    buffer_load_dwordx4 a[108:111], v9, s[16:19], s41 offen offset:0
    buffer_load_dwordx4 a[112:115], v9, s[16:19], s41 offen offset:16
    buffer_load_dwordx4 a[116:119], v9, s[16:19], s41 offen offset:32
    buffer_load_dwordx4 a[120:123], v9, s[16:19], s41 offen offset:48
    s_add_u32 s40, s40, 256
    s_add_u32 s41, s41, 1024
    buffer_load_dword v62, v3, s[12:15], s43 offen
    buffer_load_dword v62, v3, s[8:11], s43 offen
    s_add_u32 s43, s43, 1048576
    v_lshlrev_b32 v192, 16, v172
    v_lshlrev_b32 v193, 16, v174
    v_and_b32 v194, 0xffff0000, v172
    v_and_b32 v195, 0xffff0000, v174
    v_lshlrev_b32 v196, 16, v173
    v_lshlrev_b32 v197, 16, v175
    v_and_b32 v198, 0xffff0000, v173
    v_and_b32 v199, 0xffff0000, v175
    v_lshlrev_b32 v200, 16, v128
    v_and_b32 v201, 0xffff0000, v128
    v_lshlrev_b32 v202, 16, v132
    v_and_b32 v203, 0xffff0000, v132
    v_lshlrev_b32 v204, 16, v136
    v_and_b32 v205, 0xffff0000, v136
    v_lshlrev_b32 v206, 16, v140
    v_and_b32 v207, 0xffff0000, v140
    v_lshlrev_b32 v208, 16, v144
    v_and_b32 v209, 0xffff0000, v144
    v_lshlrev_b32 v210, 16, v148
    v_and_b32 v211, 0xffff0000, v148
    v_lshlrev_b32 v212, 16, v152
    v_and_b32 v213, 0xffff0000, v152
    v_pk_mul_f32 v[214:215], v[200:201], v[198:199]
    v_pk_fma_f32 v[214:215], v[202:203], v[196:197], v[214:215]
    v_pk_fma_f32 v[214:215], v[204:205], v[194:195], v[214:215]
    v_pk_fma_f32 v[214:215], v[206:207], v[192:193], v[214:215]
    v_cvt_pk_bf16_f32 v214, v214, v215
    v_and_b32 v215, 0xffff0000, v214
    v_lshlrev_b32 v214, 16, v214
    v_lshlrev_b32 v14, 16, v156
    v_and_b32 v15, 0xffff0000, v156
    v_mul_f32 v216, v214, v14
    v_mul_f32 v220, v215, v15
    v_pk_mul_f32 v[214:215], v[202:203], v[198:199]
    v_pk_fma_f32 v[214:215], v[204:205], v[196:197], v[214:215]
    v_pk_fma_f32 v[214:215], v[206:207], v[194:195], v[214:215]
    v_pk_fma_f32 v[214:215], v[208:209], v[192:193], v[214:215]
    v_cvt_pk_bf16_f32 v214, v214, v215
    v_and_b32 v215, 0xffff0000, v214
    v_lshlrev_b32 v214, 16, v214
    v_lshlrev_b32 v14, 16, v160
    v_and_b32 v15, 0xffff0000, v160
    v_mul_f32 v217, v214, v14
    v_mul_f32 v221, v215, v15
    v_pk_mul_f32 v[214:215], v[204:205], v[198:199]
    v_pk_fma_f32 v[214:215], v[206:207], v[196:197], v[214:215]
    v_pk_fma_f32 v[214:215], v[208:209], v[194:195], v[214:215]
    v_pk_fma_f32 v[214:215], v[210:211], v[192:193], v[214:215]
    v_cvt_pk_bf16_f32 v214, v214, v215
    v_and_b32 v215, 0xffff0000, v214
    v_lshlrev_b32 v214, 16, v214
    v_lshlrev_b32 v14, 16, v164
    v_and_b32 v15, 0xffff0000, v164
    v_mul_f32 v218, v214, v14
    v_mul_f32 v222, v215, v15
    v_pk_mul_f32 v[214:215], v[206:207], v[198:199]
    v_pk_fma_f32 v[214:215], v[208:209], v[196:197], v[214:215]
    v_pk_fma_f32 v[214:215], v[210:211], v[194:195], v[214:215]
    v_pk_fma_f32 v[214:215], v[212:213], v[192:193], v[214:215]
    v_cvt_pk_bf16_f32 v214, v214, v215
    v_and_b32 v215, 0xffff0000, v214
    v_lshlrev_b32 v214, 16, v214
    v_lshlrev_b32 v14, 16, v168
    v_and_b32 v15, 0xffff0000, v168
    v_mul_f32 v219, v214, v14
    v_mul_f32 v223, v215, v15
    v_cvt_pk_bf16_f32 v224, v219, v218
    v_cvt_pk_bf16_f32 v225, v217, v216
    v_cvt_pk_bf16_f32 v226, v223, v222
    v_cvt_pk_bf16_f32 v227, v221, v220
    ds_write_b64 v10, v[224:225] offset:0
    ds_write_b64 v10, v[226:227] offset:128
    v_lshlrev_b32 v192, 16, v176
    v_lshlrev_b32 v193, 16, v178
    v_and_b32 v194, 0xffff0000, v176
    v_and_b32 v195, 0xffff0000, v178
    v_lshlrev_b32 v196, 16, v177
    v_lshlrev_b32 v197, 16, v179
    v_and_b32 v198, 0xffff0000, v177
    v_and_b32 v199, 0xffff0000, v179
    v_lshlrev_b32 v200, 16, v129
    v_and_b32 v201, 0xffff0000, v129
    v_lshlrev_b32 v202, 16, v133
    v_and_b32 v203, 0xffff0000, v133
    v_lshlrev_b32 v204, 16, v137
    v_and_b32 v205, 0xffff0000, v137
    v_lshlrev_b32 v206, 16, v141
    v_and_b32 v207, 0xffff0000, v141
    v_lshlrev_b32 v208, 16, v145
    v_and_b32 v209, 0xffff0000, v145
    v_lshlrev_b32 v210, 16, v149
    v_and_b32 v211, 0xffff0000, v149
    v_lshlrev_b32 v212, 16, v153
    v_and_b32 v213, 0xffff0000, v153
    v_pk_mul_f32 v[214:215], v[200:201], v[198:199]
    v_pk_fma_f32 v[214:215], v[202:203], v[196:197], v[214:215]
    v_pk_fma_f32 v[214:215], v[204:205], v[194:195], v[214:215]
    v_pk_fma_f32 v[214:215], v[206:207], v[192:193], v[214:215]
    v_cvt_pk_bf16_f32 v214, v214, v215
    v_and_b32 v215, 0xffff0000, v214
    v_lshlrev_b32 v214, 16, v214
    v_lshlrev_b32 v14, 16, v157
    v_and_b32 v15, 0xffff0000, v157
    v_mul_f32 v216, v214, v14
    v_mul_f32 v220, v215, v15
    v_pk_mul_f32 v[214:215], v[202:203], v[198:199]
    v_pk_fma_f32 v[214:215], v[204:205], v[196:197], v[214:215]
    v_pk_fma_f32 v[214:215], v[206:207], v[194:195], v[214:215]
    v_pk_fma_f32 v[214:215], v[208:209], v[192:193], v[214:215]
    v_cvt_pk_bf16_f32 v214, v214, v215
    v_and_b32 v215, 0xffff0000, v214
    v_lshlrev_b32 v214, 16, v214
    v_lshlrev_b32 v14, 16, v161
    v_and_b32 v15, 0xffff0000, v161
    v_mul_f32 v217, v214, v14
    v_mul_f32 v221, v215, v15
    v_pk_mul_f32 v[214:215], v[204:205], v[198:199]
    v_pk_fma_f32 v[214:215], v[206:207], v[196:197], v[214:215]
    v_pk_fma_f32 v[214:215], v[208:209], v[194:195], v[214:215]
    v_pk_fma_f32 v[214:215], v[210:211], v[192:193], v[214:215]
    v_cvt_pk_bf16_f32 v214, v214, v215
    v_and_b32 v215, 0xffff0000, v214
    v_lshlrev_b32 v214, 16, v214
    v_lshlrev_b32 v14, 16, v165
    v_and_b32 v15, 0xffff0000, v165
    v_mul_f32 v218, v214, v14
    v_mul_f32 v222, v215, v15
    v_pk_mul_f32 v[214:215], v[206:207], v[198:199]
    v_pk_fma_f32 v[214:215], v[208:209], v[196:197], v[214:215]
    v_pk_fma_f32 v[214:215], v[210:211], v[194:195], v[214:215]
    v_pk_fma_f32 v[214:215], v[212:213], v[192:193], v[214:215]
    v_cvt_pk_bf16_f32 v214, v214, v215
    v_and_b32 v215, 0xffff0000, v214
    v_lshlrev_b32 v214, 16, v214
    v_lshlrev_b32 v14, 16, v169
    v_and_b32 v15, 0xffff0000, v169
    v_mul_f32 v219, v214, v14
    v_mul_f32 v223, v215, v15
    v_cvt_pk_bf16_f32 v228, v219, v218
    v_cvt_pk_bf16_f32 v229, v217, v216
    v_cvt_pk_bf16_f32 v230, v223, v222
    v_cvt_pk_bf16_f32 v231, v221, v220
    ds_write_b64 v10, v[228:229] offset:256
    ds_write_b64 v10, v[230:231] offset:384
    v_lshlrev_b32 v192, 16, v180
    v_lshlrev_b32 v193, 16, v182
    v_and_b32 v194, 0xffff0000, v180
    v_and_b32 v195, 0xffff0000, v182
    v_lshlrev_b32 v196, 16, v181
    v_lshlrev_b32 v197, 16, v183
    v_and_b32 v198, 0xffff0000, v181
    v_and_b32 v199, 0xffff0000, v183
    v_lshlrev_b32 v200, 16, v130
    v_and_b32 v201, 0xffff0000, v130
    v_lshlrev_b32 v202, 16, v134
    v_and_b32 v203, 0xffff0000, v134
    v_lshlrev_b32 v204, 16, v138
    v_and_b32 v205, 0xffff0000, v138
    v_lshlrev_b32 v206, 16, v142
    v_and_b32 v207, 0xffff0000, v142
    v_lshlrev_b32 v208, 16, v146
    v_and_b32 v209, 0xffff0000, v146
    v_lshlrev_b32 v210, 16, v150
    v_and_b32 v211, 0xffff0000, v150
    v_lshlrev_b32 v212, 16, v154
    v_and_b32 v213, 0xffff0000, v154
    v_pk_mul_f32 v[214:215], v[200:201], v[198:199]
    v_pk_fma_f32 v[214:215], v[202:203], v[196:197], v[214:215]
    v_pk_fma_f32 v[214:215], v[204:205], v[194:195], v[214:215]
    v_pk_fma_f32 v[214:215], v[206:207], v[192:193], v[214:215]
    v_cvt_pk_bf16_f32 v214, v214, v215
    v_and_b32 v215, 0xffff0000, v214
    v_lshlrev_b32 v214, 16, v214
    v_lshlrev_b32 v14, 16, v158
    v_and_b32 v15, 0xffff0000, v158
    v_mul_f32 v216, v214, v14
    v_mul_f32 v220, v215, v15
    v_pk_mul_f32 v[214:215], v[202:203], v[198:199]
    v_pk_fma_f32 v[214:215], v[204:205], v[196:197], v[214:215]
    v_pk_fma_f32 v[214:215], v[206:207], v[194:195], v[214:215]
    v_pk_fma_f32 v[214:215], v[208:209], v[192:193], v[214:215]
    v_cvt_pk_bf16_f32 v214, v214, v215
    v_and_b32 v215, 0xffff0000, v214
    v_lshlrev_b32 v214, 16, v214
    v_lshlrev_b32 v14, 16, v162
    v_and_b32 v15, 0xffff0000, v162
    v_mul_f32 v217, v214, v14
    v_mul_f32 v221, v215, v15
    v_pk_mul_f32 v[214:215], v[204:205], v[198:199]
    v_pk_fma_f32 v[214:215], v[206:207], v[196:197], v[214:215]
    v_pk_fma_f32 v[214:215], v[208:209], v[194:195], v[214:215]
    v_pk_fma_f32 v[214:215], v[210:211], v[192:193], v[214:215]
    v_cvt_pk_bf16_f32 v214, v214, v215
    v_and_b32 v215, 0xffff0000, v214
    v_lshlrev_b32 v214, 16, v214
    v_lshlrev_b32 v14, 16, v166
    v_and_b32 v15, 0xffff0000, v166
    v_mul_f32 v218, v214, v14
    v_mul_f32 v222, v215, v15
    v_pk_mul_f32 v[214:215], v[206:207], v[198:199]
    v_pk_fma_f32 v[214:215], v[208:209], v[196:197], v[214:215]
    v_pk_fma_f32 v[214:215], v[210:211], v[194:195], v[214:215]
    v_pk_fma_f32 v[214:215], v[212:213], v[192:193], v[214:215]
    v_cvt_pk_bf16_f32 v214, v214, v215
    v_and_b32 v215, 0xffff0000, v214
    v_lshlrev_b32 v214, 16, v214
    v_lshlrev_b32 v14, 16, v170
    v_and_b32 v15, 0xffff0000, v170
    v_mul_f32 v219, v214, v14
    v_mul_f32 v223, v215, v15
    v_cvt_pk_bf16_f32 v224, v219, v218
    v_cvt_pk_bf16_f32 v225, v217, v216
    v_cvt_pk_bf16_f32 v226, v223, v222
    v_cvt_pk_bf16_f32 v227, v221, v220
    ds_write_b64 v10, v[224:225] offset:512
    ds_write_b64 v10, v[226:227] offset:640
    v_lshlrev_b32 v192, 16, v184
    v_lshlrev_b32 v193, 16, v186
    v_and_b32 v194, 0xffff0000, v184
    v_and_b32 v195, 0xffff0000, v186
    v_lshlrev_b32 v196, 16, v185
    v_lshlrev_b32 v197, 16, v187
    v_and_b32 v198, 0xffff0000, v185
    v_and_b32 v199, 0xffff0000, v187
    v_lshlrev_b32 v200, 16, v131
    v_and_b32 v201, 0xffff0000, v131
    v_lshlrev_b32 v202, 16, v135
    v_and_b32 v203, 0xffff0000, v135
    v_lshlrev_b32 v204, 16, v139
    v_and_b32 v205, 0xffff0000, v139
    v_lshlrev_b32 v206, 16, v143
    v_and_b32 v207, 0xffff0000, v143
    v_lshlrev_b32 v208, 16, v147
    v_and_b32 v209, 0xffff0000, v147
    v_lshlrev_b32 v210, 16, v151
    v_and_b32 v211, 0xffff0000, v151
    v_lshlrev_b32 v212, 16, v155
    v_and_b32 v213, 0xffff0000, v155
    v_pk_mul_f32 v[214:215], v[200:201], v[198:199]
    v_pk_fma_f32 v[214:215], v[202:203], v[196:197], v[214:215]
    v_pk_fma_f32 v[214:215], v[204:205], v[194:195], v[214:215]
    v_pk_fma_f32 v[214:215], v[206:207], v[192:193], v[214:215]
    v_cvt_pk_bf16_f32 v214, v214, v215
    v_and_b32 v215, 0xffff0000, v214
    v_lshlrev_b32 v214, 16, v214
    v_lshlrev_b32 v14, 16, v159
    v_and_b32 v15, 0xffff0000, v159
    v_mul_f32 v216, v214, v14
    v_mul_f32 v220, v215, v15
    v_pk_mul_f32 v[214:215], v[202:203], v[198:199]
    v_pk_fma_f32 v[214:215], v[204:205], v[196:197], v[214:215]
    v_pk_fma_f32 v[214:215], v[206:207], v[194:195], v[214:215]
    v_pk_fma_f32 v[214:215], v[208:209], v[192:193], v[214:215]
    v_cvt_pk_bf16_f32 v214, v214, v215
    v_and_b32 v215, 0xffff0000, v214
    v_lshlrev_b32 v214, 16, v214
    v_lshlrev_b32 v14, 16, v163
    v_and_b32 v15, 0xffff0000, v163
    v_mul_f32 v217, v214, v14
    v_mul_f32 v221, v215, v15
    v_pk_mul_f32 v[214:215], v[204:205], v[198:199]
    v_pk_fma_f32 v[214:215], v[206:207], v[196:197], v[214:215]
    v_pk_fma_f32 v[214:215], v[208:209], v[194:195], v[214:215]
    v_pk_fma_f32 v[214:215], v[210:211], v[192:193], v[214:215]
    v_cvt_pk_bf16_f32 v214, v214, v215
    v_and_b32 v215, 0xffff0000, v214
    v_lshlrev_b32 v214, 16, v214
    v_lshlrev_b32 v14, 16, v167
    v_and_b32 v15, 0xffff0000, v167
    v_mul_f32 v218, v214, v14
    v_mul_f32 v222, v215, v15
    v_pk_mul_f32 v[214:215], v[206:207], v[198:199]
    v_pk_fma_f32 v[214:215], v[208:209], v[196:197], v[214:215]
    v_pk_fma_f32 v[214:215], v[210:211], v[194:195], v[214:215]
    v_pk_fma_f32 v[214:215], v[212:213], v[192:193], v[214:215]
    v_cvt_pk_bf16_f32 v214, v214, v215
    v_and_b32 v215, 0xffff0000, v214
    v_lshlrev_b32 v214, 16, v214
    v_lshlrev_b32 v14, 16, v171
    v_and_b32 v15, 0xffff0000, v171
    v_mul_f32 v219, v214, v14
    v_mul_f32 v223, v215, v15
    v_cvt_pk_bf16_f32 v228, v219, v218
    v_cvt_pk_bf16_f32 v229, v217, v216
    v_cvt_pk_bf16_f32 v230, v223, v222
    v_cvt_pk_bf16_f32 v231, v221, v220
    ds_write_b64 v10, v[228:229] offset:768
    ds_write_b64 v10, v[230:231] offset:896
    s_waitcnt lgkmcnt(0)
    s_barrier
    ds_read_b128 v[64:67], v11 offset:0
    ds_read_b128 v[68:71], v11 offset:1024
    ds_read_b128 v[72:75], v11 offset:2048
    ds_read_b128 v[76:79], v11 offset:3072
    s_waitcnt lgkmcnt(0)
    s_barrier
    v_add_u32 v7, 0, v12
    buffer_store_dwordx4 v[64:67], v7, s[28:31], s42 offen
    v_add_u32 v7, 32768, v12
    buffer_store_dwordx4 v[68:71], v7, s[28:31], s42 offen
    v_add_u32 v7, 65536, v12
    buffer_store_dwordx4 v[72:75], v7, s[28:31], s42 offen
    v_add_u32 v7, 98304, v12
    buffer_store_dwordx4 v[76:79], v7, s[28:31], s42 offen
    s_add_u32 s42, s42, 524288
    s_sub_u32 s39, s39, 1
    s_cmp_lg_u32 s39, 0
    s_cbranch_scc1 k1_kernel_kv
k1_kernel_end:
    s_endpgm
.section .rodata,"a"
.p2align 6
.amdhsa_kernel k1_kernel
  .amdhsa_next_free_vgpr 512
  .amdhsa_next_free_sgpr 102
  .amdhsa_accum_offset 256
  .amdhsa_group_segment_fixed_size 0
  .amdhsa_kernarg_size 104
  .amdhsa_user_sgpr_count 2
  .amdhsa_user_sgpr_kernarg_segment_ptr 1
  .amdhsa_system_sgpr_workgroup_id_x 1
.end_amdhsa_kernel
.text
.text
.globl k2_kernel
.p2align 8
.type k2_kernel,@function
k2_kernel:

    s_cmp_ge_u32 s2, 256
    s_cbranch_scc1 k2_kernel_end
    s_load_dwordx2 s[4:5], s[0:1], 96
    s_load_dwordx4 s[52:55], s[0:1], 72
    s_load_dwordx2 s[50:51], s[0:1], 0
    s_load_dwordx4 s[44:47], s[0:1], 32
    v_lshrrev_b32 v1, 6, v0
    v_and_b32 v2, 63, v0
    v_mov_b32 v3, 150528
    v_readfirstlane_b32 s32, v1
    v_mov_b32 v8, 0
    v_mov_b32 v9, 0
    v_mov_b32 v10, 0
    v_mov_b32 v11, 0
    ds_write_b128 v3, v[8:11]
    s_waitcnt lgkmcnt(0)
    s_barrier
    s_and_b32 s56, s2, 7
    s_lshr_b32 s57, s2, 3
    s_and_b32 s58, s56, 3
    s_lshl_b32 s58, s58, 2
    s_and_b32 s59, s57, 3
    s_add_u32 s36, s58, s59
    s_lshr_b32 s58, s56, 2
    s_lshl_b32 s58, s58, 3
    s_lshr_b32 s59, s57, 2
    s_add_u32 s37, s58, s59
    s_cmp_ge_u32 s32, 4
    s_cbranch_scc1 k2_kernel_help
    v_lshrrev_b32 v3, 3, v2
    v_bfe_u32 v4, v2, 1, 2
    v_bfe_u32 v5, v2, 4, 2
    v_xor_b32 v4, v4, v5
    v_and_b32 v5, 1, v2
    v_lshl_add_u32 v4, v4, 1, v5
    v_lshlrev_b32 v4, 4, v4
    s_mul_i32 s56, s32, 32
    v_add_u32 v3, s56, v3
    v_lshlrev_b32 v3, 11, v3
    s_lshl_b32 s56, s37, 7
    v_add3_u32 v14, v3, v4, s56
    v_add_u32 v15, 16384, v14
    v_add_u32 v16, 32768, v14
    v_add_u32 v17, 49152, v14
    s_mul_i32 s39, s32, 4096
    s_lshl_b32 s56, s36, 3
    s_lshl_b32 s57, s32, 1
    s_add_u32 s56, s56, s57
    s_mul_i32 s56, s56, 114688
    v_lshlrev_b32 v3, 4, v2
    v_add_u32 v8, s56, v3
    v_add_u32 v9, 114688, v8
    s_mov_b32 s33, 0
    s_mov_b32 s34, 0
    s_mov_b32 s38, 0
    s_waitcnt lgkmcnt(0)
    s_add_u32 s8, s4, 8388608
    s_addc_u32 s9, s5, 0
    s_mov_b32 s10, 14680064
    s_mov_b32 s11, 0x00020000
    s_mov_b32 s12, s52
    s_mov_b32 s13, s53
    s_mov_b32 s14, 7340032
    s_mov_b32 s15, 0x00020000
    s_add_u32 m0, s38, s39
    s_nop 0
    buffer_load_dwordx4 v14, s[12:15], s34 offen lds
    s_add_u32 m0, s38, s39
    s_add_u32 m0, m0, 1024
    buffer_load_dwordx4 v15, s[12:15], s34 offen lds
    s_add_u32 m0, s38, s39
    s_add_u32 m0, m0, 2048
    buffer_load_dwordx4 v16, s[12:15], s34 offen lds
    s_add_u32 m0, s38, s39
    s_add_u32 m0, m0, 3072
    buffer_load_dwordx4 v17, s[12:15], s34 offen lds
    s_add_u32 s34, s34, 262144
    s_add_u32 s38, s38, 16384
    s_and_b32 s38, s38, 65535
    buffer_load_dwordx4 v[64:67], v8, s[8:11], s33 offen
    buffer_load_dwordx4 v[68:71], v9, s[8:11], s33 offen
    s_add_u32 s33, s33, 1024
    buffer_load_dwordx4 v[72:75], v8, s[8:11], s33 offen
    buffer_load_dwordx4 v[76:79], v9, s[8:11], s33 offen
    s_add_u32 s33, s33, 1024
    s_add_u32 m0, s38, s39
    s_nop 0
    buffer_load_dwordx4 v14, s[12:15], s34 offen lds
    s_add_u32 m0, s38, s39
    s_add_u32 m0, m0, 1024
    buffer_load_dwordx4 v15, s[12:15], s34 offen lds
    buffer_load_dwordx4 v[80:83], v8, s[8:11], s33 offen
    buffer_load_dwordx4 v[84:87], v9, s[8:11], s33 offen
    s_add_u32 s33, s33, 1024
    s_add_u32 m0, s38, s39
    s_add_u32 m0, m0, 2048
    buffer_load_dwordx4 v16, s[12:15], s34 offen lds
    s_add_u32 m0, s38, s39
    s_add_u32 m0, m0, 3072
    buffer_load_dwordx4 v17, s[12:15], s34 offen lds
    s_add_u32 s34, s34, 262144
    s_add_u32 s38, s38, 16384
    s_and_b32 s38, s38, 65535
    buffer_load_dwordx4 v[88:91], v8, s[8:11], s33 offen
    buffer_load_dwordx4 v[92:95], v9, s[8:11], s33 offen
    s_add_u32 s33, s33, 1024
    buffer_load_dwordx4 v[96:99], v8, s[8:11], s33 offen
    buffer_load_dwordx4 v[100:103], v9, s[8:11], s33 offen
    s_add_u32 s33, s33, 1024
    buffer_load_dwordx4 v[104:107], v8, s[8:11], s33 offen
    buffer_load_dwordx4 v[108:111], v9, s[8:11], s33 offen
    s_add_u32 s33, s33, 1024
    s_add_u32 m0, s38, s39
    s_nop 0
    buffer_load_dwordx4 v14, s[12:15], s34 offen lds
    s_add_u32 m0, s38, s39
    s_add_u32 m0, m0, 1024
    buffer_load_dwordx4 v15, s[12:15], s34 offen lds
    buffer_load_dwordx4 v[112:115], v8, s[8:11], s33 offen
    buffer_load_dwordx4 v[116:119], v9, s[8:11], s33 offen
    s_add_u32 s33, s33, 1024
    s_add_u32 m0, s38, s39
    s_add_u32 m0, m0, 2048
    buffer_load_dwordx4 v16, s[12:15], s34 offen lds
    s_add_u32 m0, s38, s39
    s_add_u32 m0, m0, 3072
    buffer_load_dwordx4 v17, s[12:15], s34 offen lds
    s_add_u32 s34, s34, 262144
    s_add_u32 s38, s38, 16384
    s_and_b32 s38, s38, 65535
    buffer_load_dwordx4 v[120:123], v8, s[8:11], s33 offen
    buffer_load_dwordx4 v[124:127], v9, s[8:11], s33 offen
    s_add_u32 s33, s33, 1024
    v_lshrrev_b32 v3, 4, v2
    v_bfe_u32 v4, v2, 2, 2
    v_and_b32 v5, 3, v2
    v_lshl_add_u32 v3, v3, 2, v4
    v_bfe_u32 v4, v3, 1, 2
    v_lshlrev_b32 v3, 7, v3
    v_lshl_add_u32 v3, v5, 3, v3
    v_xor_b32 v5, 0, v4
    v_lshl_add_u32 v10, v5, 5, v3
    v_xor_b32 v5, 1, v4
    v_lshl_add_u32 v11, v5, 5, v3
    v_xor_b32 v5, 2, v4
    v_lshl_add_u32 v12, v5, 5, v3
    v_xor_b32 v5, 3, v4
    v_lshl_add_u32 v13, v5, 5, v3
    v_mov_b32 v192, 0
    v_mov_b32 v193, 0
    v_mov_b32 v194, 0
    v_mov_b32 v195, 0
    v_mov_b32 v196, 0
    v_mov_b32 v197, 0
    v_mov_b32 v198, 0
    v_mov_b32 v199, 0
    v_mov_b32 v200, 0
    v_mov_b32 v201, 0
    v_mov_b32 v202, 0
    v_mov_b32 v203, 0
    v_mov_b32 v204, 0
    v_mov_b32 v205, 0
    v_mov_b32 v206, 0
    v_mov_b32 v207, 0
    v_mov_b32 v208, 0
    v_mov_b32 v209, 0
    v_mov_b32 v210, 0
    v_mov_b32 v211, 0
    v_mov_b32 v212, 0
    v_mov_b32 v213, 0
    v_mov_b32 v214, 0
    v_mov_b32 v215, 0
    v_mov_b32 v216, 0
    v_mov_b32 v217, 0
    v_mov_b32 v218, 0
    v_mov_b32 v219, 0
    v_mov_b32 v220, 0
    v_mov_b32 v221, 0
    v_mov_b32 v222, 0
    v_mov_b32 v223, 0
    s_mov_b32 s16, s54
    s_mov_b32 s17, s55
    s_mov_b32 s18, 4194304
    s_mov_b32 s19, 0x00020000
    v_lshrrev_b32 v3, 4, v2
    v_and_b32 v4, 1, v3
    v_lshlrev_b32 v4, 4, v4
    v_lshrrev_b32 v5, 1, v3
    v_lshl_add_u32 v4, v5, 3, v4
    s_lshl_b32 s56, s37, 6
    v_add_u32 v7, s56, v4
    s_lshl_b32 s56, s36, 7
    s_lshl_b32 s57, s32, 5
    s_add_u32 s56, s56, s57
    v_and_b32 v5, 15, v2
    v_add_u32 v6, s56, v5
    v_lshlrev_b32 v6, 11, v6
    v_lshl_add_u32 v6, v7, 1, v6
    s_mul_i32 s56, s32, 21248
    s_add_u32 s56, s56, 65536
    v_lshlrev_b32 v18, 7, v5
    v_lshl_add_u32 v18, v4, 1, v18
    v_add_u32 v18, s56, v18
    v_lshlrev_b32 v19, 6, v4
    v_lshl_add_u32 v19, v5, 3, v19
    v_add_u32 v19, s56, v19
    v_mov_b32 v20, 150528
    v_mov_b32 v21, 1
    s_waitcnt vmcnt(24)
    s_mov_b64 exec, 1
    ds_add_u32 v20, v21
    s_mov_b64 exec, -1
    s_mov_b32 s61, 4
k2_kernel_s0:
    ds_read_b32 v22, v20
    s_waitcnt lgkmcnt(0)
    v_readfirstlane_b32 s62, v22
    s_nop 3
    s_cmp_ge_u32 s62, s61
    s_cbranch_scc0 k2_kernel_s0
    ds_read_b64_tr_b16 v[32:33], v10 offset:0
    ds_read_b64_tr_b16 v[34:35], v10 offset:2048
    ds_read_b64_tr_b16 v[36:37], v11 offset:0
    ds_read_b64_tr_b16 v[38:39], v11 offset:2048
    ds_read_b64_tr_b16 v[40:41], v12 offset:0
    ds_read_b64_tr_b16 v[42:43], v12 offset:2048
    ds_read_b64_tr_b16 v[44:45], v13 offset:0
    ds_read_b64_tr_b16 v[46:47], v13 offset:2048
    s_mov_b32 s35, 7
k2_kernel_loop:
    s_waitcnt vmcnt(14)
    s_mov_b64 exec, 1
    ds_add_u32 v20, v21
    s_mov_b64 exec, -1
    s_add_u32 s61, s61, 4
    s_waitcnt lgkmcnt(7)
    v_mfma_f32_16x16x32_bf16 v[192:195], v[32:35], v[64:67], v[192:195]
    ds_read_b64_tr_b16 v[48:49], v10 offset:4096
    ds_read_b64_tr_b16 v[50:51], v10 offset:6144
    v_mfma_f32_16x16x32_bf16 v[196:199], v[32:35], v[68:71], v[196:199]
    s_waitcnt lgkmcnt(7)
    v_mfma_f32_16x16x32_bf16 v[200:203], v[36:39], v[64:67], v[200:203]
    ds_read_b64_tr_b16 v[52:53], v11 offset:4096
    ds_read_b64_tr_b16 v[54:55], v11 offset:6144
    v_mfma_f32_16x16x32_bf16 v[204:207], v[36:39], v[68:71], v[204:207]
    s_waitcnt lgkmcnt(7)
    v_mfma_f32_16x16x32_bf16 v[208:211], v[40:43], v[64:67], v[208:211]
    ds_read_b64_tr_b16 v[56:57], v12 offset:4096
    ds_read_b64_tr_b16 v[58:59], v12 offset:6144
    v_mfma_f32_16x16x32_bf16 v[212:215], v[40:43], v[68:71], v[212:215]
    s_waitcnt lgkmcnt(7)
    v_mfma_f32_16x16x32_bf16 v[216:219], v[44:47], v[64:67], v[216:219]
    ds_read_b64_tr_b16 v[60:61], v13 offset:4096
    ds_read_b64_tr_b16 v[62:63], v13 offset:6144
    v_mfma_f32_16x16x32_bf16 v[220:223], v[44:47], v[68:71], v[220:223]
    buffer_load_dwordx4 v[64:67], v8, s[8:11], s33 offen
    buffer_load_dwordx4 v[68:71], v9, s[8:11], s33 offen
    s_add_u32 s33, s33, 1024
    ds_read_b32 v22, v20
    s_waitcnt lgkmcnt(7)
    v_mfma_f32_16x16x32_bf16 v[192:195], v[48:51], v[72:75], v[192:195]
    ds_read_b64_tr_b16 v[32:33], v10 offset:8192
    ds_read_b64_tr_b16 v[34:35], v10 offset:10240
    v_mfma_f32_16x16x32_bf16 v[196:199], v[48:51], v[76:79], v[196:199]
    s_waitcnt lgkmcnt(7)
    v_mfma_f32_16x16x32_bf16 v[200:203], v[52:55], v[72:75], v[200:203]
    ds_read_b64_tr_b16 v[36:37], v11 offset:8192
    ds_read_b64_tr_b16 v[38:39], v11 offset:10240
    v_mfma_f32_16x16x32_bf16 v[204:207], v[52:55], v[76:79], v[204:207]
    s_waitcnt lgkmcnt(7)
    v_mfma_f32_16x16x32_bf16 v[208:211], v[56:59], v[72:75], v[208:211]
    ds_read_b64_tr_b16 v[40:41], v12 offset:8192
    ds_read_b64_tr_b16 v[42:43], v12 offset:10240
    v_mfma_f32_16x16x32_bf16 v[212:215], v[56:59], v[76:79], v[212:215]
    s_waitcnt lgkmcnt(7)
    v_mfma_f32_16x16x32_bf16 v[216:219], v[60:63], v[72:75], v[216:219]
    ds_read_b64_tr_b16 v[44:45], v13 offset:8192
    ds_read_b64_tr_b16 v[46:47], v13 offset:10240
    v_mfma_f32_16x16x32_bf16 v[220:223], v[60:63], v[76:79], v[220:223]
    buffer_load_dwordx4 v[72:75], v8, s[8:11], s33 offen
    buffer_load_dwordx4 v[76:79], v9, s[8:11], s33 offen
    s_add_u32 s33, s33, 1024
    s_waitcnt lgkmcnt(8)
    v_readfirstlane_b32 s62, v22
    s_nop 3
    s_cmp_ge_u32 s62, s61
    s_cbranch_scc1 k2_kernel_sp0_ok
k2_kernel_sp0:
    ds_read_b32 v22, v20
    s_waitcnt lgkmcnt(0)
    v_readfirstlane_b32 s62, v22
    s_nop 3
    s_cmp_ge_u32 s62, s61
    s_cbranch_scc0 k2_kernel_sp0
k2_kernel_sp0_ok:
    s_waitcnt lgkmcnt(6)
    v_mfma_f32_16x16x32_bf16 v[192:195], v[32:35], v[80:83], v[192:195]
    ds_read_b64_tr_b16 v[48:49], v10 offset:12288
    ds_read_b64_tr_b16 v[50:51], v10 offset:14336
    v_mfma_f32_16x16x32_bf16 v[196:199], v[32:35], v[84:87], v[196:199]
    s_add_u32 m0, s38, s39
    s_nop 0
    buffer_load_dwordx4 v14, s[12:15], s34 offen lds
    s_waitcnt lgkmcnt(6)
    v_mfma_f32_16x16x32_bf16 v[200:203], v[36:39], v[80:83], v[200:203]
    ds_read_b64_tr_b16 v[52:53], v11 offset:12288
    ds_read_b64_tr_b16 v[54:55], v11 offset:14336
    v_mfma_f32_16x16x32_bf16 v[204:207], v[36:39], v[84:87], v[204:207]
    s_waitcnt lgkmcnt(6)
    v_mfma_f32_16x16x32_bf16 v[208:211], v[40:43], v[80:83], v[208:211]
    ds_read_b64_tr_b16 v[56:57], v12 offset:12288
    ds_read_b64_tr_b16 v[58:59], v12 offset:14336
    v_mfma_f32_16x16x32_bf16 v[212:215], v[40:43], v[84:87], v[212:215]
    s_add_u32 m0, s38, s39
    s_add_u32 m0, m0, 1024
    buffer_load_dwordx4 v15, s[12:15], s34 offen lds
    s_waitcnt lgkmcnt(6)
    v_mfma_f32_16x16x32_bf16 v[216:219], v[44:47], v[80:83], v[216:219]
    ds_read_b64_tr_b16 v[60:61], v13 offset:12288
    ds_read_b64_tr_b16 v[62:63], v13 offset:14336
    v_mfma_f32_16x16x32_bf16 v[220:223], v[44:47], v[84:87], v[220:223]
    buffer_load_dwordx4 v[80:83], v8, s[8:11], s33 offen
    buffer_load_dwordx4 v[84:87], v9, s[8:11], s33 offen
    s_add_u32 s33, s33, 1024
    s_waitcnt vmcnt(20)
    s_waitcnt lgkmcnt(6)
    v_mfma_f32_16x16x32_bf16 v[192:195], v[48:51], v[88:91], v[192:195]
    ds_read_b64_tr_b16 v[32:33], v10 offset:16384
    ds_read_b64_tr_b16 v[34:35], v10 offset:18432
    v_mfma_f32_16x16x32_bf16 v[196:199], v[48:51], v[92:95], v[196:199]
    s_add_u32 m0, s38, s39
    s_add_u32 m0, m0, 2048
    buffer_load_dwordx4 v16, s[12:15], s34 offen lds
    s_waitcnt lgkmcnt(6)
    v_mfma_f32_16x16x32_bf16 v[200:203], v[52:55], v[88:91], v[200:203]
    ds_read_b64_tr_b16 v[36:37], v11 offset:16384
    ds_read_b64_tr_b16 v[38:39], v11 offset:18432
    v_mfma_f32_16x16x32_bf16 v[204:207], v[52:55], v[92:95], v[204:207]
    s_waitcnt lgkmcnt(6)
    v_mfma_f32_16x16x32_bf16 v[208:211], v[56:59], v[88:91], v[208:211]
    ds_read_b64_tr_b16 v[40:41], v12 offset:16384
    ds_read_b64_tr_b16 v[42:43], v12 offset:18432
    v_mfma_f32_16x16x32_bf16 v[212:215], v[56:59], v[92:95], v[212:215]
    s_add_u32 m0, s38, s39
    s_add_u32 m0, m0, 3072
    buffer_load_dwordx4 v17, s[12:15], s34 offen lds
    s_add_u32 s34, s34, 262144
    s_add_u32 s38, s38, 16384
    s_and_b32 s38, s38, 65535
    s_waitcnt lgkmcnt(6)
    v_mfma_f32_16x16x32_bf16 v[216:219], v[60:63], v[88:91], v[216:219]
    ds_read_b64_tr_b16 v[44:45], v13 offset:16384
    ds_read_b64_tr_b16 v[46:47], v13 offset:18432
    v_mfma_f32_16x16x32_bf16 v[220:223], v[60:63], v[92:95], v[220:223]
    buffer_load_dwordx4 v[88:91], v8, s[8:11], s33 offen
    buffer_load_dwordx4 v[92:95], v9, s[8:11], s33 offen
    s_add_u32 s33, s33, 1024
    s_waitcnt vmcnt(14)
    s_mov_b64 exec, 1
    ds_add_u32 v20, v21
    s_mov_b64 exec, -1
    s_add_u32 s61, s61, 4
    s_waitcnt lgkmcnt(7)
    v_mfma_f32_16x16x32_bf16 v[192:195], v[32:35], v[96:99], v[192:195]
    ds_read_b64_tr_b16 v[48:49], v10 offset:20480
    ds_read_b64_tr_b16 v[50:51], v10 offset:22528
    v_mfma_f32_16x16x32_bf16 v[196:199], v[32:35], v[100:103], v[196:199]
    s_waitcnt lgkmcnt(7)
    v_mfma_f32_16x16x32_bf16 v[200:203], v[36:39], v[96:99], v[200:203]
    ds_read_b64_tr_b16 v[52:53], v11 offset:20480
    ds_read_b64_tr_b16 v[54:55], v11 offset:22528
    v_mfma_f32_16x16x32_bf16 v[204:207], v[36:39], v[100:103], v[204:207]
    s_waitcnt lgkmcnt(7)
    v_mfma_f32_16x16x32_bf16 v[208:211], v[40:43], v[96:99], v[208:211]
    ds_read_b64_tr_b16 v[56:57], v12 offset:20480
    ds_read_b64_tr_b16 v[58:59], v12 offset:22528
    v_mfma_f32_16x16x32_bf16 v[212:215], v[40:43], v[100:103], v[212:215]
    s_waitcnt lgkmcnt(7)
    v_mfma_f32_16x16x32_bf16 v[216:219], v[44:47], v[96:99], v[216:219]
    ds_read_b64_tr_b16 v[60:61], v13 offset:20480
    ds_read_b64_tr_b16 v[62:63], v13 offset:22528
    v_mfma_f32_16x16x32_bf16 v[220:223], v[44:47], v[100:103], v[220:223]
    buffer_load_dwordx4 v[96:99], v8, s[8:11], s33 offen
    buffer_load_dwordx4 v[100:103], v9, s[8:11], s33 offen
    s_add_u32 s33, s33, 1024
    ds_read_b32 v22, v20
    s_waitcnt lgkmcnt(7)
    v_mfma_f32_16x16x32_bf16 v[192:195], v[48:51], v[104:107], v[192:195]
    ds_read_b64_tr_b16 v[32:33], v10 offset:24576
    ds_read_b64_tr_b16 v[34:35], v10 offset:26624
    v_mfma_f32_16x16x32_bf16 v[196:199], v[48:51], v[108:111], v[196:199]
    s_waitcnt lgkmcnt(7)
    v_mfma_f32_16x16x32_bf16 v[200:203], v[52:55], v[104:107], v[200:203]
    ds_read_b64_tr_b16 v[36:37], v11 offset:24576
    ds_read_b64_tr_b16 v[38:39], v11 offset:26624
    v_mfma_f32_16x16x32_bf16 v[204:207], v[52:55], v[108:111], v[204:207]
    s_waitcnt lgkmcnt(7)
    v_mfma_f32_16x16x32_bf16 v[208:211], v[56:59], v[104:107], v[208:211]
    ds_read_b64_tr_b16 v[40:41], v12 offset:24576
    ds_read_b64_tr_b16 v[42:43], v12 offset:26624
    v_mfma_f32_16x16x32_bf16 v[212:215], v[56:59], v[108:111], v[212:215]
    s_waitcnt lgkmcnt(7)
    v_mfma_f32_16x16x32_bf16 v[216:219], v[60:63], v[104:107], v[216:219]
    ds_read_b64_tr_b16 v[44:45], v13 offset:24576
    ds_read_b64_tr_b16 v[46:47], v13 offset:26624
    v_mfma_f32_16x16x32_bf16 v[220:223], v[60:63], v[108:111], v[220:223]
    buffer_load_dwordx4 v[104:107], v8, s[8:11], s33 offen
    buffer_load_dwordx4 v[108:111], v9, s[8:11], s33 offen
    s_add_u32 s33, s33, 1024
    s_waitcnt lgkmcnt(8)
    v_readfirstlane_b32 s62, v22
    s_nop 3
    s_cmp_ge_u32 s62, s61
    s_cbranch_scc1 k2_kernel_sp1_ok
k2_kernel_sp1:
    ds_read_b32 v22, v20
    s_waitcnt lgkmcnt(0)
    v_readfirstlane_b32 s62, v22
    s_nop 3
    s_cmp_ge_u32 s62, s61
    s_cbranch_scc0 k2_kernel_sp1
k2_kernel_sp1_ok:
    s_waitcnt lgkmcnt(6)
    v_mfma_f32_16x16x32_bf16 v[192:195], v[32:35], v[112:115], v[192:195]
    ds_read_b64_tr_b16 v[48:49], v10 offset:28672
    ds_read_b64_tr_b16 v[50:51], v10 offset:30720
    v_mfma_f32_16x16x32_bf16 v[196:199], v[32:35], v[116:119], v[196:199]
    s_add_u32 m0, s38, s39
    s_nop 0
    buffer_load_dwordx4 v14, s[12:15], s34 offen lds
    s_waitcnt lgkmcnt(6)
    v_mfma_f32_16x16x32_bf16 v[200:203], v[36:39], v[112:115], v[200:203]
    ds_read_b64_tr_b16 v[52:53], v11 offset:28672
    ds_read_b64_tr_b16 v[54:55], v11 offset:30720
    v_mfma_f32_16x16x32_bf16 v[204:207], v[36:39], v[116:119], v[204:207]
    s_waitcnt lgkmcnt(6)
    v_mfma_f32_16x16x32_bf16 v[208:211], v[40:43], v[112:115], v[208:211]
    ds_read_b64_tr_b16 v[56:57], v12 offset:28672
    ds_read_b64_tr_b16 v[58:59], v12 offset:30720
    v_mfma_f32_16x16x32_bf16 v[212:215], v[40:43], v[116:119], v[212:215]
    s_add_u32 m0, s38, s39
    s_add_u32 m0, m0, 1024
    buffer_load_dwordx4 v15, s[12:15], s34 offen lds
    s_waitcnt lgkmcnt(6)
    v_mfma_f32_16x16x32_bf16 v[216:219], v[44:47], v[112:115], v[216:219]
    ds_read_b64_tr_b16 v[60:61], v13 offset:28672
    ds_read_b64_tr_b16 v[62:63], v13 offset:30720
    v_mfma_f32_16x16x32_bf16 v[220:223], v[44:47], v[116:119], v[220:223]
    buffer_load_dwordx4 v[112:115], v8, s[8:11], s33 offen
    buffer_load_dwordx4 v[116:119], v9, s[8:11], s33 offen
    s_add_u32 s33, s33, 1024
    s_waitcnt vmcnt(20)
    s_waitcnt lgkmcnt(6)
    v_mfma_f32_16x16x32_bf16 v[192:195], v[48:51], v[120:123], v[192:195]
    ds_read_b64_tr_b16 v[32:33], v10 offset:32768
    ds_read_b64_tr_b16 v[34:35], v10 offset:34816
    v_mfma_f32_16x16x32_bf16 v[196:199], v[48:51], v[124:127], v[196:199]
    s_add_u32 m0, s38, s39
    s_add_u32 m0, m0, 2048
    buffer_load_dwordx4 v16, s[12:15], s34 offen lds
    s_waitcnt lgkmcnt(6)
    v_mfma_f32_16x16x32_bf16 v[200:203], v[52:55], v[120:123], v[200:203]
    ds_read_b64_tr_b16 v[36:37], v11 offset:32768
    ds_read_b64_tr_b16 v[38:39], v11 offset:34816
    v_mfma_f32_16x16x32_bf16 v[204:207], v[52:55], v[124:127], v[204:207]
    s_waitcnt lgkmcnt(6)
    v_mfma_f32_16x16x32_bf16 v[208:211], v[56:59], v[120:123], v[208:211]
    ds_read_b64_tr_b16 v[40:41], v12 offset:32768
    ds_read_b64_tr_b16 v[42:43], v12 offset:34816
    v_mfma_f32_16x16x32_bf16 v[212:215], v[56:59], v[124:127], v[212:215]
    s_add_u32 m0, s38, s39
    s_add_u32 m0, m0, 3072
    buffer_load_dwordx4 v17, s[12:15], s34 offen lds
    s_add_u32 s34, s34, 262144
    s_add_u32 s38, s38, 16384
    s_and_b32 s38, s38, 65535
    s_waitcnt lgkmcnt(6)
    v_mfma_f32_16x16x32_bf16 v[216:219], v[60:63], v[120:123], v[216:219]
    ds_read_b64_tr_b16 v[44:45], v13 offset:32768
    ds_read_b64_tr_b16 v[46:47], v13 offset:34816
    v_mfma_f32_16x16x32_bf16 v[220:223], v[60:63], v[124:127], v[220:223]
    buffer_load_dwordx4 v[120:123], v8, s[8:11], s33 offen
    buffer_load_dwordx4 v[124:127], v9, s[8:11], s33 offen
    s_add_u32 s33, s33, 1024
    s_waitcnt vmcnt(14)
    s_mov_b64 exec, 1
    ds_add_u32 v20, v21
    s_mov_b64 exec, -1
    s_add_u32 s61, s61, 4
    s_waitcnt lgkmcnt(7)
    v_mfma_f32_16x16x32_bf16 v[192:195], v[32:35], v[64:67], v[192:195]
    ds_read_b64_tr_b16 v[48:49], v10 offset:36864
    ds_read_b64_tr_b16 v[50:51], v10 offset:38912
    v_mfma_f32_16x16x32_bf16 v[196:199], v[32:35], v[68:71], v[196:199]
    s_waitcnt lgkmcnt(7)
    v_mfma_f32_16x16x32_bf16 v[200:203], v[36:39], v[64:67], v[200:203]
    ds_read_b64_tr_b16 v[52:53], v11 offset:36864
    ds_read_b64_tr_b16 v[54:55], v11 offset:38912
    v_mfma_f32_16x16x32_bf16 v[204:207], v[36:39], v[68:71], v[204:207]
    s_waitcnt lgkmcnt(7)
    v_mfma_f32_16x16x32_bf16 v[208:211], v[40:43], v[64:67], v[208:211]
    ds_read_b64_tr_b16 v[56:57], v12 offset:36864
    ds_read_b64_tr_b16 v[58:59], v12 offset:38912
    v_mfma_f32_16x16x32_bf16 v[212:215], v[40:43], v[68:71], v[212:215]
    s_waitcnt lgkmcnt(7)
    v_mfma_f32_16x16x32_bf16 v[216:219], v[44:47], v[64:67], v[216:219]
    ds_read_b64_tr_b16 v[60:61], v13 offset:36864
    ds_read_b64_tr_b16 v[62:63], v13 offset:38912
    v_mfma_f32_16x16x32_bf16 v[220:223], v[44:47], v[68:71], v[220:223]
    buffer_load_dwordx4 v[64:67], v8, s[8:11], s33 offen
    buffer_load_dwordx4 v[68:71], v9, s[8:11], s33 offen
    s_add_u32 s33, s33, 1024
    ds_read_b32 v22, v20
    s_waitcnt lgkmcnt(7)
    v_mfma_f32_16x16x32_bf16 v[192:195], v[48:51], v[72:75], v[192:195]
    ds_read_b64_tr_b16 v[32:33], v10 offset:40960
    ds_read_b64_tr_b16 v[34:35], v10 offset:43008
    v_mfma_f32_16x16x32_bf16 v[196:199], v[48:51], v[76:79], v[196:199]
    s_waitcnt lgkmcnt(7)
    v_mfma_f32_16x16x32_bf16 v[200:203], v[52:55], v[72:75], v[200:203]
    ds_read_b64_tr_b16 v[36:37], v11 offset:40960
    ds_read_b64_tr_b16 v[38:39], v11 offset:43008
    v_mfma_f32_16x16x32_bf16 v[204:207], v[52:55], v[76:79], v[204:207]
    s_waitcnt lgkmcnt(7)
    v_mfma_f32_16x16x32_bf16 v[208:211], v[56:59], v[72:75], v[208:211]
    ds_read_b64_tr_b16 v[40:41], v12 offset:40960
    ds_read_b64_tr_b16 v[42:43], v12 offset:43008
    v_mfma_f32_16x16x32_bf16 v[212:215], v[56:59], v[76:79], v[212:215]
    s_waitcnt lgkmcnt(7)
    v_mfma_f32_16x16x32_bf16 v[216:219], v[60:63], v[72:75], v[216:219]
    ds_read_b64_tr_b16 v[44:45], v13 offset:40960
    ds_read_b64_tr_b16 v[46:47], v13 offset:43008
    v_mfma_f32_16x16x32_bf16 v[220:223], v[60:63], v[76:79], v[220:223]
    buffer_load_dwordx4 v[72:75], v8, s[8:11], s33 offen
    buffer_load_dwordx4 v[76:79], v9, s[8:11], s33 offen
    s_add_u32 s33, s33, 1024
    s_waitcnt lgkmcnt(8)
    v_readfirstlane_b32 s62, v22
    s_nop 3
    s_cmp_ge_u32 s62, s61
    s_cbranch_scc1 k2_kernel_sp2_ok
k2_kernel_sp2:
    ds_read_b32 v22, v20
    s_waitcnt lgkmcnt(0)
    v_readfirstlane_b32 s62, v22
    s_nop 3
    s_cmp_ge_u32 s62, s61
    s_cbranch_scc0 k2_kernel_sp2
k2_kernel_sp2_ok:
    s_waitcnt lgkmcnt(6)
    v_mfma_f32_16x16x32_bf16 v[192:195], v[32:35], v[80:83], v[192:195]
    ds_read_b64_tr_b16 v[48:49], v10 offset:45056
    ds_read_b64_tr_b16 v[50:51], v10 offset:47104
    v_mfma_f32_16x16x32_bf16 v[196:199], v[32:35], v[84:87], v[196:199]
    s_add_u32 m0, s38, s39
    s_nop 0
    buffer_load_dwordx4 v14, s[12:15], s34 offen lds
    s_waitcnt lgkmcnt(6)
    v_mfma_f32_16x16x32_bf16 v[200:203], v[36:39], v[80:83], v[200:203]
    ds_read_b64_tr_b16 v[52:53], v11 offset:45056
    ds_read_b64_tr_b16 v[54:55], v11 offset:47104
    v_mfma_f32_16x16x32_bf16 v[204:207], v[36:39], v[84:87], v[204:207]
    s_waitcnt lgkmcnt(6)
    v_mfma_f32_16x16x32_bf16 v[208:211], v[40:43], v[80:83], v[208:211]
    ds_read_b64_tr_b16 v[56:57], v12 offset:45056
    ds_read_b64_tr_b16 v[58:59], v12 offset:47104
    v_mfma_f32_16x16x32_bf16 v[212:215], v[40:43], v[84:87], v[212:215]
    s_add_u32 m0, s38, s39
    s_add_u32 m0, m0, 1024
    buffer_load_dwordx4 v15, s[12:15], s34 offen lds
    s_waitcnt lgkmcnt(6)
    v_mfma_f32_16x16x32_bf16 v[216:219], v[44:47], v[80:83], v[216:219]
    ds_read_b64_tr_b16 v[60:61], v13 offset:45056
    ds_read_b64_tr_b16 v[62:63], v13 offset:47104
    v_mfma_f32_16x16x32_bf16 v[220:223], v[44:47], v[84:87], v[220:223]
    buffer_load_dwordx4 v[80:83], v8, s[8:11], s33 offen
    buffer_load_dwordx4 v[84:87], v9, s[8:11], s33 offen
    s_add_u32 s33, s33, 1024
    s_waitcnt vmcnt(20)
    s_waitcnt lgkmcnt(6)
    v_mfma_f32_16x16x32_bf16 v[192:195], v[48:51], v[88:91], v[192:195]
    ds_read_b64_tr_b16 v[32:33], v10 offset:49152
    ds_read_b64_tr_b16 v[34:35], v10 offset:51200
    v_mfma_f32_16x16x32_bf16 v[196:199], v[48:51], v[92:95], v[196:199]
    s_add_u32 m0, s38, s39
    s_add_u32 m0, m0, 2048
    buffer_load_dwordx4 v16, s[12:15], s34 offen lds
    s_waitcnt lgkmcnt(6)
    v_mfma_f32_16x16x32_bf16 v[200:203], v[52:55], v[88:91], v[200:203]
    ds_read_b64_tr_b16 v[36:37], v11 offset:49152
    ds_read_b64_tr_b16 v[38:39], v11 offset:51200
    v_mfma_f32_16x16x32_bf16 v[204:207], v[52:55], v[92:95], v[204:207]
    s_waitcnt lgkmcnt(6)
    v_mfma_f32_16x16x32_bf16 v[208:211], v[56:59], v[88:91], v[208:211]
    ds_read_b64_tr_b16 v[40:41], v12 offset:49152
    ds_read_b64_tr_b16 v[42:43], v12 offset:51200
    v_mfma_f32_16x16x32_bf16 v[212:215], v[56:59], v[92:95], v[212:215]
    s_add_u32 m0, s38, s39
    s_add_u32 m0, m0, 3072
    buffer_load_dwordx4 v17, s[12:15], s34 offen lds
    s_add_u32 s34, s34, 262144
    s_add_u32 s38, s38, 16384
    s_and_b32 s38, s38, 65535
    s_waitcnt lgkmcnt(6)
    v_mfma_f32_16x16x32_bf16 v[216:219], v[60:63], v[88:91], v[216:219]
    ds_read_b64_tr_b16 v[44:45], v13 offset:49152
    ds_read_b64_tr_b16 v[46:47], v13 offset:51200
    v_mfma_f32_16x16x32_bf16 v[220:223], v[60:63], v[92:95], v[220:223]
    buffer_load_dwordx4 v[88:91], v8, s[8:11], s33 offen
    buffer_load_dwordx4 v[92:95], v9, s[8:11], s33 offen
    s_add_u32 s33, s33, 1024
    s_waitcnt vmcnt(14)
    s_mov_b64 exec, 1
    ds_add_u32 v20, v21
    s_mov_b64 exec, -1
    s_add_u32 s61, s61, 4
    s_waitcnt lgkmcnt(7)
    v_mfma_f32_16x16x32_bf16 v[192:195], v[32:35], v[96:99], v[192:195]
    ds_read_b64_tr_b16 v[48:49], v10 offset:53248
    ds_read_b64_tr_b16 v[50:51], v10 offset:55296
    v_mfma_f32_16x16x32_bf16 v[196:199], v[32:35], v[100:103], v[196:199]
    s_waitcnt lgkmcnt(7)
    v_mfma_f32_16x16x32_bf16 v[200:203], v[36:39], v[96:99], v[200:203]
    ds_read_b64_tr_b16 v[52:53], v11 offset:53248
    ds_read_b64_tr_b16 v[54:55], v11 offset:55296
    v_mfma_f32_16x16x32_bf16 v[204:207], v[36:39], v[100:103], v[204:207]
    s_waitcnt lgkmcnt(7)
    v_mfma_f32_16x16x32_bf16 v[208:211], v[40:43], v[96:99], v[208:211]
    ds_read_b64_tr_b16 v[56:57], v12 offset:53248
    ds_read_b64_tr_b16 v[58:59], v12 offset:55296
    v_mfma_f32_16x16x32_bf16 v[212:215], v[40:43], v[100:103], v[212:215]
    s_waitcnt lgkmcnt(7)
    v_mfma_f32_16x16x32_bf16 v[216:219], v[44:47], v[96:99], v[216:219]
    ds_read_b64_tr_b16 v[60:61], v13 offset:53248
    ds_read_b64_tr_b16 v[62:63], v13 offset:55296
    v_mfma_f32_16x16x32_bf16 v[220:223], v[44:47], v[100:103], v[220:223]
    buffer_load_dwordx4 v[96:99], v8, s[8:11], s33 offen
    buffer_load_dwordx4 v[100:103], v9, s[8:11], s33 offen
    s_add_u32 s33, s33, 1024
    ds_read_b32 v22, v20
    s_waitcnt lgkmcnt(7)
    v_mfma_f32_16x16x32_bf16 v[192:195], v[48:51], v[104:107], v[192:195]
    ds_read_b64_tr_b16 v[32:33], v10 offset:57344
    ds_read_b64_tr_b16 v[34:35], v10 offset:59392
    v_mfma_f32_16x16x32_bf16 v[196:199], v[48:51], v[108:111], v[196:199]
    s_waitcnt lgkmcnt(7)
    v_mfma_f32_16x16x32_bf16 v[200:203], v[52:55], v[104:107], v[200:203]
    ds_read_b64_tr_b16 v[36:37], v11 offset:57344
    ds_read_b64_tr_b16 v[38:39], v11 offset:59392
    v_mfma_f32_16x16x32_bf16 v[204:207], v[52:55], v[108:111], v[204:207]
    s_waitcnt lgkmcnt(7)
    v_mfma_f32_16x16x32_bf16 v[208:211], v[56:59], v[104:107], v[208:211]
    ds_read_b64_tr_b16 v[40:41], v12 offset:57344
    ds_read_b64_tr_b16 v[42:43], v12 offset:59392
    v_mfma_f32_16x16x32_bf16 v[212:215], v[56:59], v[108:111], v[212:215]
    s_waitcnt lgkmcnt(7)
    v_mfma_f32_16x16x32_bf16 v[216:219], v[60:63], v[104:107], v[216:219]
    ds_read_b64_tr_b16 v[44:45], v13 offset:57344
    ds_read_b64_tr_b16 v[46:47], v13 offset:59392
    v_mfma_f32_16x16x32_bf16 v[220:223], v[60:63], v[108:111], v[220:223]
    buffer_load_dwordx4 v[104:107], v8, s[8:11], s33 offen
    buffer_load_dwordx4 v[108:111], v9, s[8:11], s33 offen
    s_add_u32 s33, s33, 1024
    s_waitcnt lgkmcnt(8)
    v_readfirstlane_b32 s62, v22
    s_nop 3
    s_cmp_ge_u32 s62, s61
    s_cbranch_scc1 k2_kernel_sp3_ok
k2_kernel_sp3:
    ds_read_b32 v22, v20
    s_waitcnt lgkmcnt(0)
    v_readfirstlane_b32 s62, v22
    s_nop 3
    s_cmp_ge_u32 s62, s61
    s_cbranch_scc0 k2_kernel_sp3
k2_kernel_sp3_ok:
    s_waitcnt lgkmcnt(6)
    v_mfma_f32_16x16x32_bf16 v[192:195], v[32:35], v[112:115], v[192:195]
    ds_read_b64_tr_b16 v[48:49], v10 offset:61440
    ds_read_b64_tr_b16 v[50:51], v10 offset:63488
    v_mfma_f32_16x16x32_bf16 v[196:199], v[32:35], v[116:119], v[196:199]
    s_add_u32 m0, s38, s39
    s_nop 0
    buffer_load_dwordx4 v14, s[12:15], s34 offen lds
    s_waitcnt lgkmcnt(6)
    v_mfma_f32_16x16x32_bf16 v[200:203], v[36:39], v[112:115], v[200:203]
    ds_read_b64_tr_b16 v[52:53], v11 offset:61440
    ds_read_b64_tr_b16 v[54:55], v11 offset:63488
    v_mfma_f32_16x16x32_bf16 v[204:207], v[36:39], v[116:119], v[204:207]
    s_waitcnt lgkmcnt(6)
    v_mfma_f32_16x16x32_bf16 v[208:211], v[40:43], v[112:115], v[208:211]
    ds_read_b64_tr_b16 v[56:57], v12 offset:61440
    ds_read_b64_tr_b16 v[58:59], v12 offset:63488
    v_mfma_f32_16x16x32_bf16 v[212:215], v[40:43], v[116:119], v[212:215]
    s_add_u32 m0, s38, s39
    s_add_u32 m0, m0, 1024
    buffer_load_dwordx4 v15, s[12:15], s34 offen lds
    s_waitcnt lgkmcnt(6)
    v_mfma_f32_16x16x32_bf16 v[216:219], v[44:47], v[112:115], v[216:219]
    ds_read_b64_tr_b16 v[60:61], v13 offset:61440
    ds_read_b64_tr_b16 v[62:63], v13 offset:63488
    v_mfma_f32_16x16x32_bf16 v[220:223], v[44:47], v[116:119], v[220:223]
    buffer_load_dwordx4 v[112:115], v8, s[8:11], s33 offen
    buffer_load_dwordx4 v[116:119], v9, s[8:11], s33 offen
    s_add_u32 s33, s33, 1024
    s_waitcnt vmcnt(20)
    s_waitcnt lgkmcnt(6)
    v_mfma_f32_16x16x32_bf16 v[192:195], v[48:51], v[120:123], v[192:195]
    ds_read_b64_tr_b16 v[32:33], v10 offset:0
    ds_read_b64_tr_b16 v[34:35], v10 offset:2048
    v_mfma_f32_16x16x32_bf16 v[196:199], v[48:51], v[124:127], v[196:199]
    s_add_u32 m0, s38, s39
    s_add_u32 m0, m0, 2048
    buffer_load_dwordx4 v16, s[12:15], s34 offen lds
    s_waitcnt lgkmcnt(6)
    v_mfma_f32_16x16x32_bf16 v[200:203], v[52:55], v[120:123], v[200:203]
    ds_read_b64_tr_b16 v[36:37], v11 offset:0
    ds_read_b64_tr_b16 v[38:39], v11 offset:2048
    v_mfma_f32_16x16x32_bf16 v[204:207], v[52:55], v[124:127], v[204:207]
    s_waitcnt lgkmcnt(6)
    v_mfma_f32_16x16x32_bf16 v[208:211], v[56:59], v[120:123], v[208:211]
    ds_read_b64_tr_b16 v[40:41], v12 offset:0
    ds_read_b64_tr_b16 v[42:43], v12 offset:2048
    v_mfma_f32_16x16x32_bf16 v[212:215], v[56:59], v[124:127], v[212:215]
    s_add_u32 m0, s38, s39
    s_add_u32 m0, m0, 3072
    buffer_load_dwordx4 v17, s[12:15], s34 offen lds
    s_add_u32 s34, s34, 262144
    s_add_u32 s38, s38, 16384
    s_and_b32 s38, s38, 65535
    s_waitcnt lgkmcnt(6)
    v_mfma_f32_16x16x32_bf16 v[216:219], v[60:63], v[120:123], v[216:219]
    ds_read_b64_tr_b16 v[44:45], v13 offset:0
    ds_read_b64_tr_b16 v[46:47], v13 offset:2048
    v_mfma_f32_16x16x32_bf16 v[220:223], v[60:63], v[124:127], v[220:223]
    buffer_load_dwordx4 v[120:123], v8, s[8:11], s33 offen
    buffer_load_dwordx4 v[124:127], v9, s[8:11], s33 offen
    s_add_u32 s33, s33, 1024
    s_sub_u32 s35, s35, 1
    s_cmp_lg_u32 s35, 0
    s_cbranch_scc1 k2_kernel_loop
k2_kernel_ho:
    ds_read_b32 v22, v20 offset:8
    s_waitcnt lgkmcnt(0)
    v_readfirstlane_b32 s62, v22
    s_nop 3
    s_cmp_ge_u32 s62, 4
    s_cbranch_scc0 k2_kernel_ho
    s_waitcnt vmcnt(0)
    v_and_b32 v5, 15, v2
    v_lshlrev_b32 v5, 3, v5
    v_add_u32 v5, s56, v5
    ds_read_b64 v[24:25], v5 offset:8192
    ds_read_b64 v[26:27], v5 offset:8320
    ds_read_b128 v[64:67], v18 offset:4096
    ds_read_b64 v[72:73], v19 offset:12288
    ds_read_b64 v[74:75], v19 offset:12544
    ds_read_b128 v[76:79], v18 offset:4160
    ds_read_b64 v[84:85], v19 offset:14336
    ds_read_b64 v[86:87], v19 offset:14592
    ds_read_b128 v[88:91], v18 offset:6144
    ds_read_b64 v[96:97], v19 offset:12416
    ds_read_b64 v[98:99], v19 offset:12672
    ds_read_b128 v[100:103], v18 offset:6208
    ds_read_b64 v[108:109], v19 offset:14464
    ds_read_b64 v[110:111], v19 offset:14720
    s_waitcnt lgkmcnt(12)
    v_rcp_f32 v25, v25
    v_rcp_f32 v27, v27
    v_cvt_pk_bf16_f32 v128, v192, v193
    v_cvt_pk_bf16_f32 v129, v194, v195
    v_cvt_pk_bf16_f32 v130, v200, v201
    v_cvt_pk_bf16_f32 v131, v202, v203
    s_nop 1
    v_permlane16_swap_b32 v128, v130
    v_permlane16_swap_b32 v129, v131
    s_waitcnt lgkmcnt(9)
    v_lshlrev_b32 v161, 16, v72
    v_lshlrev_b32 v162, 16, v64
    v_lshlrev_b32 v163, 16, v128
    v_and_b32 v165, 0xffff0000, v72
    v_and_b32 v166, 0xffff0000, v64
    v_and_b32 v167, 0xffff0000, v128
    v_sub_f32 v160, v162, v24
    v_sub_f32 v164, v166, v24
    v_cvt_pk_bf16_f32 v160, v160, v164
    v_and_b32 v164, 0xffff0000, v160
    v_lshlrev_b32 v160, 16, v160
    v_mul_f32 v160, v160, v25
    v_mul_f32 v164, v164, v25
    v_cvt_pk_bf16_f32 v160, v160, v164
    v_and_b32 v164, 0xffff0000, v160
    v_lshlrev_b32 v160, 16, v160
    v_mul_f32 v160, v160, v161
    v_mul_f32 v164, v164, v165
    v_cvt_pk_bf16_f32 v160, v160, v164
    v_and_b32 v164, 0xffff0000, v160
    v_lshlrev_b32 v160, 16, v160
    v_add_f32 v160, v160, v162
    v_add_f32 v164, v164, v166
    v_cvt_pk_bf16_f32 v160, v160, v164
    v_and_b32 v164, 0xffff0000, v160
    v_lshlrev_b32 v160, 16, v160
    v_add_f32 v160, v160, v163
    v_add_f32 v164, v164, v167
    v_cvt_pk_bf16_f32 v132, v160, v164
    v_lshlrev_b32 v161, 16, v73
    v_lshlrev_b32 v162, 16, v65
    v_lshlrev_b32 v163, 16, v129
    v_and_b32 v165, 0xffff0000, v73
    v_and_b32 v166, 0xffff0000, v65
    v_and_b32 v167, 0xffff0000, v129
    v_sub_f32 v160, v162, v24
    v_sub_f32 v164, v166, v24
    v_cvt_pk_bf16_f32 v160, v160, v164
    v_and_b32 v164, 0xffff0000, v160
    v_lshlrev_b32 v160, 16, v160
    v_mul_f32 v160, v160, v25
    v_mul_f32 v164, v164, v25
    v_cvt_pk_bf16_f32 v160, v160, v164
    v_and_b32 v164, 0xffff0000, v160
    v_lshlrev_b32 v160, 16, v160
    v_mul_f32 v160, v160, v161
    v_mul_f32 v164, v164, v165
    v_cvt_pk_bf16_f32 v160, v160, v164
    v_and_b32 v164, 0xffff0000, v160
    v_lshlrev_b32 v160, 16, v160
    v_add_f32 v160, v160, v162
    v_add_f32 v164, v164, v166
    v_cvt_pk_bf16_f32 v160, v160, v164
    v_and_b32 v164, 0xffff0000, v160
    v_lshlrev_b32 v160, 16, v160
    v_add_f32 v160, v160, v163
    v_add_f32 v164, v164, v167
    v_cvt_pk_bf16_f32 v133, v160, v164
    v_lshlrev_b32 v161, 16, v74
    v_lshlrev_b32 v162, 16, v66
    v_lshlrev_b32 v163, 16, v130
    v_and_b32 v165, 0xffff0000, v74
    v_and_b32 v166, 0xffff0000, v66
    v_and_b32 v167, 0xffff0000, v130
    v_sub_f32 v160, v162, v24
    v_sub_f32 v164, v166, v24
    v_cvt_pk_bf16_f32 v160, v160, v164
    v_and_b32 v164, 0xffff0000, v160
    v_lshlrev_b32 v160, 16, v160
    v_mul_f32 v160, v160, v25
    v_mul_f32 v164, v164, v25
    v_cvt_pk_bf16_f32 v160, v160, v164
    v_and_b32 v164, 0xffff0000, v160
    v_lshlrev_b32 v160, 16, v160
    v_mul_f32 v160, v160, v161
    v_mul_f32 v164, v164, v165
    v_cvt_pk_bf16_f32 v160, v160, v164
    v_and_b32 v164, 0xffff0000, v160
    v_lshlrev_b32 v160, 16, v160
    v_add_f32 v160, v160, v162
    v_add_f32 v164, v164, v166
    v_cvt_pk_bf16_f32 v160, v160, v164
    v_and_b32 v164, 0xffff0000, v160
    v_lshlrev_b32 v160, 16, v160
    v_add_f32 v160, v160, v163
    v_add_f32 v164, v164, v167
    v_cvt_pk_bf16_f32 v134, v160, v164
    v_lshlrev_b32 v161, 16, v75
    v_lshlrev_b32 v162, 16, v67
    v_lshlrev_b32 v163, 16, v131
    v_and_b32 v165, 0xffff0000, v75
    v_and_b32 v166, 0xffff0000, v67
    v_and_b32 v167, 0xffff0000, v131
    v_sub_f32 v160, v162, v24
    v_sub_f32 v164, v166, v24
    v_cvt_pk_bf16_f32 v160, v160, v164
    v_and_b32 v164, 0xffff0000, v160
    v_lshlrev_b32 v160, 16, v160
    v_mul_f32 v160, v160, v25
    v_mul_f32 v164, v164, v25
    v_cvt_pk_bf16_f32 v160, v160, v164
    v_and_b32 v164, 0xffff0000, v160
    v_lshlrev_b32 v160, 16, v160
    v_mul_f32 v160, v160, v161
    v_mul_f32 v164, v164, v165
    v_cvt_pk_bf16_f32 v160, v160, v164
    v_and_b32 v164, 0xffff0000, v160
    v_lshlrev_b32 v160, 16, v160
    v_add_f32 v160, v160, v162
    v_add_f32 v164, v164, v166
    v_cvt_pk_bf16_f32 v160, v160, v164
    v_and_b32 v164, 0xffff0000, v160
    v_lshlrev_b32 v160, 16, v160
    v_add_f32 v160, v160, v163
    v_add_f32 v164, v164, v167
    v_cvt_pk_bf16_f32 v135, v160, v164
    v_add_u32 v3, 0, v6
    buffer_store_dwordx4 v[132:135], v3, s[16:19], 0 offen
    v_cvt_pk_bf16_f32 v144, v208, v209
    v_cvt_pk_bf16_f32 v145, v210, v211
    v_cvt_pk_bf16_f32 v146, v216, v217
    v_cvt_pk_bf16_f32 v147, v218, v219
    s_nop 1
    v_permlane16_swap_b32 v144, v146
    v_permlane16_swap_b32 v145, v147
    s_waitcnt lgkmcnt(6)
    v_lshlrev_b32 v161, 16, v84
    v_lshlrev_b32 v162, 16, v76
    v_lshlrev_b32 v163, 16, v144
    v_and_b32 v165, 0xffff0000, v84
    v_and_b32 v166, 0xffff0000, v76
    v_and_b32 v167, 0xffff0000, v144
    v_sub_f32 v160, v162, v24
    v_sub_f32 v164, v166, v24
    v_cvt_pk_bf16_f32 v160, v160, v164
    v_and_b32 v164, 0xffff0000, v160
    v_lshlrev_b32 v160, 16, v160
    v_mul_f32 v160, v160, v25
    v_mul_f32 v164, v164, v25
    v_cvt_pk_bf16_f32 v160, v160, v164
    v_and_b32 v164, 0xffff0000, v160
    v_lshlrev_b32 v160, 16, v160
    v_mul_f32 v160, v160, v161
    v_mul_f32 v164, v164, v165
    v_cvt_pk_bf16_f32 v160, v160, v164
    v_and_b32 v164, 0xffff0000, v160
    v_lshlrev_b32 v160, 16, v160
    v_add_f32 v160, v160, v162
    v_add_f32 v164, v164, v166
    v_cvt_pk_bf16_f32 v160, v160, v164
    v_and_b32 v164, 0xffff0000, v160
    v_lshlrev_b32 v160, 16, v160
    v_add_f32 v160, v160, v163
    v_add_f32 v164, v164, v167
    v_cvt_pk_bf16_f32 v148, v160, v164
    v_lshlrev_b32 v161, 16, v85
    v_lshlrev_b32 v162, 16, v77
    v_lshlrev_b32 v163, 16, v145
    v_and_b32 v165, 0xffff0000, v85
    v_and_b32 v166, 0xffff0000, v77
    v_and_b32 v167, 0xffff0000, v145
    v_sub_f32 v160, v162, v24
    v_sub_f32 v164, v166, v24
    v_cvt_pk_bf16_f32 v160, v160, v164
    v_and_b32 v164, 0xffff0000, v160
    v_lshlrev_b32 v160, 16, v160
    v_mul_f32 v160, v160, v25
    v_mul_f32 v164, v164, v25
    v_cvt_pk_bf16_f32 v160, v160, v164
    v_and_b32 v164, 0xffff0000, v160
    v_lshlrev_b32 v160, 16, v160
    v_mul_f32 v160, v160, v161
    v_mul_f32 v164, v164, v165
    v_cvt_pk_bf16_f32 v160, v160, v164
    v_and_b32 v164, 0xffff0000, v160
    v_lshlrev_b32 v160, 16, v160
    v_add_f32 v160, v160, v162
    v_add_f32 v164, v164, v166
    v_cvt_pk_bf16_f32 v160, v160, v164
    v_and_b32 v164, 0xffff0000, v160
    v_lshlrev_b32 v160, 16, v160
    v_add_f32 v160, v160, v163
    v_add_f32 v164, v164, v167
    v_cvt_pk_bf16_f32 v149, v160, v164
    v_lshlrev_b32 v161, 16, v86
    v_lshlrev_b32 v162, 16, v78
    v_lshlrev_b32 v163, 16, v146
    v_and_b32 v165, 0xffff0000, v86
    v_and_b32 v166, 0xffff0000, v78
    v_and_b32 v167, 0xffff0000, v146
    v_sub_f32 v160, v162, v24
    v_sub_f32 v164, v166, v24
    v_cvt_pk_bf16_f32 v160, v160, v164
    v_and_b32 v164, 0xffff0000, v160
    v_lshlrev_b32 v160, 16, v160
    v_mul_f32 v160, v160, v25
    v_mul_f32 v164, v164, v25
    v_cvt_pk_bf16_f32 v160, v160, v164
    v_and_b32 v164, 0xffff0000, v160
    v_lshlrev_b32 v160, 16, v160
    v_mul_f32 v160, v160, v161
    v_mul_f32 v164, v164, v165
    v_cvt_pk_bf16_f32 v160, v160, v164
    v_and_b32 v164, 0xffff0000, v160
    v_lshlrev_b32 v160, 16, v160
    v_add_f32 v160, v160, v162
    v_add_f32 v164, v164, v166
    v_cvt_pk_bf16_f32 v160, v160, v164
    v_and_b32 v164, 0xffff0000, v160
    v_lshlrev_b32 v160, 16, v160
    v_add_f32 v160, v160, v163
    v_add_f32 v164, v164, v167
    v_cvt_pk_bf16_f32 v150, v160, v164
    v_lshlrev_b32 v161, 16, v87
    v_lshlrev_b32 v162, 16, v79
    v_lshlrev_b32 v163, 16, v147
    v_and_b32 v165, 0xffff0000, v87
    v_and_b32 v166, 0xffff0000, v79
    v_and_b32 v167, 0xffff0000, v147
    v_sub_f32 v160, v162, v24
    v_sub_f32 v164, v166, v24
    v_cvt_pk_bf16_f32 v160, v160, v164
    v_and_b32 v164, 0xffff0000, v160
    v_lshlrev_b32 v160, 16, v160
    v_mul_f32 v160, v160, v25
    v_mul_f32 v164, v164, v25
    v_cvt_pk_bf16_f32 v160, v160, v164
    v_and_b32 v164, 0xffff0000, v160
    v_lshlrev_b32 v160, 16, v160
    v_mul_f32 v160, v160, v161
    v_mul_f32 v164, v164, v165
    v_cvt_pk_bf16_f32 v160, v160, v164
    v_and_b32 v164, 0xffff0000, v160
    v_lshlrev_b32 v160, 16, v160
    v_add_f32 v160, v160, v162
    v_add_f32 v164, v164, v166
    v_cvt_pk_bf16_f32 v160, v160, v164
    v_and_b32 v164, 0xffff0000, v160
    v_lshlrev_b32 v160, 16, v160
    v_add_f32 v160, v160, v163
    v_add_f32 v164, v164, v167
    v_cvt_pk_bf16_f32 v151, v160, v164
    v_add_u32 v3, 64, v6
    buffer_store_dwordx4 v[148:151], v3, s[16:19], 0 offen
    v_cvt_pk_bf16_f32 v128, v196, v197
    v_cvt_pk_bf16_f32 v129, v198, v199
    v_cvt_pk_bf16_f32 v130, v204, v205
    v_cvt_pk_bf16_f32 v131, v206, v207
    s_nop 1
    v_permlane16_swap_b32 v128, v130
    v_permlane16_swap_b32 v129, v131
    s_waitcnt lgkmcnt(3)
    v_lshlrev_b32 v161, 16, v96
    v_lshlrev_b32 v162, 16, v88
    v_lshlrev_b32 v163, 16, v128
    v_and_b32 v165, 0xffff0000, v96
    v_and_b32 v166, 0xffff0000, v88
    v_and_b32 v167, 0xffff0000, v128
    v_sub_f32 v160, v162, v26
    v_sub_f32 v164, v166, v26
    v_cvt_pk_bf16_f32 v160, v160, v164
    v_and_b32 v164, 0xffff0000, v160
    v_lshlrev_b32 v160, 16, v160
    v_mul_f32 v160, v160, v27
    v_mul_f32 v164, v164, v27
    v_cvt_pk_bf16_f32 v160, v160, v164
    v_and_b32 v164, 0xffff0000, v160
    v_lshlrev_b32 v160, 16, v160
    v_mul_f32 v160, v160, v161
    v_mul_f32 v164, v164, v165
    v_cvt_pk_bf16_f32 v160, v160, v164
    v_and_b32 v164, 0xffff0000, v160
    v_lshlrev_b32 v160, 16, v160
    v_add_f32 v160, v160, v162
    v_add_f32 v164, v164, v166
    v_cvt_pk_bf16_f32 v160, v160, v164
    v_and_b32 v164, 0xffff0000, v160
    v_lshlrev_b32 v160, 16, v160
    v_add_f32 v160, v160, v163
    v_add_f32 v164, v164, v167
    v_cvt_pk_bf16_f32 v132, v160, v164
    v_lshlrev_b32 v161, 16, v97
    v_lshlrev_b32 v162, 16, v89
    v_lshlrev_b32 v163, 16, v129
    v_and_b32 v165, 0xffff0000, v97
    v_and_b32 v166, 0xffff0000, v89
    v_and_b32 v167, 0xffff0000, v129
    v_sub_f32 v160, v162, v26
    v_sub_f32 v164, v166, v26
    v_cvt_pk_bf16_f32 v160, v160, v164
    v_and_b32 v164, 0xffff0000, v160
    v_lshlrev_b32 v160, 16, v160
    v_mul_f32 v160, v160, v27
    v_mul_f32 v164, v164, v27
    v_cvt_pk_bf16_f32 v160, v160, v164
    v_and_b32 v164, 0xffff0000, v160
    v_lshlrev_b32 v160, 16, v160
    v_mul_f32 v160, v160, v161
    v_mul_f32 v164, v164, v165
    v_cvt_pk_bf16_f32 v160, v160, v164
    v_and_b32 v164, 0xffff0000, v160
    v_lshlrev_b32 v160, 16, v160
    v_add_f32 v160, v160, v162
    v_add_f32 v164, v164, v166
    v_cvt_pk_bf16_f32 v160, v160, v164
    v_and_b32 v164, 0xffff0000, v160
    v_lshlrev_b32 v160, 16, v160
    v_add_f32 v160, v160, v163
    v_add_f32 v164, v164, v167
    v_cvt_pk_bf16_f32 v133, v160, v164
    v_lshlrev_b32 v161, 16, v98
    v_lshlrev_b32 v162, 16, v90
    v_lshlrev_b32 v163, 16, v130
    v_and_b32 v165, 0xffff0000, v98
    v_and_b32 v166, 0xffff0000, v90
    v_and_b32 v167, 0xffff0000, v130
    v_sub_f32 v160, v162, v26
    v_sub_f32 v164, v166, v26
    v_cvt_pk_bf16_f32 v160, v160, v164
    v_and_b32 v164, 0xffff0000, v160
    v_lshlrev_b32 v160, 16, v160
    v_mul_f32 v160, v160, v27
    v_mul_f32 v164, v164, v27
    v_cvt_pk_bf16_f32 v160, v160, v164
    v_and_b32 v164, 0xffff0000, v160
    v_lshlrev_b32 v160, 16, v160
    v_mul_f32 v160, v160, v161
    v_mul_f32 v164, v164, v165
    v_cvt_pk_bf16_f32 v160, v160, v164
    v_and_b32 v164, 0xffff0000, v160
    v_lshlrev_b32 v160, 16, v160
    v_add_f32 v160, v160, v162
    v_add_f32 v164, v164, v166
    v_cvt_pk_bf16_f32 v160, v160, v164
    v_and_b32 v164, 0xffff0000, v160
    v_lshlrev_b32 v160, 16, v160
    v_add_f32 v160, v160, v163
    v_add_f32 v164, v164, v167
    v_cvt_pk_bf16_f32 v134, v160, v164
    v_lshlrev_b32 v161, 16, v99
    v_lshlrev_b32 v162, 16, v91
    v_lshlrev_b32 v163, 16, v131
    v_and_b32 v165, 0xffff0000, v99
    v_and_b32 v166, 0xffff0000, v91
    v_and_b32 v167, 0xffff0000, v131
    v_sub_f32 v160, v162, v26
    v_sub_f32 v164, v166, v26
    v_cvt_pk_bf16_f32 v160, v160, v164
    v_and_b32 v164, 0xffff0000, v160
    v_lshlrev_b32 v160, 16, v160
    v_mul_f32 v160, v160, v27
    v_mul_f32 v164, v164, v27
    v_cvt_pk_bf16_f32 v160, v160, v164
    v_and_b32 v164, 0xffff0000, v160
    v_lshlrev_b32 v160, 16, v160
    v_mul_f32 v160, v160, v161
    v_mul_f32 v164, v164, v165
    v_cvt_pk_bf16_f32 v160, v160, v164
    v_and_b32 v164, 0xffff0000, v160
    v_lshlrev_b32 v160, 16, v160
    v_add_f32 v160, v160, v162
    v_add_f32 v164, v164, v166
    v_cvt_pk_bf16_f32 v160, v160, v164
    v_and_b32 v164, 0xffff0000, v160
    v_lshlrev_b32 v160, 16, v160
    v_add_f32 v160, v160, v163
    v_add_f32 v164, v164, v167
    v_cvt_pk_bf16_f32 v135, v160, v164
    v_add_u32 v3, 32768, v6
    buffer_store_dwordx4 v[132:135], v3, s[16:19], 0 offen
    v_cvt_pk_bf16_f32 v144, v212, v213
    v_cvt_pk_bf16_f32 v145, v214, v215
    v_cvt_pk_bf16_f32 v146, v220, v221
    v_cvt_pk_bf16_f32 v147, v222, v223
    s_nop 1
    v_permlane16_swap_b32 v144, v146
    v_permlane16_swap_b32 v145, v147
    s_waitcnt lgkmcnt(0)
    v_lshlrev_b32 v161, 16, v108
    v_lshlrev_b32 v162, 16, v100
    v_lshlrev_b32 v163, 16, v144
    v_and_b32 v165, 0xffff0000, v108
    v_and_b32 v166, 0xffff0000, v100
    v_and_b32 v167, 0xffff0000, v144
    v_sub_f32 v160, v162, v26
    v_sub_f32 v164, v166, v26
    v_cvt_pk_bf16_f32 v160, v160, v164
    v_and_b32 v164, 0xffff0000, v160
    v_lshlrev_b32 v160, 16, v160
    v_mul_f32 v160, v160, v27
    v_mul_f32 v164, v164, v27
    v_cvt_pk_bf16_f32 v160, v160, v164
    v_and_b32 v164, 0xffff0000, v160
    v_lshlrev_b32 v160, 16, v160
    v_mul_f32 v160, v160, v161
    v_mul_f32 v164, v164, v165
    v_cvt_pk_bf16_f32 v160, v160, v164
    v_and_b32 v164, 0xffff0000, v160
    v_lshlrev_b32 v160, 16, v160
    v_add_f32 v160, v160, v162
    v_add_f32 v164, v164, v166
    v_cvt_pk_bf16_f32 v160, v160, v164
    v_and_b32 v164, 0xffff0000, v160
    v_lshlrev_b32 v160, 16, v160
    v_add_f32 v160, v160, v163
    v_add_f32 v164, v164, v167
    v_cvt_pk_bf16_f32 v148, v160, v164
    v_lshlrev_b32 v161, 16, v109
    v_lshlrev_b32 v162, 16, v101
    v_lshlrev_b32 v163, 16, v145
    v_and_b32 v165, 0xffff0000, v109
    v_and_b32 v166, 0xffff0000, v101
    v_and_b32 v167, 0xffff0000, v145
    v_sub_f32 v160, v162, v26
    v_sub_f32 v164, v166, v26
    v_cvt_pk_bf16_f32 v160, v160, v164
    v_and_b32 v164, 0xffff0000, v160
    v_lshlrev_b32 v160, 16, v160
    v_mul_f32 v160, v160, v27
    v_mul_f32 v164, v164, v27
    v_cvt_pk_bf16_f32 v160, v160, v164
    v_and_b32 v164, 0xffff0000, v160
    v_lshlrev_b32 v160, 16, v160
    v_mul_f32 v160, v160, v161
    v_mul_f32 v164, v164, v165
    v_cvt_pk_bf16_f32 v160, v160, v164
    v_and_b32 v164, 0xffff0000, v160
    v_lshlrev_b32 v160, 16, v160
    v_add_f32 v160, v160, v162
    v_add_f32 v164, v164, v166
    v_cvt_pk_bf16_f32 v160, v160, v164
    v_and_b32 v164, 0xffff0000, v160
    v_lshlrev_b32 v160, 16, v160
    v_add_f32 v160, v160, v163
    v_add_f32 v164, v164, v167
    v_cvt_pk_bf16_f32 v149, v160, v164
    v_lshlrev_b32 v161, 16, v110
    v_lshlrev_b32 v162, 16, v102
    v_lshlrev_b32 v163, 16, v146
    v_and_b32 v165, 0xffff0000, v110
    v_and_b32 v166, 0xffff0000, v102
    v_and_b32 v167, 0xffff0000, v146
    v_sub_f32 v160, v162, v26
    v_sub_f32 v164, v166, v26
    v_cvt_pk_bf16_f32 v160, v160, v164
    v_and_b32 v164, 0xffff0000, v160
    v_lshlrev_b32 v160, 16, v160
    v_mul_f32 v160, v160, v27
    v_mul_f32 v164, v164, v27
    v_cvt_pk_bf16_f32 v160, v160, v164
    v_and_b32 v164, 0xffff0000, v160
    v_lshlrev_b32 v160, 16, v160
    v_mul_f32 v160, v160, v161
    v_mul_f32 v164, v164, v165
    v_cvt_pk_bf16_f32 v160, v160, v164
    v_and_b32 v164, 0xffff0000, v160
    v_lshlrev_b32 v160, 16, v160
    v_add_f32 v160, v160, v162
    v_add_f32 v164, v164, v166
    v_cvt_pk_bf16_f32 v160, v160, v164
    v_and_b32 v164, 0xffff0000, v160
    v_lshlrev_b32 v160, 16, v160
    v_add_f32 v160, v160, v163
    v_add_f32 v164, v164, v167
    v_cvt_pk_bf16_f32 v150, v160, v164
    v_lshlrev_b32 v161, 16, v111
    v_lshlrev_b32 v162, 16, v103
    v_lshlrev_b32 v163, 16, v147
    v_and_b32 v165, 0xffff0000, v111
    v_and_b32 v166, 0xffff0000, v103
    v_and_b32 v167, 0xffff0000, v147
    v_sub_f32 v160, v162, v26
    v_sub_f32 v164, v166, v26
    v_cvt_pk_bf16_f32 v160, v160, v164
    v_and_b32 v164, 0xffff0000, v160
    v_lshlrev_b32 v160, 16, v160
    v_mul_f32 v160, v160, v27
    v_mul_f32 v164, v164, v27
    v_cvt_pk_bf16_f32 v160, v160, v164
    v_and_b32 v164, 0xffff0000, v160
    v_lshlrev_b32 v160, 16, v160
    v_mul_f32 v160, v160, v161
    v_mul_f32 v164, v164, v165
    v_cvt_pk_bf16_f32 v160, v160, v164
    v_and_b32 v164, 0xffff0000, v160
    v_lshlrev_b32 v160, 16, v160
    v_add_f32 v160, v160, v162
    v_add_f32 v164, v164, v166
    v_cvt_pk_bf16_f32 v160, v160, v164
    v_and_b32 v164, 0xffff0000, v160
    v_lshlrev_b32 v160, 16, v160
    v_add_f32 v160, v160, v163
    v_add_f32 v164, v164, v167
    v_cvt_pk_bf16_f32 v151, v160, v164
    v_add_u32 v3, 32832, v6
    buffer_store_dwordx4 v[148:151], v3, s[16:19], 0 offen
    s_endpgm
k2_kernel_help:
    s_sub_u32 s33, s32, 4
    s_lshl_b32 s34, s2, 2
    s_add_u32 s56, s34, s33
    s_lshl_b32 s57, s56, 12
    s_mul_i32 s59, s33, 21248
    s_add_u32 s59, s59, 65536
    v_lshlrev_b32 v3, 4, v2
    s_waitcnt lgkmcnt(0)
    s_add_u32 s8, s44, s57
    s_addc_u32 s9, s45, 0
    s_mov_b32 s10, 4096
    s_mov_b32 s11, 0x00020000
    s_add_u32 s58, s57, 4194304
    s_add_u32 s12, s4, s58
    s_addc_u32 s13, s5, 0
    s_mov_b32 s14, 4096
    s_mov_b32 s15, 0x00020000
    s_add_u32 m0, s59, 16640
    s_mov_b32 s60, 0
    buffer_load_dwordx4 v3, s[12:15], s60 offen lds
    s_add_u32 m0, s59, 17664
    s_mov_b32 s60, 1024
    buffer_load_dwordx4 v3, s[12:15], s60 offen lds
    s_add_u32 m0, s59, 18688
    s_mov_b32 s60, 2048
    buffer_load_dwordx4 v3, s[12:15], s60 offen lds
    s_add_u32 m0, s59, 19712
    s_mov_b32 s60, 3072
    buffer_load_dwordx4 v3, s[12:15], s60 offen lds
    v_add_u32 v4, 0xffffffe0, v3
    v_add_u32 v5, 0xfffffff0, v3
    buffer_load_dwordx4 v[32:35], v4, s[8:11], 0 offen
    buffer_load_dwordx4 v[36:39], v5, s[8:11], 0 offen
    v_add_u32 v4, 0x3e0, v3
    v_add_u32 v5, 0x3f0, v3
    buffer_load_dwordx4 v[40:43], v4, s[8:11], 0 offen
    buffer_load_dwordx4 v[44:47], v5, s[8:11], 0 offen
    v_add_u32 v4, 0x7e0, v3
    v_add_u32 v5, 0x7f0, v3
    buffer_load_dwordx4 v[48:51], v4, s[8:11], 0 offen
    buffer_load_dwordx4 v[52:55], v5, s[8:11], 0 offen
    v_add_u32 v4, 0xbe0, v3
    v_add_u32 v5, 0xbf0, v3
    buffer_load_dwordx4 v[56:59], v4, s[8:11], 0 offen
    buffer_load_dwordx4 v[60:63], v5, s[8:11], 0 offen
    v_add_u32 v4, 0xfe0, v3
    v_add_u32 v5, 0xff0, v3
    buffer_load_dwordx4 v[64:67], v4, s[8:11], 0 offen
    buffer_load_dwordx4 v[68:71], v5, s[8:11], 0 offen
    s_add_u32 s16, s4, 25165824
    s_addc_u32 s17, s5, 0
    s_mov_b32 s18, 4194304
    s_mov_b32 s19, 0x00020000
    s_mov_b32 s20, s46
    s_mov_b32 s21, s47
    s_mov_b32 s22, 2048
    s_mov_b32 s23, 0x00020000
    s_lshl_b32 s57, s56, 1
    v_mov_b32 v4, s57
    buffer_load_ushort v6, v4, s[20:23], 0 offen
    v_mov_b32 v8, 0
    v_mov_b32 v9, 0
    v_mov_b32 v10, 0
    v_mov_b32 v11, 0
    v_add_u32 v4, s59, v3
    v_cmp_gt_u32 vcc, 32, v2
    s_and_saveexec_b64 s[62:63], vcc
    ds_write_b128 v4, v[8:11] offset:20736
    s_mov_b64 exec, s[62:63]
    v_and_b32 v14, 15, v2
    v_add_u32 v14, 1, v14
    v_and_b32 v5, 3, v14
    v_mul_u32_u24 v5, 4160, v5
    v_lshrrev_b32 v14, 2, v14
    v_lshl_add_u32 v5, v14, 3, v5
    v_lshrrev_b32 v7, 4, v2
    v_lshl_add_u32 v5, v7, 4, v5
    v_add_u32 v12, s59, v5
    v_and_b32 v14, 15, v2
    v_lshlrev_b32 v14, 5, v14
    v_sub_u32 v14, 17120, v14
    v_lshl_add_u32 v14, v7, 4, v14
    v_add_u32 v13, s59, v14
    v_mov_b32 v192, 0
    v_mov_b32 v193, 0
    v_mov_b32 v194, 0
    v_mov_b32 v195, 0
    v_mov_b32 v196, 0
    v_mov_b32 v197, 0
    v_mov_b32 v198, 0
    v_mov_b32 v199, 0
    v_mov_b32 v200, 0
    v_mov_b32 v201, 0
    v_mov_b32 v202, 0
    v_mov_b32 v203, 0
    v_mov_b32 v204, 0
    v_mov_b32 v205, 0
    v_mov_b32 v206, 0
    v_mov_b32 v207, 0
    v_mov_b32 v208, 0
    v_mov_b32 v209, 0
    v_mov_b32 v210, 0
    v_mov_b32 v211, 0
    v_mov_b32 v212, 0
    v_mov_b32 v213, 0
    v_mov_b32 v214, 0
    v_mov_b32 v215, 0
    v_mov_b32 v216, 0
    v_mov_b32 v217, 0
    v_mov_b32 v218, 0
    v_mov_b32 v219, 0
    v_mov_b32 v220, 0
    v_mov_b32 v221, 0
    v_mov_b32 v222, 0
    v_mov_b32 v223, 0
    s_waitcnt vmcnt(9)
    v_alignbit_b32 v72, v33, v32, 16
    v_alignbit_b32 v73, v34, v33, 16
    v_alignbit_b32 v74, v35, v34, 16
    v_alignbit_b32 v75, v36, v35, 16
    v_alignbit_b32 v76, v37, v36, 16
    v_mov_b32 v80, v33
    v_mov_b32 v84, v73
    v_mov_b32 v81, v34
    v_mov_b32 v85, v74
    v_mov_b32 v82, v35
    v_mov_b32 v86, v75
    v_mov_b32 v83, v36
    v_mov_b32 v87, v76
    ds_write_b128 v4, v[32:35] offset:0
    ds_write_b128 v4, v[72:75] offset:4160
    ds_write_b128 v4, v[80:83] offset:8320
    ds_write_b128 v4, v[84:87] offset:12480
    s_waitcnt vmcnt(7)
    v_alignbit_b32 v88, v41, v40, 16
    v_alignbit_b32 v89, v42, v41, 16
    v_alignbit_b32 v90, v43, v42, 16
    v_alignbit_b32 v91, v44, v43, 16
    v_alignbit_b32 v92, v45, v44, 16
    v_mov_b32 v96, v41
    v_mov_b32 v100, v89
    v_mov_b32 v97, v42
    v_mov_b32 v101, v90
    v_mov_b32 v98, v43
    v_mov_b32 v102, v91
    v_mov_b32 v99, v44
    v_mov_b32 v103, v92
    ds_write_b128 v4, v[40:43] offset:1024
    ds_write_b128 v4, v[88:91] offset:5184
    ds_write_b128 v4, v[96:99] offset:9344
    ds_write_b128 v4, v[100:103] offset:13504
    s_waitcnt vmcnt(5)
    v_alignbit_b32 v72, v49, v48, 16
    v_alignbit_b32 v73, v50, v49, 16
    v_alignbit_b32 v74, v51, v50, 16
    v_alignbit_b32 v75, v52, v51, 16
    v_alignbit_b32 v76, v53, v52, 16
    v_mov_b32 v80, v49
    v_mov_b32 v84, v73
    v_mov_b32 v81, v50
    v_mov_b32 v85, v74
    v_mov_b32 v82, v51
    v_mov_b32 v86, v75
    v_mov_b32 v83, v52
    v_mov_b32 v87, v76
    ds_write_b128 v4, v[48:51] offset:2048
    ds_write_b128 v4, v[72:75] offset:6208
    ds_write_b128 v4, v[80:83] offset:10368
    ds_write_b128 v4, v[84:87] offset:14528
    s_waitcnt vmcnt(3)
    v_alignbit_b32 v88, v57, v56, 16
    v_alignbit_b32 v89, v58, v57, 16
    v_alignbit_b32 v90, v59, v58, 16
    v_alignbit_b32 v91, v60, v59, 16
    v_alignbit_b32 v92, v61, v60, 16
    v_mov_b32 v96, v57
    v_mov_b32 v100, v89
    v_mov_b32 v97, v58
    v_mov_b32 v101, v90
    v_mov_b32 v98, v59
    v_mov_b32 v102, v91
    v_mov_b32 v99, v60
    v_mov_b32 v103, v92
    ds_write_b128 v4, v[56:59] offset:3072
    ds_write_b128 v4, v[88:91] offset:7232
    ds_write_b128 v4, v[96:99] offset:11392
    ds_write_b128 v4, v[100:103] offset:15552
    s_waitcnt vmcnt(1)
    v_alignbit_b32 v72, v65, v64, 16
    v_alignbit_b32 v73, v66, v65, 16
    v_alignbit_b32 v74, v67, v66, 16
    v_alignbit_b32 v75, v68, v67, 16
    v_alignbit_b32 v76, v69, v68, 16
    v_cmp_gt_u32 vcc, 4, v2
    s_and_saveexec_b64 s[62:63], vcc
    v_mov_b32 v80, v65
    v_mov_b32 v84, v73
    v_mov_b32 v81, v66
    v_mov_b32 v85, v74
    v_mov_b32 v82, v67
    v_mov_b32 v86, v75
    v_mov_b32 v83, v68
    v_mov_b32 v87, v76
    ds_write_b128 v4, v[64:67] offset:4096
    ds_write_b128 v4, v[72:75] offset:8256
    ds_write_b128 v4, v[80:83] offset:12416
    ds_write_b128 v4, v[84:87] offset:16576
    s_mov_b64 exec, s[62:63]
    s_waitcnt vmcnt(0)
    s_waitcnt lgkmcnt(0)
    ds_read_b128 v[32:35], v13 offset:4032
    ds_read_b64 v[92:93], v12 offset:448
    ds_read_b64 v[94:95], v12 offset:456
    ds_read_b64 v[124:125], v12 offset:960
    ds_read_b64 v[126:127], v12 offset:968
    ds_read_b64 v[156:157], v12 offset:1472
    ds_read_b64 v[158:159], v12 offset:1480
    ds_read_b64 v[188:189], v12 offset:1984
    ds_read_b64 v[190:191], v12 offset:1992
    ds_read_b128 v[36:39], v13 offset:3968
    ds_read_b64 v[88:89], v12 offset:384
    ds_read_b64 v[90:91], v12 offset:392
    ds_read_b64 v[120:121], v12 offset:896
    ds_read_b64 v[122:123], v12 offset:904
    ds_read_b64 v[152:153], v12 offset:1408
    ds_read_b64 v[154:155], v12 offset:1416
    ds_read_b64 v[184:185], v12 offset:1920
    ds_read_b64 v[186:187], v12 offset:1928
    ds_read_b128 v[40:43], v13 offset:3904
    ds_read_b64 v[84:85], v12 offset:320
    ds_read_b64 v[86:87], v12 offset:328
    ds_read_b64 v[116:117], v12 offset:832
    ds_read_b64 v[118:119], v12 offset:840
    ds_read_b64 v[148:149], v12 offset:1344
    ds_read_b64 v[150:151], v12 offset:1352
    ds_read_b64 v[180:181], v12 offset:1856
    ds_read_b64 v[182:183], v12 offset:1864
    ds_read_b128 v[44:47], v13 offset:3840
    ds_read_b64 v[80:81], v12 offset:256
    ds_read_b64 v[82:83], v12 offset:264
    ds_read_b64 v[112:113], v12 offset:768
    ds_read_b64 v[114:115], v12 offset:776
    ds_read_b64 v[144:145], v12 offset:1280
    ds_read_b64 v[146:147], v12 offset:1288
    ds_read_b64 v[176:177], v12 offset:1792
    ds_read_b64 v[178:179], v12 offset:1800
    s_waitcnt lgkmcnt(14)
    v_mfma_f32_16x16x32_bf16 v[192:195], v[92:95], v[32:35], v[192:195]
    ds_read_b128 v[48:51], v13 offset:3776
    ds_read_b64 v[76:77], v12 offset:192
    ds_read_b64 v[78:79], v12 offset:200
    ds_read_b64 v[108:109], v12 offset:704
    ds_read_b64 v[110:111], v12 offset:712
    ds_read_b64 v[140:141], v12 offset:1216
    ds_read_b64 v[142:143], v12 offset:1224
    ds_read_b64 v[172:173], v12 offset:1728
    ds_read_b64 v[174:175], v12 offset:1736
    v_mfma_f32_16x16x32_bf16 v[196:199], v[124:127], v[32:35], v[196:199]
    v_mfma_f32_16x16x32_bf16 v[200:203], v[156:159], v[32:35], v[200:203]
    v_mfma_f32_16x16x32_bf16 v[204:207], v[188:191], v[32:35], v[204:207]
    v_mfma_f32_16x16x32_bf16 v[192:195], v[88:91], v[36:39], v[192:195]
    ds_read_b128 v[52:55], v13 offset:3712
    ds_read_b64 v[72:73], v12 offset:128
    ds_read_b64 v[74:75], v12 offset:136
    ds_read_b64 v[104:105], v12 offset:640
    ds_read_b64 v[106:107], v12 offset:648
    ds_read_b64 v[136:137], v12 offset:1152
    ds_read_b64 v[138:139], v12 offset:1160
    ds_read_b64 v[168:169], v12 offset:1664
    ds_read_b64 v[170:171], v12 offset:1672
    v_mfma_f32_16x16x32_bf16 v[196:199], v[120:123], v[36:39], v[196:199]
    v_mfma_f32_16x16x32_bf16 v[200:203], v[152:155], v[36:39], v[200:203]
    v_mfma_f32_16x16x32_bf16 v[204:207], v[184:187], v[36:39], v[204:207]
    v_mfma_f32_16x16x32_bf16 v[192:195], v[84:87], v[40:43], v[192:195]
    ds_read_b128 v[56:59], v13 offset:3648
    ds_read_b64 v[68:69], v12 offset:64
    ds_read_b64 v[70:71], v12 offset:72
    ds_read_b64 v[100:101], v12 offset:576
    ds_read_b64 v[102:103], v12 offset:584
    ds_read_b64 v[132:133], v12 offset:1088
    ds_read_b64 v[134:135], v12 offset:1096
    ds_read_b64 v[164:165], v12 offset:1600
    ds_read_b64 v[166:167], v12 offset:1608
    s_waitcnt lgkmcnt(14)
    v_mfma_f32_16x16x32_bf16 v[196:199], v[116:119], v[40:43], v[196:199]
    v_mfma_f32_16x16x32_bf16 v[200:203], v[148:151], v[40:43], v[200:203]
    v_mfma_f32_16x16x32_bf16 v[204:207], v[180:183], v[40:43], v[204:207]
    v_mfma_f32_16x16x32_bf16 v[192:195], v[80:83], v[44:47], v[192:195]
    ds_read_b128 v[60:63], v13 offset:3584
    ds_read_b64 v[64:65], v12 offset:0
    ds_read_b64 v[66:67], v12 offset:8
    ds_read_b64 v[96:97], v12 offset:512
    ds_read_b64 v[98:99], v12 offset:520
    ds_read_b64 v[128:129], v12 offset:1024
    ds_read_b64 v[130:131], v12 offset:1032
    ds_read_b64 v[160:161], v12 offset:1536
    ds_read_b64 v[162:163], v12 offset:1544
    v_mfma_f32_16x16x32_bf16 v[196:199], v[112:115], v[44:47], v[196:199]
    v_mfma_f32_16x16x32_bf16 v[200:203], v[144:147], v[44:47], v[200:203]
    v_mfma_f32_16x16x32_bf16 v[204:207], v[176:179], v[44:47], v[204:207]
    v_mfma_f32_16x16x32_bf16 v[192:195], v[76:79], v[48:51], v[192:195]
    ds_read_b128 v[32:35], v13 offset:3520
    v_mfma_f32_16x16x32_bf16 v[196:199], v[108:111], v[48:51], v[196:199]
    v_mfma_f32_16x16x32_bf16 v[200:203], v[140:143], v[48:51], v[200:203]
    v_mfma_f32_16x16x32_bf16 v[204:207], v[172:175], v[48:51], v[204:207]
    v_mfma_f32_16x16x32_bf16 v[192:195], v[72:75], v[52:55], v[192:195]
    ds_read_b128 v[36:39], v13 offset:3456
    s_waitcnt lgkmcnt(14)
    v_mfma_f32_16x16x32_bf16 v[196:199], v[104:107], v[52:55], v[196:199]
    v_mfma_f32_16x16x32_bf16 v[200:203], v[136:139], v[52:55], v[200:203]
    v_mfma_f32_16x16x32_bf16 v[204:207], v[168:171], v[52:55], v[204:207]
    v_mfma_f32_16x16x32_bf16 v[192:195], v[68:71], v[56:59], v[192:195]
    ds_read_b128 v[40:43], v13 offset:3392
    v_mfma_f32_16x16x32_bf16 v[196:199], v[100:103], v[56:59], v[196:199]
    s_waitcnt lgkmcnt(14)
    v_mfma_f32_16x16x32_bf16 v[200:203], v[132:135], v[56:59], v[200:203]
    s_waitcnt lgkmcnt(12)
    v_mfma_f32_16x16x32_bf16 v[204:207], v[164:167], v[56:59], v[204:207]
    s_waitcnt lgkmcnt(9)
    v_mfma_f32_16x16x32_bf16 v[192:195], v[64:67], v[60:63], v[192:195]
    ds_read_b128 v[44:47], v13 offset:3328
    s_waitcnt lgkmcnt(8)
    v_mfma_f32_16x16x32_bf16 v[196:199], v[96:99], v[60:63], v[196:199]
    s_waitcnt lgkmcnt(6)
    v_mfma_f32_16x16x32_bf16 v[200:203], v[128:131], v[60:63], v[200:203]
    s_waitcnt lgkmcnt(4)
    v_mfma_f32_16x16x32_bf16 v[204:207], v[160:163], v[60:63], v[204:207]
    s_waitcnt lgkmcnt(3)
    v_mfma_f32_16x16x32_bf16 v[196:199], v[92:95], v[32:35], v[196:199]
    ds_read_b128 v[48:51], v13 offset:3264
    v_mfma_f32_16x16x32_bf16 v[200:203], v[124:127], v[32:35], v[200:203]
    v_mfma_f32_16x16x32_bf16 v[204:207], v[156:159], v[32:35], v[204:207]
    v_mfma_f32_16x16x32_bf16 v[208:211], v[188:191], v[32:35], v[208:211]
    s_waitcnt lgkmcnt(3)
    v_mfma_f32_16x16x32_bf16 v[196:199], v[88:91], v[36:39], v[196:199]
    ds_read_b128 v[52:55], v13 offset:3200
    v_mfma_f32_16x16x32_bf16 v[200:203], v[120:123], v[36:39], v[200:203]
    v_mfma_f32_16x16x32_bf16 v[204:207], v[152:155], v[36:39], v[204:207]
    v_mfma_f32_16x16x32_bf16 v[208:211], v[184:187], v[36:39], v[208:211]
    s_waitcnt lgkmcnt(3)
    v_mfma_f32_16x16x32_bf16 v[196:199], v[84:87], v[40:43], v[196:199]
    ds_read_b128 v[56:59], v13 offset:3136
    v_mfma_f32_16x16x32_bf16 v[200:203], v[116:119], v[40:43], v[200:203]
    v_mfma_f32_16x16x32_bf16 v[204:207], v[148:151], v[40:43], v[204:207]
    v_mfma_f32_16x16x32_bf16 v[208:211], v[180:183], v[40:43], v[208:211]
    s_waitcnt lgkmcnt(3)
    v_mfma_f32_16x16x32_bf16 v[196:199], v[80:83], v[44:47], v[196:199]
    ds_read_b128 v[60:63], v13 offset:3072
    v_mfma_f32_16x16x32_bf16 v[200:203], v[112:115], v[44:47], v[200:203]
    v_mfma_f32_16x16x32_bf16 v[204:207], v[144:147], v[44:47], v[204:207]
    v_mfma_f32_16x16x32_bf16 v[208:211], v[176:179], v[44:47], v[208:211]
    s_waitcnt lgkmcnt(3)
    v_mfma_f32_16x16x32_bf16 v[196:199], v[76:79], v[48:51], v[196:199]
    ds_read_b128 v[32:35], v13 offset:3008
    v_mfma_f32_16x16x32_bf16 v[200:203], v[108:111], v[48:51], v[200:203]
    v_mfma_f32_16x16x32_bf16 v[204:207], v[140:143], v[48:51], v[204:207]
    v_mfma_f32_16x16x32_bf16 v[208:211], v[172:175], v[48:51], v[208:211]
    s_waitcnt lgkmcnt(3)
    v_mfma_f32_16x16x32_bf16 v[196:199], v[72:75], v[52:55], v[196:199]
    ds_read_b128 v[36:39], v13 offset:2944
    v_mfma_f32_16x16x32_bf16 v[200:203], v[104:107], v[52:55], v[200:203]
    v_mfma_f32_16x16x32_bf16 v[204:207], v[136:139], v[52:55], v[204:207]
    v_mfma_f32_16x16x32_bf16 v[208:211], v[168:171], v[52:55], v[208:211]
    s_waitcnt lgkmcnt(3)
    v_mfma_f32_16x16x32_bf16 v[196:199], v[68:71], v[56:59], v[196:199]
    ds_read_b128 v[40:43], v13 offset:2880
    v_mfma_f32_16x16x32_bf16 v[200:203], v[100:103], v[56:59], v[200:203]
    v_mfma_f32_16x16x32_bf16 v[204:207], v[132:135], v[56:59], v[204:207]
    v_mfma_f32_16x16x32_bf16 v[208:211], v[164:167], v[56:59], v[208:211]
    s_waitcnt lgkmcnt(3)
    v_mfma_f32_16x16x32_bf16 v[196:199], v[64:67], v[60:63], v[196:199]
    ds_read_b128 v[44:47], v13 offset:2816
    v_mfma_f32_16x16x32_bf16 v[200:203], v[96:99], v[60:63], v[200:203]
    v_mfma_f32_16x16x32_bf16 v[204:207], v[128:131], v[60:63], v[204:207]
    v_mfma_f32_16x16x32_bf16 v[208:211], v[160:163], v[60:63], v[208:211]
    s_waitcnt lgkmcnt(3)
    v_mfma_f32_16x16x32_bf16 v[200:203], v[92:95], v[32:35], v[200:203]
    ds_read_b128 v[48:51], v13 offset:2752
    v_mfma_f32_16x16x32_bf16 v[204:207], v[124:127], v[32:35], v[204:207]
    v_mfma_f32_16x16x32_bf16 v[208:211], v[156:159], v[32:35], v[208:211]
    v_mfma_f32_16x16x32_bf16 v[212:215], v[188:191], v[32:35], v[212:215]
    s_waitcnt lgkmcnt(3)
    v_mfma_f32_16x16x32_bf16 v[200:203], v[88:91], v[36:39], v[200:203]
    ds_read_b128 v[52:55], v13 offset:2688
    v_mfma_f32_16x16x32_bf16 v[204:207], v[120:123], v[36:39], v[204:207]
    v_mfma_f32_16x16x32_bf16 v[208:211], v[152:155], v[36:39], v[208:211]
    v_mfma_f32_16x16x32_bf16 v[212:215], v[184:187], v[36:39], v[212:215]
    s_waitcnt lgkmcnt(3)
    v_mfma_f32_16x16x32_bf16 v[200:203], v[84:87], v[40:43], v[200:203]
    ds_read_b128 v[56:59], v13 offset:2624
    v_mfma_f32_16x16x32_bf16 v[204:207], v[116:119], v[40:43], v[204:207]
    v_mfma_f32_16x16x32_bf16 v[208:211], v[148:151], v[40:43], v[208:211]
    v_mfma_f32_16x16x32_bf16 v[212:215], v[180:183], v[40:43], v[212:215]
    s_waitcnt lgkmcnt(3)
    v_mfma_f32_16x16x32_bf16 v[200:203], v[80:83], v[44:47], v[200:203]
    ds_read_b128 v[60:63], v13 offset:2560
    v_mfma_f32_16x16x32_bf16 v[204:207], v[112:115], v[44:47], v[204:207]
    v_mfma_f32_16x16x32_bf16 v[208:211], v[144:147], v[44:47], v[208:211]
    v_mfma_f32_16x16x32_bf16 v[212:215], v[176:179], v[44:47], v[212:215]
    s_waitcnt lgkmcnt(3)
    v_mfma_f32_16x16x32_bf16 v[200:203], v[76:79], v[48:51], v[200:203]
    ds_read_b128 v[32:35], v13 offset:2496
    v_mfma_f32_16x16x32_bf16 v[204:207], v[108:111], v[48:51], v[204:207]
    v_mfma_f32_16x16x32_bf16 v[208:211], v[140:143], v[48:51], v[208:211]
    v_mfma_f32_16x16x32_bf16 v[212:215], v[172:175], v[48:51], v[212:215]
    s_waitcnt lgkmcnt(3)
    v_mfma_f32_16x16x32_bf16 v[200:203], v[72:75], v[52:55], v[200:203]
    ds_read_b128 v[36:39], v13 offset:2432
    v_mfma_f32_16x16x32_bf16 v[204:207], v[104:107], v[52:55], v[204:207]
    v_mfma_f32_16x16x32_bf16 v[208:211], v[136:139], v[52:55], v[208:211]
    v_mfma_f32_16x16x32_bf16 v[212:215], v[168:171], v[52:55], v[212:215]
    s_waitcnt lgkmcnt(3)
    v_mfma_f32_16x16x32_bf16 v[200:203], v[68:71], v[56:59], v[200:203]
    ds_read_b128 v[40:43], v13 offset:2368
    v_mfma_f32_16x16x32_bf16 v[204:207], v[100:103], v[56:59], v[204:207]
    v_mfma_f32_16x16x32_bf16 v[208:211], v[132:135], v[56:59], v[208:211]
    v_mfma_f32_16x16x32_bf16 v[212:215], v[164:167], v[56:59], v[212:215]
    s_waitcnt lgkmcnt(3)
    v_mfma_f32_16x16x32_bf16 v[200:203], v[64:67], v[60:63], v[200:203]
    ds_read_b128 v[44:47], v13 offset:2304
    v_mfma_f32_16x16x32_bf16 v[204:207], v[96:99], v[60:63], v[204:207]
    v_mfma_f32_16x16x32_bf16 v[208:211], v[128:131], v[60:63], v[208:211]
    v_mfma_f32_16x16x32_bf16 v[212:215], v[160:163], v[60:63], v[212:215]
    s_waitcnt lgkmcnt(3)
    v_mfma_f32_16x16x32_bf16 v[204:207], v[92:95], v[32:35], v[204:207]
    ds_read_b128 v[48:51], v13 offset:2240
    v_mfma_f32_16x16x32_bf16 v[208:211], v[124:127], v[32:35], v[208:211]
    v_mfma_f32_16x16x32_bf16 v[212:215], v[156:159], v[32:35], v[212:215]
    v_mfma_f32_16x16x32_bf16 v[216:219], v[188:191], v[32:35], v[216:219]
    s_waitcnt lgkmcnt(3)
    v_mfma_f32_16x16x32_bf16 v[204:207], v[88:91], v[36:39], v[204:207]
    ds_read_b128 v[52:55], v13 offset:2176
    v_mfma_f32_16x16x32_bf16 v[208:211], v[120:123], v[36:39], v[208:211]
    v_mfma_f32_16x16x32_bf16 v[212:215], v[152:155], v[36:39], v[212:215]
    v_mfma_f32_16x16x32_bf16 v[216:219], v[184:187], v[36:39], v[216:219]
    s_waitcnt lgkmcnt(3)
    v_mfma_f32_16x16x32_bf16 v[204:207], v[84:87], v[40:43], v[204:207]
    ds_read_b128 v[56:59], v13 offset:2112
    v_mfma_f32_16x16x32_bf16 v[208:211], v[116:119], v[40:43], v[208:211]
    v_mfma_f32_16x16x32_bf16 v[212:215], v[148:151], v[40:43], v[212:215]
    v_mfma_f32_16x16x32_bf16 v[216:219], v[180:183], v[40:43], v[216:219]
    s_waitcnt lgkmcnt(3)
    v_mfma_f32_16x16x32_bf16 v[204:207], v[80:83], v[44:47], v[204:207]
    ds_read_b128 v[60:63], v13 offset:2048
    v_mfma_f32_16x16x32_bf16 v[208:211], v[112:115], v[44:47], v[208:211]
    v_mfma_f32_16x16x32_bf16 v[212:215], v[144:147], v[44:47], v[212:215]
    v_mfma_f32_16x16x32_bf16 v[216:219], v[176:179], v[44:47], v[216:219]
    s_waitcnt lgkmcnt(3)
    v_mfma_f32_16x16x32_bf16 v[204:207], v[76:79], v[48:51], v[204:207]
    ds_read_b128 v[32:35], v13 offset:1984
    v_mfma_f32_16x16x32_bf16 v[208:211], v[108:111], v[48:51], v[208:211]
    v_mfma_f32_16x16x32_bf16 v[212:215], v[140:143], v[48:51], v[212:215]
    v_mfma_f32_16x16x32_bf16 v[216:219], v[172:175], v[48:51], v[216:219]
    s_waitcnt lgkmcnt(3)
    v_mfma_f32_16x16x32_bf16 v[204:207], v[72:75], v[52:55], v[204:207]
    ds_read_b128 v[36:39], v13 offset:1920
    v_mfma_f32_16x16x32_bf16 v[208:211], v[104:107], v[52:55], v[208:211]
    v_mfma_f32_16x16x32_bf16 v[212:215], v[136:139], v[52:55], v[212:215]
    v_mfma_f32_16x16x32_bf16 v[216:219], v[168:171], v[52:55], v[216:219]
    s_waitcnt lgkmcnt(3)
    v_mfma_f32_16x16x32_bf16 v[204:207], v[68:71], v[56:59], v[204:207]
    ds_read_b128 v[40:43], v13 offset:1856
    v_mfma_f32_16x16x32_bf16 v[208:211], v[100:103], v[56:59], v[208:211]
    v_mfma_f32_16x16x32_bf16 v[212:215], v[132:135], v[56:59], v[212:215]
    v_mfma_f32_16x16x32_bf16 v[216:219], v[164:167], v[56:59], v[216:219]
    s_waitcnt lgkmcnt(3)
    v_mfma_f32_16x16x32_bf16 v[204:207], v[64:67], v[60:63], v[204:207]
    ds_read_b128 v[44:47], v13 offset:1792
    v_mfma_f32_16x16x32_bf16 v[208:211], v[96:99], v[60:63], v[208:211]
    v_mfma_f32_16x16x32_bf16 v[212:215], v[128:131], v[60:63], v[212:215]
    v_mfma_f32_16x16x32_bf16 v[216:219], v[160:163], v[60:63], v[216:219]
    s_waitcnt lgkmcnt(3)
    v_mfma_f32_16x16x32_bf16 v[208:211], v[92:95], v[32:35], v[208:211]
    ds_read_b128 v[48:51], v13 offset:1728
    v_mfma_f32_16x16x32_bf16 v[212:215], v[124:127], v[32:35], v[212:215]
    v_mfma_f32_16x16x32_bf16 v[216:219], v[156:159], v[32:35], v[216:219]
    v_mfma_f32_16x16x32_bf16 v[220:223], v[188:191], v[32:35], v[220:223]
    s_waitcnt lgkmcnt(3)
    v_mfma_f32_16x16x32_bf16 v[208:211], v[88:91], v[36:39], v[208:211]
    ds_read_b128 v[52:55], v13 offset:1664
    v_mfma_f32_16x16x32_bf16 v[212:215], v[120:123], v[36:39], v[212:215]
    v_mfma_f32_16x16x32_bf16 v[216:219], v[152:155], v[36:39], v[216:219]
    v_mfma_f32_16x16x32_bf16 v[220:223], v[184:187], v[36:39], v[220:223]
    s_waitcnt lgkmcnt(3)
    v_mfma_f32_16x16x32_bf16 v[208:211], v[84:87], v[40:43], v[208:211]
    ds_read_b128 v[56:59], v13 offset:1600
    v_mfma_f32_16x16x32_bf16 v[212:215], v[116:119], v[40:43], v[212:215]
    v_mfma_f32_16x16x32_bf16 v[216:219], v[148:151], v[40:43], v[216:219]
    v_mfma_f32_16x16x32_bf16 v[220:223], v[180:183], v[40:43], v[220:223]
    s_waitcnt lgkmcnt(3)
    v_mfma_f32_16x16x32_bf16 v[208:211], v[80:83], v[44:47], v[208:211]
    ds_read_b128 v[60:63], v13 offset:1536
    v_mfma_f32_16x16x32_bf16 v[212:215], v[112:115], v[44:47], v[212:215]
    v_mfma_f32_16x16x32_bf16 v[216:219], v[144:147], v[44:47], v[216:219]
    v_mfma_f32_16x16x32_bf16 v[220:223], v[176:179], v[44:47], v[220:223]
    s_waitcnt lgkmcnt(3)
    v_mfma_f32_16x16x32_bf16 v[208:211], v[76:79], v[48:51], v[208:211]
    ds_read_b128 v[32:35], v13 offset:1472
    v_mfma_f32_16x16x32_bf16 v[212:215], v[108:111], v[48:51], v[212:215]
    v_mfma_f32_16x16x32_bf16 v[216:219], v[140:143], v[48:51], v[216:219]
    v_mfma_f32_16x16x32_bf16 v[220:223], v[172:175], v[48:51], v[220:223]
    s_waitcnt lgkmcnt(3)
    v_mfma_f32_16x16x32_bf16 v[208:211], v[72:75], v[52:55], v[208:211]
    ds_read_b128 v[36:39], v13 offset:1408
    v_mfma_f32_16x16x32_bf16 v[212:215], v[104:107], v[52:55], v[212:215]
    v_mfma_f32_16x16x32_bf16 v[216:219], v[136:139], v[52:55], v[216:219]
    v_mfma_f32_16x16x32_bf16 v[220:223], v[168:171], v[52:55], v[220:223]
    s_waitcnt lgkmcnt(3)
    v_mfma_f32_16x16x32_bf16 v[208:211], v[68:71], v[56:59], v[208:211]
    ds_read_b128 v[40:43], v13 offset:1344
    v_mfma_f32_16x16x32_bf16 v[212:215], v[100:103], v[56:59], v[212:215]
    v_mfma_f32_16x16x32_bf16 v[216:219], v[132:135], v[56:59], v[216:219]
    v_mfma_f32_16x16x32_bf16 v[220:223], v[164:167], v[56:59], v[220:223]
    s_waitcnt lgkmcnt(3)
    v_mfma_f32_16x16x32_bf16 v[208:211], v[64:67], v[60:63], v[208:211]
    ds_read_b128 v[44:47], v13 offset:1280
    v_mfma_f32_16x16x32_bf16 v[212:215], v[96:99], v[60:63], v[212:215]
    v_mfma_f32_16x16x32_bf16 v[216:219], v[128:131], v[60:63], v[216:219]
    v_mfma_f32_16x16x32_bf16 v[220:223], v[160:163], v[60:63], v[220:223]
    s_waitcnt lgkmcnt(3)
    v_mfma_f32_16x16x32_bf16 v[212:215], v[92:95], v[32:35], v[212:215]
    ds_read_b128 v[48:51], v13 offset:1216
    v_mfma_f32_16x16x32_bf16 v[216:219], v[124:127], v[32:35], v[216:219]
    v_mfma_f32_16x16x32_bf16 v[220:223], v[156:159], v[32:35], v[220:223]
    s_waitcnt lgkmcnt(3)
    v_mfma_f32_16x16x32_bf16 v[212:215], v[88:91], v[36:39], v[212:215]
    ds_read_b128 v[52:55], v13 offset:1152
    v_mfma_f32_16x16x32_bf16 v[216:219], v[120:123], v[36:39], v[216:219]
    v_mfma_f32_16x16x32_bf16 v[220:223], v[152:155], v[36:39], v[220:223]
    s_waitcnt lgkmcnt(3)
    v_mfma_f32_16x16x32_bf16 v[212:215], v[84:87], v[40:43], v[212:215]
    ds_read_b128 v[56:59], v13 offset:1088
    v_mfma_f32_16x16x32_bf16 v[216:219], v[116:119], v[40:43], v[216:219]
    v_mfma_f32_16x16x32_bf16 v[220:223], v[148:151], v[40:43], v[220:223]
    s_waitcnt lgkmcnt(3)
    v_mfma_f32_16x16x32_bf16 v[212:215], v[80:83], v[44:47], v[212:215]
    ds_read_b128 v[60:63], v13 offset:1024
    v_mfma_f32_16x16x32_bf16 v[216:219], v[112:115], v[44:47], v[216:219]
    v_mfma_f32_16x16x32_bf16 v[220:223], v[144:147], v[44:47], v[220:223]
    s_waitcnt lgkmcnt(3)
    v_mfma_f32_16x16x32_bf16 v[212:215], v[76:79], v[48:51], v[212:215]
    ds_read_b128 v[32:35], v13 offset:960
    v_mfma_f32_16x16x32_bf16 v[216:219], v[108:111], v[48:51], v[216:219]
    v_mfma_f32_16x16x32_bf16 v[220:223], v[140:143], v[48:51], v[220:223]
    s_waitcnt lgkmcnt(3)
    v_mfma_f32_16x16x32_bf16 v[212:215], v[72:75], v[52:55], v[212:215]
    ds_read_b128 v[36:39], v13 offset:896
    v_mfma_f32_16x16x32_bf16 v[216:219], v[104:107], v[52:55], v[216:219]
    v_mfma_f32_16x16x32_bf16 v[220:223], v[136:139], v[52:55], v[220:223]
    s_waitcnt lgkmcnt(3)
    v_mfma_f32_16x16x32_bf16 v[212:215], v[68:71], v[56:59], v[212:215]
    ds_read_b128 v[40:43], v13 offset:832
    v_mfma_f32_16x16x32_bf16 v[216:219], v[100:103], v[56:59], v[216:219]
    v_mfma_f32_16x16x32_bf16 v[220:223], v[132:135], v[56:59], v[220:223]
    s_waitcnt lgkmcnt(3)
    v_mfma_f32_16x16x32_bf16 v[212:215], v[64:67], v[60:63], v[212:215]
    ds_read_b128 v[44:47], v13 offset:768
    v_mfma_f32_16x16x32_bf16 v[216:219], v[96:99], v[60:63], v[216:219]
    v_mfma_f32_16x16x32_bf16 v[220:223], v[128:131], v[60:63], v[220:223]
    s_waitcnt lgkmcnt(3)
    v_mfma_f32_16x16x32_bf16 v[216:219], v[92:95], v[32:35], v[216:219]
    ds_read_b128 v[48:51], v13 offset:704
    v_mfma_f32_16x16x32_bf16 v[220:223], v[124:127], v[32:35], v[220:223]
    s_waitcnt lgkmcnt(3)
    v_mfma_f32_16x16x32_bf16 v[216:219], v[88:91], v[36:39], v[216:219]
    ds_read_b128 v[52:55], v13 offset:640
    v_mfma_f32_16x16x32_bf16 v[220:223], v[120:123], v[36:39], v[220:223]
    s_waitcnt lgkmcnt(3)
    v_mfma_f32_16x16x32_bf16 v[216:219], v[84:87], v[40:43], v[216:219]
    ds_read_b128 v[56:59], v13 offset:576
    v_mfma_f32_16x16x32_bf16 v[220:223], v[116:119], v[40:43], v[220:223]
    s_waitcnt lgkmcnt(3)
    v_mfma_f32_16x16x32_bf16 v[216:219], v[80:83], v[44:47], v[216:219]
    ds_read_b128 v[60:63], v13 offset:512
    v_mfma_f32_16x16x32_bf16 v[220:223], v[112:115], v[44:47], v[220:223]
    s_waitcnt lgkmcnt(3)
    v_mfma_f32_16x16x32_bf16 v[216:219], v[76:79], v[48:51], v[216:219]
    ds_read_b128 v[32:35], v13 offset:448
    v_mfma_f32_16x16x32_bf16 v[220:223], v[108:111], v[48:51], v[220:223]
    s_waitcnt lgkmcnt(3)
    v_mfma_f32_16x16x32_bf16 v[216:219], v[72:75], v[52:55], v[216:219]
    ds_read_b128 v[36:39], v13 offset:384
    v_mfma_f32_16x16x32_bf16 v[220:223], v[104:107], v[52:55], v[220:223]
    s_waitcnt lgkmcnt(3)
    v_mfma_f32_16x16x32_bf16 v[216:219], v[68:71], v[56:59], v[216:219]
    ds_read_b128 v[40:43], v13 offset:320
    v_mfma_f32_16x16x32_bf16 v[220:223], v[100:103], v[56:59], v[220:223]
    s_waitcnt lgkmcnt(3)
    v_mfma_f32_16x16x32_bf16 v[216:219], v[64:67], v[60:63], v[216:219]
    ds_read_b128 v[44:47], v13 offset:256
    v_mfma_f32_16x16x32_bf16 v[220:223], v[96:99], v[60:63], v[220:223]
    s_waitcnt lgkmcnt(3)
    v_mfma_f32_16x16x32_bf16 v[220:223], v[92:95], v[32:35], v[220:223]
    ds_read_b128 v[48:51], v13 offset:192
    s_waitcnt lgkmcnt(3)
    v_mfma_f32_16x16x32_bf16 v[220:223], v[88:91], v[36:39], v[220:223]
    ds_read_b128 v[52:55], v13 offset:128
    s_waitcnt lgkmcnt(3)
    v_mfma_f32_16x16x32_bf16 v[220:223], v[84:87], v[40:43], v[220:223]
    ds_read_b128 v[56:59], v13 offset:64
    s_waitcnt lgkmcnt(3)
    v_mfma_f32_16x16x32_bf16 v[220:223], v[80:83], v[44:47], v[220:223]
    ds_read_b128 v[60:63], v13 offset:0
    s_waitcnt lgkmcnt(3)
    v_mfma_f32_16x16x32_bf16 v[220:223], v[76:79], v[48:51], v[220:223]
    s_waitcnt lgkmcnt(2)
    v_mfma_f32_16x16x32_bf16 v[220:223], v[72:75], v[52:55], v[220:223]
    s_waitcnt lgkmcnt(1)
    v_mfma_f32_16x16x32_bf16 v[220:223], v[68:71], v[56:59], v[220:223]
    s_waitcnt lgkmcnt(0)
    v_mfma_f32_16x16x32_bf16 v[220:223], v[64:67], v[60:63], v[220:223]
    ds_read_b128 v[32:35], v13 offset:4032
    ds_read_b64 v[92:93], v12 offset:2496
    ds_read_b64 v[94:95], v12 offset:2504
    ds_read_b64 v[124:125], v12 offset:3008
    ds_read_b64 v[126:127], v12 offset:3016
    ds_read_b64 v[156:157], v12 offset:3520
    ds_read_b64 v[158:159], v12 offset:3528
    ds_read_b64 v[188:189], v12 offset:4032
    ds_read_b64 v[190:191], v12 offset:4040
    ds_read_b128 v[36:39], v13 offset:3968
    ds_read_b64 v[88:89], v12 offset:2432
    ds_read_b64 v[90:91], v12 offset:2440
    ds_read_b64 v[120:121], v12 offset:2944
    ds_read_b64 v[122:123], v12 offset:2952
    ds_read_b64 v[152:153], v12 offset:3456
    ds_read_b64 v[154:155], v12 offset:3464
    ds_read_b64 v[184:185], v12 offset:3968
    ds_read_b64 v[186:187], v12 offset:3976
    ds_read_b128 v[40:43], v13 offset:3904
    ds_read_b64 v[84:85], v12 offset:2368
    ds_read_b64 v[86:87], v12 offset:2376
    ds_read_b64 v[116:117], v12 offset:2880
    ds_read_b64 v[118:119], v12 offset:2888
    ds_read_b64 v[148:149], v12 offset:3392
    ds_read_b64 v[150:151], v12 offset:3400
    ds_read_b64 v[180:181], v12 offset:3904
    ds_read_b64 v[182:183], v12 offset:3912
    ds_read_b128 v[44:47], v13 offset:3840
    ds_read_b64 v[80:81], v12 offset:2304
    ds_read_b64 v[82:83], v12 offset:2312
    ds_read_b64 v[112:113], v12 offset:2816
    ds_read_b64 v[114:115], v12 offset:2824
    ds_read_b64 v[144:145], v12 offset:3328
    ds_read_b64 v[146:147], v12 offset:3336
    ds_read_b64 v[176:177], v12 offset:3840
    ds_read_b64 v[178:179], v12 offset:3848
    s_waitcnt lgkmcnt(14)
    v_mfma_f32_16x16x32_bf16 v[208:211], v[92:95], v[32:35], v[208:211]
    ds_read_b128 v[48:51], v13 offset:3776
    ds_read_b64 v[76:77], v12 offset:2240
    ds_read_b64 v[78:79], v12 offset:2248
    ds_read_b64 v[108:109], v12 offset:2752
    ds_read_b64 v[110:111], v12 offset:2760
    ds_read_b64 v[140:141], v12 offset:3264
    ds_read_b64 v[142:143], v12 offset:3272
    ds_read_b64 v[172:173], v12 offset:3776
    ds_read_b64 v[174:175], v12 offset:3784
    v_mfma_f32_16x16x32_bf16 v[212:215], v[124:127], v[32:35], v[212:215]
    v_mfma_f32_16x16x32_bf16 v[216:219], v[156:159], v[32:35], v[216:219]
    v_mfma_f32_16x16x32_bf16 v[220:223], v[188:191], v[32:35], v[220:223]
    v_mfma_f32_16x16x32_bf16 v[208:211], v[88:91], v[36:39], v[208:211]
    ds_read_b128 v[52:55], v13 offset:3712
    ds_read_b64 v[72:73], v12 offset:2176
    ds_read_b64 v[74:75], v12 offset:2184
    ds_read_b64 v[104:105], v12 offset:2688
    ds_read_b64 v[106:107], v12 offset:2696
    ds_read_b64 v[136:137], v12 offset:3200
    ds_read_b64 v[138:139], v12 offset:3208
    ds_read_b64 v[168:169], v12 offset:3712
    ds_read_b64 v[170:171], v12 offset:3720
    v_mfma_f32_16x16x32_bf16 v[212:215], v[120:123], v[36:39], v[212:215]
    v_mfma_f32_16x16x32_bf16 v[216:219], v[152:155], v[36:39], v[216:219]
    v_mfma_f32_16x16x32_bf16 v[220:223], v[184:187], v[36:39], v[220:223]
    v_mfma_f32_16x16x32_bf16 v[208:211], v[84:87], v[40:43], v[208:211]
    ds_read_b128 v[56:59], v13 offset:3648
    ds_read_b64 v[68:69], v12 offset:2112
    ds_read_b64 v[70:71], v12 offset:2120
    ds_read_b64 v[100:101], v12 offset:2624
    ds_read_b64 v[102:103], v12 offset:2632
    ds_read_b64 v[132:133], v12 offset:3136
    ds_read_b64 v[134:135], v12 offset:3144
    ds_read_b64 v[164:165], v12 offset:3648
    ds_read_b64 v[166:167], v12 offset:3656
    s_waitcnt lgkmcnt(14)
    v_mfma_f32_16x16x32_bf16 v[212:215], v[116:119], v[40:43], v[212:215]
    v_mfma_f32_16x16x32_bf16 v[216:219], v[148:151], v[40:43], v[216:219]
    v_mfma_f32_16x16x32_bf16 v[220:223], v[180:183], v[40:43], v[220:223]
    v_mfma_f32_16x16x32_bf16 v[208:211], v[80:83], v[44:47], v[208:211]
    ds_read_b128 v[60:63], v13 offset:3584
    ds_read_b64 v[64:65], v12 offset:2048
    ds_read_b64 v[66:67], v12 offset:2056
    ds_read_b64 v[96:97], v12 offset:2560
    ds_read_b64 v[98:99], v12 offset:2568
    ds_read_b64 v[128:129], v12 offset:3072
    ds_read_b64 v[130:131], v12 offset:3080
    ds_read_b64 v[160:161], v12 offset:3584
    ds_read_b64 v[162:163], v12 offset:3592
    v_mfma_f32_16x16x32_bf16 v[212:215], v[112:115], v[44:47], v[212:215]
    v_mfma_f32_16x16x32_bf16 v[216:219], v[144:147], v[44:47], v[216:219]
    v_mfma_f32_16x16x32_bf16 v[220:223], v[176:179], v[44:47], v[220:223]
    v_mfma_f32_16x16x32_bf16 v[208:211], v[76:79], v[48:51], v[208:211]
    ds_read_b128 v[32:35], v13 offset:3520
    v_mfma_f32_16x16x32_bf16 v[212:215], v[108:111], v[48:51], v[212:215]
    v_mfma_f32_16x16x32_bf16 v[216:219], v[140:143], v[48:51], v[216:219]
    v_mfma_f32_16x16x32_bf16 v[220:223], v[172:175], v[48:51], v[220:223]
    v_mfma_f32_16x16x32_bf16 v[208:211], v[72:75], v[52:55], v[208:211]
    ds_read_b128 v[36:39], v13 offset:3456
    s_waitcnt lgkmcnt(14)
    v_mfma_f32_16x16x32_bf16 v[212:215], v[104:107], v[52:55], v[212:215]
    v_mfma_f32_16x16x32_bf16 v[216:219], v[136:139], v[52:55], v[216:219]
    v_mfma_f32_16x16x32_bf16 v[220:223], v[168:171], v[52:55], v[220:223]
    v_mfma_f32_16x16x32_bf16 v[208:211], v[68:71], v[56:59], v[208:211]
    ds_read_b128 v[40:43], v13 offset:3392
    v_mfma_f32_16x16x32_bf16 v[212:215], v[100:103], v[56:59], v[212:215]
    s_waitcnt lgkmcnt(14)
    v_mfma_f32_16x16x32_bf16 v[216:219], v[132:135], v[56:59], v[216:219]
    s_waitcnt lgkmcnt(12)
    v_mfma_f32_16x16x32_bf16 v[220:223], v[164:167], v[56:59], v[220:223]
    s_waitcnt lgkmcnt(9)
    v_mfma_f32_16x16x32_bf16 v[208:211], v[64:67], v[60:63], v[208:211]
    ds_read_b128 v[44:47], v13 offset:3328
    s_waitcnt lgkmcnt(8)
    v_mfma_f32_16x16x32_bf16 v[212:215], v[96:99], v[60:63], v[212:215]
    s_waitcnt lgkmcnt(6)
    v_mfma_f32_16x16x32_bf16 v[216:219], v[128:131], v[60:63], v[216:219]
    s_waitcnt lgkmcnt(4)
    v_mfma_f32_16x16x32_bf16 v[220:223], v[160:163], v[60:63], v[220:223]
    s_waitcnt lgkmcnt(3)
    v_mfma_f32_16x16x32_bf16 v[212:215], v[92:95], v[32:35], v[212:215]
    ds_read_b128 v[48:51], v13 offset:3264
    v_mfma_f32_16x16x32_bf16 v[216:219], v[124:127], v[32:35], v[216:219]
    v_mfma_f32_16x16x32_bf16 v[220:223], v[156:159], v[32:35], v[220:223]
    s_waitcnt lgkmcnt(3)
    v_mfma_f32_16x16x32_bf16 v[212:215], v[88:91], v[36:39], v[212:215]
    ds_read_b128 v[52:55], v13 offset:3200
    v_mfma_f32_16x16x32_bf16 v[216:219], v[120:123], v[36:39], v[216:219]
    v_mfma_f32_16x16x32_bf16 v[220:223], v[152:155], v[36:39], v[220:223]
    s_waitcnt lgkmcnt(3)
    v_mfma_f32_16x16x32_bf16 v[212:215], v[84:87], v[40:43], v[212:215]
    ds_read_b128 v[56:59], v13 offset:3136
    v_mfma_f32_16x16x32_bf16 v[216:219], v[116:119], v[40:43], v[216:219]
    v_mfma_f32_16x16x32_bf16 v[220:223], v[148:151], v[40:43], v[220:223]
    s_waitcnt lgkmcnt(3)
    v_mfma_f32_16x16x32_bf16 v[212:215], v[80:83], v[44:47], v[212:215]
    ds_read_b128 v[60:63], v13 offset:3072
    v_mfma_f32_16x16x32_bf16 v[216:219], v[112:115], v[44:47], v[216:219]
    v_mfma_f32_16x16x32_bf16 v[220:223], v[144:147], v[44:47], v[220:223]
    s_waitcnt lgkmcnt(3)
    v_mfma_f32_16x16x32_bf16 v[212:215], v[76:79], v[48:51], v[212:215]
    ds_read_b128 v[32:35], v13 offset:3008
    v_mfma_f32_16x16x32_bf16 v[216:219], v[108:111], v[48:51], v[216:219]
    v_mfma_f32_16x16x32_bf16 v[220:223], v[140:143], v[48:51], v[220:223]
    s_waitcnt lgkmcnt(3)
    v_mfma_f32_16x16x32_bf16 v[212:215], v[72:75], v[52:55], v[212:215]
    ds_read_b128 v[36:39], v13 offset:2944
    v_mfma_f32_16x16x32_bf16 v[216:219], v[104:107], v[52:55], v[216:219]
    v_mfma_f32_16x16x32_bf16 v[220:223], v[136:139], v[52:55], v[220:223]
    s_waitcnt lgkmcnt(3)
    v_mfma_f32_16x16x32_bf16 v[212:215], v[68:71], v[56:59], v[212:215]
    ds_read_b128 v[40:43], v13 offset:2880
    v_mfma_f32_16x16x32_bf16 v[216:219], v[100:103], v[56:59], v[216:219]
    v_mfma_f32_16x16x32_bf16 v[220:223], v[132:135], v[56:59], v[220:223]
    s_waitcnt lgkmcnt(3)
    v_mfma_f32_16x16x32_bf16 v[212:215], v[64:67], v[60:63], v[212:215]
    ds_read_b128 v[44:47], v13 offset:2816
    v_mfma_f32_16x16x32_bf16 v[216:219], v[96:99], v[60:63], v[216:219]
    v_mfma_f32_16x16x32_bf16 v[220:223], v[128:131], v[60:63], v[220:223]
    s_waitcnt lgkmcnt(3)
    v_mfma_f32_16x16x32_bf16 v[216:219], v[92:95], v[32:35], v[216:219]
    ds_read_b128 v[48:51], v13 offset:2752
    v_mfma_f32_16x16x32_bf16 v[220:223], v[124:127], v[32:35], v[220:223]
    s_waitcnt lgkmcnt(3)
    v_mfma_f32_16x16x32_bf16 v[216:219], v[88:91], v[36:39], v[216:219]
    ds_read_b128 v[52:55], v13 offset:2688
    v_mfma_f32_16x16x32_bf16 v[220:223], v[120:123], v[36:39], v[220:223]
    s_waitcnt lgkmcnt(3)
    v_mfma_f32_16x16x32_bf16 v[216:219], v[84:87], v[40:43], v[216:219]
    ds_read_b128 v[56:59], v13 offset:2624
    v_mfma_f32_16x16x32_bf16 v[220:223], v[116:119], v[40:43], v[220:223]
    s_waitcnt lgkmcnt(3)
    v_mfma_f32_16x16x32_bf16 v[216:219], v[80:83], v[44:47], v[216:219]
    ds_read_b128 v[60:63], v13 offset:2560
    v_mfma_f32_16x16x32_bf16 v[220:223], v[112:115], v[44:47], v[220:223]
    s_waitcnt lgkmcnt(3)
    v_mfma_f32_16x16x32_bf16 v[216:219], v[76:79], v[48:51], v[216:219]
    ds_read_b128 v[32:35], v13 offset:2496
    v_mfma_f32_16x16x32_bf16 v[220:223], v[108:111], v[48:51], v[220:223]
    s_waitcnt lgkmcnt(3)
    v_mfma_f32_16x16x32_bf16 v[216:219], v[72:75], v[52:55], v[216:219]
    ds_read_b128 v[36:39], v13 offset:2432
    v_mfma_f32_16x16x32_bf16 v[220:223], v[104:107], v[52:55], v[220:223]
    s_waitcnt lgkmcnt(3)
    v_mfma_f32_16x16x32_bf16 v[216:219], v[68:71], v[56:59], v[216:219]
    ds_read_b128 v[40:43], v13 offset:2368
    v_mfma_f32_16x16x32_bf16 v[220:223], v[100:103], v[56:59], v[220:223]
    s_waitcnt lgkmcnt(3)
    v_mfma_f32_16x16x32_bf16 v[216:219], v[64:67], v[60:63], v[216:219]
    ds_read_b128 v[44:47], v13 offset:2304
    v_mfma_f32_16x16x32_bf16 v[220:223], v[96:99], v[60:63], v[220:223]
    s_waitcnt lgkmcnt(3)
    v_mfma_f32_16x16x32_bf16 v[220:223], v[92:95], v[32:35], v[220:223]
    ds_read_b128 v[48:51], v13 offset:2240
    s_waitcnt lgkmcnt(3)
    v_mfma_f32_16x16x32_bf16 v[220:223], v[88:91], v[36:39], v[220:223]
    ds_read_b128 v[52:55], v13 offset:2176
    s_waitcnt lgkmcnt(3)
    v_mfma_f32_16x16x32_bf16 v[220:223], v[84:87], v[40:43], v[220:223]
    ds_read_b128 v[56:59], v13 offset:2112
    s_waitcnt lgkmcnt(3)
    v_mfma_f32_16x16x32_bf16 v[220:223], v[80:83], v[44:47], v[220:223]
    ds_read_b128 v[60:63], v13 offset:2048
    s_waitcnt lgkmcnt(3)
    v_mfma_f32_16x16x32_bf16 v[220:223], v[76:79], v[48:51], v[220:223]
    s_waitcnt lgkmcnt(2)
    v_mfma_f32_16x16x32_bf16 v[220:223], v[72:75], v[52:55], v[220:223]
    s_waitcnt lgkmcnt(1)
    v_mfma_f32_16x16x32_bf16 v[220:223], v[68:71], v[56:59], v[220:223]
    s_waitcnt lgkmcnt(0)
    v_mfma_f32_16x16x32_bf16 v[220:223], v[64:67], v[60:63], v[220:223]
    v_lshlrev_b32 v6, 16, v6
    v_and_b32 v4, 15, v2
    v_lshlrev_b32 v4, 5, v4
    v_lshl_add_u32 v4, v7, 3, v4
    v_sub_u32 v5, 17144, v4
    v_add_u32 v5, s59, v5
    v_add_u32 v14, s59, v4
    ds_read_b64 v[32:33], v5 offset:3584
    ds_read_b64 v[34:35], v5 offset:3072
    ds_read_b64 v[36:37], v5 offset:2560
    ds_read_b64 v[38:39], v5 offset:2048
    ds_read_b64 v[40:41], v5 offset:1536
    ds_read_b64 v[42:43], v5 offset:1024
    ds_read_b64 v[44:45], v5 offset:512
    ds_read_b64 v[46:47], v5 offset:0
    s_nop 7
    s_nop 7
    s_waitcnt lgkmcnt(7)
    v_and_b32 v64, 0xffff0000, v33
    v_lshlrev_b32 v65, 16, v33
    v_and_b32 v66, 0xffff0000, v32
    v_lshlrev_b32 v67, 16, v32
    v_mul_f32 v64, v64, v6
    v_mul_f32 v65, v65, v6
    v_mul_f32 v66, v66, v6
    v_mul_f32 v67, v67, v6
    v_cvt_pk_bf16_f32 v68, v64, v65
    v_cvt_pk_bf16_f32 v69, v66, v67
    v_cvt_pk_bf16_f32 v70, v192, v193
    v_cvt_pk_bf16_f32 v71, v194, v195
    v_lshlrev_b32 v64, 16, v68
    v_and_b32 v65, 0xffff0000, v68
    v_lshlrev_b32 v66, 16, v70
    v_and_b32 v67, 0xffff0000, v70
    v_add_f32 v64, v64, v66
    v_add_f32 v65, v65, v67
    v_cvt_pk_bf16_f32 v72, v64, v65
    v_lshlrev_b32 v64, 16, v69
    v_and_b32 v65, 0xffff0000, v69
    v_lshlrev_b32 v66, 16, v71
    v_and_b32 v67, 0xffff0000, v71
    v_add_f32 v64, v64, v66
    v_add_f32 v65, v65, v67
    v_cvt_pk_bf16_f32 v73, v64, v65
    ds_write_b64 v14, v[72:73] offset:0
    s_waitcnt lgkmcnt(7)
    v_and_b32 v80, 0xffff0000, v35
    v_lshlrev_b32 v81, 16, v35
    v_and_b32 v82, 0xffff0000, v34
    v_lshlrev_b32 v83, 16, v34
    v_mul_f32 v80, v80, v6
    v_mul_f32 v81, v81, v6
    v_mul_f32 v82, v82, v6
    v_mul_f32 v83, v83, v6
    v_cvt_pk_bf16_f32 v84, v80, v81
    v_cvt_pk_bf16_f32 v85, v82, v83
    v_cvt_pk_bf16_f32 v86, v196, v197
    v_cvt_pk_bf16_f32 v87, v198, v199
    v_lshlrev_b32 v80, 16, v84
    v_and_b32 v81, 0xffff0000, v84
    v_lshlrev_b32 v82, 16, v86
    v_and_b32 v83, 0xffff0000, v86
    v_add_f32 v80, v80, v82
    v_add_f32 v81, v81, v83
    v_cvt_pk_bf16_f32 v88, v80, v81
    v_lshlrev_b32 v80, 16, v85
    v_and_b32 v81, 0xffff0000, v85
    v_lshlrev_b32 v82, 16, v87
    v_and_b32 v83, 0xffff0000, v87
    v_add_f32 v80, v80, v82
    v_add_f32 v81, v81, v83
    v_cvt_pk_bf16_f32 v89, v80, v81
    ds_write_b64 v14, v[88:89] offset:512
    s_waitcnt lgkmcnt(7)
    v_and_b32 v64, 0xffff0000, v37
    v_lshlrev_b32 v65, 16, v37
    v_and_b32 v66, 0xffff0000, v36
    v_lshlrev_b32 v67, 16, v36
    v_mul_f32 v64, v64, v6
    v_mul_f32 v65, v65, v6
    v_mul_f32 v66, v66, v6
    v_mul_f32 v67, v67, v6
    v_cvt_pk_bf16_f32 v68, v64, v65
    v_cvt_pk_bf16_f32 v69, v66, v67
    v_cvt_pk_bf16_f32 v70, v200, v201
    v_cvt_pk_bf16_f32 v71, v202, v203
    v_lshlrev_b32 v64, 16, v68
    v_and_b32 v65, 0xffff0000, v68
    v_lshlrev_b32 v66, 16, v70
    v_and_b32 v67, 0xffff0000, v70
    v_add_f32 v64, v64, v66
    v_add_f32 v65, v65, v67
    v_cvt_pk_bf16_f32 v72, v64, v65
    v_lshlrev_b32 v64, 16, v69
    v_and_b32 v65, 0xffff0000, v69
    v_lshlrev_b32 v66, 16, v71
    v_and_b32 v67, 0xffff0000, v71
    v_add_f32 v64, v64, v66
    v_add_f32 v65, v65, v67
    v_cvt_pk_bf16_f32 v73, v64, v65
    ds_write_b64 v14, v[72:73] offset:1024
    s_waitcnt lgkmcnt(7)
    v_and_b32 v80, 0xffff0000, v39
    v_lshlrev_b32 v81, 16, v39
    v_and_b32 v82, 0xffff0000, v38
    v_lshlrev_b32 v83, 16, v38
    v_mul_f32 v80, v80, v6
    v_mul_f32 v81, v81, v6
    v_mul_f32 v82, v82, v6
    v_mul_f32 v83, v83, v6
    v_cvt_pk_bf16_f32 v84, v80, v81
    v_cvt_pk_bf16_f32 v85, v82, v83
    v_cvt_pk_bf16_f32 v86, v204, v205
    v_cvt_pk_bf16_f32 v87, v206, v207
    v_lshlrev_b32 v80, 16, v84
    v_and_b32 v81, 0xffff0000, v84
    v_lshlrev_b32 v82, 16, v86
    v_and_b32 v83, 0xffff0000, v86
    v_add_f32 v80, v80, v82
    v_add_f32 v81, v81, v83
    v_cvt_pk_bf16_f32 v88, v80, v81
    v_lshlrev_b32 v80, 16, v85
    v_and_b32 v81, 0xffff0000, v85
    v_lshlrev_b32 v82, 16, v87
    v_and_b32 v83, 0xffff0000, v87
    v_add_f32 v80, v80, v82
    v_add_f32 v81, v81, v83
    v_cvt_pk_bf16_f32 v89, v80, v81
    ds_write_b64 v14, v[88:89] offset:1536
    s_waitcnt lgkmcnt(7)
    v_and_b32 v64, 0xffff0000, v41
    v_lshlrev_b32 v65, 16, v41
    v_and_b32 v66, 0xffff0000, v40
    v_lshlrev_b32 v67, 16, v40
    v_mul_f32 v64, v64, v6
    v_mul_f32 v65, v65, v6
    v_mul_f32 v66, v66, v6
    v_mul_f32 v67, v67, v6
    v_cvt_pk_bf16_f32 v68, v64, v65
    v_cvt_pk_bf16_f32 v69, v66, v67
    v_cvt_pk_bf16_f32 v70, v208, v209
    v_cvt_pk_bf16_f32 v71, v210, v211
    v_lshlrev_b32 v64, 16, v68
    v_and_b32 v65, 0xffff0000, v68
    v_lshlrev_b32 v66, 16, v70
    v_and_b32 v67, 0xffff0000, v70
    v_add_f32 v64, v64, v66
    v_add_f32 v65, v65, v67
    v_cvt_pk_bf16_f32 v72, v64, v65
    v_lshlrev_b32 v64, 16, v69
    v_and_b32 v65, 0xffff0000, v69
    v_lshlrev_b32 v66, 16, v71
    v_and_b32 v67, 0xffff0000, v71
    v_add_f32 v64, v64, v66
    v_add_f32 v65, v65, v67
    v_cvt_pk_bf16_f32 v73, v64, v65
    ds_write_b64 v14, v[72:73] offset:2048
    s_waitcnt lgkmcnt(7)
    v_and_b32 v80, 0xffff0000, v43
    v_lshlrev_b32 v81, 16, v43
    v_and_b32 v82, 0xffff0000, v42
    v_lshlrev_b32 v83, 16, v42
    v_mul_f32 v80, v80, v6
    v_mul_f32 v81, v81, v6
    v_mul_f32 v82, v82, v6
    v_mul_f32 v83, v83, v6
    v_cvt_pk_bf16_f32 v84, v80, v81
    v_cvt_pk_bf16_f32 v85, v82, v83
    v_cvt_pk_bf16_f32 v86, v212, v213
    v_cvt_pk_bf16_f32 v87, v214, v215
    v_lshlrev_b32 v80, 16, v84
    v_and_b32 v81, 0xffff0000, v84
    v_lshlrev_b32 v82, 16, v86
    v_and_b32 v83, 0xffff0000, v86
    v_add_f32 v80, v80, v82
    v_add_f32 v81, v81, v83
    v_cvt_pk_bf16_f32 v88, v80, v81
    v_lshlrev_b32 v80, 16, v85
    v_and_b32 v81, 0xffff0000, v85
    v_lshlrev_b32 v82, 16, v87
    v_and_b32 v83, 0xffff0000, v87
    v_add_f32 v80, v80, v82
    v_add_f32 v81, v81, v83
    v_cvt_pk_bf16_f32 v89, v80, v81
    ds_write_b64 v14, v[88:89] offset:2560
    s_waitcnt lgkmcnt(7)
    v_and_b32 v64, 0xffff0000, v45
    v_lshlrev_b32 v65, 16, v45
    v_and_b32 v66, 0xffff0000, v44
    v_lshlrev_b32 v67, 16, v44
    v_mul_f32 v64, v64, v6
    v_mul_f32 v65, v65, v6
    v_mul_f32 v66, v66, v6
    v_mul_f32 v67, v67, v6
    v_cvt_pk_bf16_f32 v68, v64, v65
    v_cvt_pk_bf16_f32 v69, v66, v67
    v_cvt_pk_bf16_f32 v70, v216, v217
    v_cvt_pk_bf16_f32 v71, v218, v219
    v_lshlrev_b32 v64, 16, v68
    v_and_b32 v65, 0xffff0000, v68
    v_lshlrev_b32 v66, 16, v70
    v_and_b32 v67, 0xffff0000, v70
    v_add_f32 v64, v64, v66
    v_add_f32 v65, v65, v67
    v_cvt_pk_bf16_f32 v72, v64, v65
    v_lshlrev_b32 v64, 16, v69
    v_and_b32 v65, 0xffff0000, v69
    v_lshlrev_b32 v66, 16, v71
    v_and_b32 v67, 0xffff0000, v71
    v_add_f32 v64, v64, v66
    v_add_f32 v65, v65, v67
    v_cvt_pk_bf16_f32 v73, v64, v65
    ds_write_b64 v14, v[72:73] offset:3072
    s_waitcnt lgkmcnt(7)
    v_and_b32 v80, 0xffff0000, v47
    v_lshlrev_b32 v81, 16, v47
    v_and_b32 v82, 0xffff0000, v46
    v_lshlrev_b32 v83, 16, v46
    v_mul_f32 v80, v80, v6
    v_mul_f32 v81, v81, v6
    v_mul_f32 v82, v82, v6
    v_mul_f32 v83, v83, v6
    v_cvt_pk_bf16_f32 v84, v80, v81
    v_cvt_pk_bf16_f32 v85, v82, v83
    v_cvt_pk_bf16_f32 v86, v220, v221
    v_cvt_pk_bf16_f32 v87, v222, v223
    v_lshlrev_b32 v80, 16, v84
    v_and_b32 v81, 0xffff0000, v84
    v_lshlrev_b32 v82, 16, v86
    v_and_b32 v83, 0xffff0000, v86
    v_add_f32 v80, v80, v82
    v_add_f32 v81, v81, v83
    v_cvt_pk_bf16_f32 v88, v80, v81
    v_lshlrev_b32 v80, 16, v85
    v_and_b32 v81, 0xffff0000, v85
    v_lshlrev_b32 v82, 16, v87
    v_and_b32 v83, 0xffff0000, v87
    v_add_f32 v80, v80, v82
    v_add_f32 v81, v81, v83
    v_cvt_pk_bf16_f32 v89, v80, v81
    ds_write_b64 v14, v[88:89] offset:3584
    s_waitcnt lgkmcnt(0)
    v_mov_b32 v23, 150528
    v_mov_b32 v24, 1
    s_mov_b64 exec, 1
    ds_add_u32 v23, v24 offset:4
    s_mov_b64 exec, -1
k2_kernel_ts:
    ds_read_b32 v25, v23 offset:4
    s_waitcnt lgkmcnt(0)
    v_readfirstlane_b32 s62, v25
    s_nop 3
    s_cmp_ge_u32 s62, 4
    s_cbranch_scc1 k2_kernel_ts_d
    s_sleep 1
    s_branch k2_kernel_ts
k2_kernel_ts_d:
    v_subrev_u32 v15, 256, v0
    v_lshlrev_b32 v4, 2, v15
    v_add_u32 v4, 65536, v4
    v_add_u32 v7, 42496, v4
    ds_read_b32 v32, v4 offset:0
    ds_read_b32 v33, v4 offset:21248
    ds_read_b32 v34, v7 offset:0
    ds_read_b32 v35, v7 offset:21248
    ds_read_b32 v36, v4 offset:1024
    ds_read_b32 v37, v4 offset:22272
    ds_read_b32 v38, v7 offset:1024
    ds_read_b32 v39, v7 offset:22272
    ds_read_b32 v40, v4 offset:2048
    ds_read_b32 v41, v4 offset:23296
    ds_read_b32 v42, v7 offset:2048
    ds_read_b32 v43, v7 offset:23296
    ds_read_b32 v44, v4 offset:3072
    ds_read_b32 v45, v4 offset:24320
    ds_read_b32 v46, v7 offset:3072
    ds_read_b32 v47, v7 offset:24320
    s_mov_b32 s40, 0x05040100
    s_mov_b32 s41, 0x07060302
    s_lshl_b32 s42, s2, 14
    v_lshlrev_b32 v5, 4, v15
    v_add_u32 v5, s42, v5
    s_waitcnt lgkmcnt(12)
    v_perm_b32 v64, v33, v32, s40
    v_perm_b32 v65, v35, v34, s40
    v_perm_b32 v66, v33, v32, s41
    v_perm_b32 v67, v35, v34, s41
    v_add_u32 v6, 0, v5
    buffer_store_dwordx4 v[64:67], v6, s[16:19], 0 offen sc1
    s_waitcnt lgkmcnt(8)
    v_perm_b32 v68, v37, v36, s40
    v_perm_b32 v69, v39, v38, s40
    v_perm_b32 v70, v37, v36, s41
    v_perm_b32 v71, v39, v38, s41
    v_add_u32 v6, 4096, v5
    buffer_store_dwordx4 v[68:71], v6, s[16:19], 0 offen sc1
    s_waitcnt lgkmcnt(4)
    v_perm_b32 v72, v41, v40, s40
    v_perm_b32 v73, v43, v42, s40
    v_perm_b32 v74, v41, v40, s41
    v_perm_b32 v75, v43, v42, s41
    v_add_u32 v6, 8192, v5
    buffer_store_dwordx4 v[72:75], v6, s[16:19], 0 offen sc1
    s_waitcnt lgkmcnt(0)
    v_perm_b32 v76, v45, v44, s40
    v_perm_b32 v77, v47, v46, s40
    v_perm_b32 v78, v45, v44, s41
    v_perm_b32 v79, v47, v46, s41
    v_add_u32 v6, 12288, v5
    buffer_store_dwordx4 v[76:79], v6, s[16:19], 0 offen sc1
    s_waitcnt vmcnt(0)
    s_add_u32 s40, s4, 30932992
    s_addc_u32 s41, s5, 0
    s_mov_b32 s42, 4096
    s_mov_b32 s43, 0x00020000
    s_lshl_b32 s56, s2, 2
    s_add_u32 s56, s56, s33
    s_lshl_b32 s56, s56, 2
    v_mov_b32 v4, s56
    v_mov_b32 v5, 1
    s_mov_b64 exec, 1
    buffer_store_dword v5, v4, s[40:43], 0 offen sc1
    s_mov_b64 exec, -1
    s_lshl_b32 s38, s36, 7
    s_lshl_b32 s39, s33, 5
    s_add_u32 s38, s38, s39
    s_lshl_b32 s36, s37, 7
    v_lshrrev_b32 v4, 3, v2
    v_add_u32 v4, s38, v4
    v_lshlrev_b32 v4, 11, v4
    v_and_b32 v5, 7, v2
    v_lshl_add_u32 v4, v5, 4, v4
    v_add_u32 v4, s36, v4
    s_mov_b32 s24, s50
    s_mov_b32 s25, s51
    s_mov_b32 s26, 4194304
    s_mov_b32 s27, 0x00020000
    s_add_u32 s28, s4, 29360128
    s_addc_u32 s29, s5, 0
    s_mov_b32 s30, 16384
    s_mov_b32 s31, 0x00020000
    s_add_u32 m0, s59, 4096
    s_mov_b32 s60, 0
    buffer_load_dwordx4 v4, s[24:27], s60 offen lds
    s_add_u32 m0, s59, 5120
    s_mov_b32 s60, 16384
    buffer_load_dwordx4 v4, s[24:27], s60 offen lds
    s_add_u32 m0, s59, 6144
    s_mov_b32 s60, 32768
    buffer_load_dwordx4 v4, s[24:27], s60 offen lds
    s_add_u32 m0, s59, 7168
    s_mov_b32 s60, 49152
    buffer_load_dwordx4 v4, s[24:27], s60 offen lds
    s_lshl_b32 s56, s38, 3
    v_add_u32 v7, s56, v3
    s_add_u32 m0, s59, 8192
    s_nop 0
    buffer_load_dwordx4 v7, s[28:31], 0 offen lds
    s_lshl_b32 s56, s36, 1
    v_lshlrev_b32 v19, 2, v2
    v_add_u32 v19, s56, v19
    s_cmp_eq_u32 s33, 0
    s_cbranch_scc0 k2_kernel_wait_lds
    s_mov_b32 s58, 100000
k2_kernel_poll:
    buffer_load_dword v20, v19, s[40:43], 0 offen sc1
    s_waitcnt vmcnt(0)
    v_cmp_ne_u32 vcc, 0, v20
    s_nop 3
    s_cmp_eq_u64 vcc, -1
    s_cbranch_scc1 k2_kernel_polled1
    s_sleep 16
    s_sub_u32 s58, s58, 1
    s_cmp_lg_u32 s58, 0
    s_cbranch_scc1 k2_kernel_poll
k2_kernel_polled1:
    v_mov_b32 v23, 150528
    v_mov_b32 v24, 1
    s_mov_b64 exec, 1
    ds_add_u32 v23, v24 offset:12
    s_mov_b64 exec, -1
    s_branch k2_kernel_polled2
k2_kernel_wait_lds:
    v_mov_b32 v23, 150528
k2_kernel_wl:
    ds_read_b32 v25, v23 offset:12
    s_waitcnt lgkmcnt(0)
    v_readfirstlane_b32 s62, v25
    s_nop 3
    s_cmp_ge_u32 s62, 1
    s_cbranch_scc1 k2_kernel_polled2
    s_sleep 8
    s_branch k2_kernel_wl
k2_kernel_polled2:
    v_lshrrev_b32 v4, 4, v2
    v_lshlrev_b32 v4, 14, v4
    v_and_b32 v5, 15, v2
    v_lshl_add_u32 v4, v5, 4, v4
    s_lshl_b32 s56, s36, 11
    s_lshl_b32 s57, s38, 3
    s_add_u32 s56, s56, s57
    v_add_u32 v21, s56, v4
    v_add_u32 v22, s59, v3
    s_mov_b32 s60, 0
    buffer_load_dwordx4 v[64:67], v21, s[16:19], s60 offen sc1
    s_mov_b32 s60, 65536
    buffer_load_dwordx4 v[68:71], v21, s[16:19], s60 offen sc1
    s_mov_b32 s60, 131072
    buffer_load_dwordx4 v[72:75], v21, s[16:19], s60 offen sc1
    s_mov_b32 s60, 196608
    buffer_load_dwordx4 v[76:79], v21, s[16:19], s60 offen sc1
    s_waitcnt vmcnt(0)
    ds_write_b128 v22, v[64:67] offset:12288
    ds_write_b128 v22, v[68:71] offset:13312
    ds_write_b128 v22, v[72:75] offset:14336
    ds_write_b128 v22, v[76:79] offset:15360
    s_waitcnt lgkmcnt(0)
    v_mov_b32 v23, 150528
    v_mov_b32 v24, 1
    s_mov_b64 exec, 1
    ds_add_u32 v23, v24 offset:8
    s_mov_b64 exec, -1
k2_kernel_end:
    s_endpgm
.section .rodata,"a"
.p2align 6
.amdhsa_kernel k2_kernel
  .amdhsa_next_free_vgpr 224
  .amdhsa_next_free_sgpr 96
  .amdhsa_accum_offset 224
  .amdhsa_group_segment_fixed_size 0
  .amdhsa_kernarg_size 104
  .amdhsa_user_sgpr_count 2
  .amdhsa_user_sgpr_kernarg_segment_ptr 1
  .amdhsa_system_sgpr_workgroup_id_x 1
.end_amdhsa_kernel
.text
```
